```python
import torch

def _softmax(x, axis=-1):
    return torch.softmax(x, dim=axis)
def _gelu(x):
    return torch.nn.functional.gelu(x, approximate="tanh")
def _silu(x):
    return torch.nn.functional.silu(x)
def _sigmoid(x):
    return torch.sigmoid(x)
def _layernorm(x, axis=-1, eps=1e-5):
    m = x.mean(dim=axis, keepdim=True)
    v = x.var(dim=axis, keepdim=True, unbiased=False)
    return (x - m) / torch.sqrt(v + eps)
def _scatter_add(tgt, idx, src, axis=0):
    return tgt.clone().index_add_(axis, idx, src)
def _segment_sum(src, seg, n):
    out = torch.zeros((n,) + src.shape[1:], dtype=src.dtype)
    return out.index_add_(0, seg, src)
def _pad(x, pw):
    flat = tuple(v for pair in reversed(pw) for v in pair)
    return torch.nn.functional.pad(x, flat)

kernel_name = 'concat_heads__gqa_block_cached__mha_block_cached__near_ridge'

def setup_inputs():

    _w = (lambda a: (lambda t: t.to(torch.bfloat16) if t.is_floating_point() else t)(torch.as_tensor(a)))
    def _A_setup():
        B, Sq, D = 8, 96, 640
        Hq, Hkv, Sk, Dh = 32, 32, 512, 128
        assert Hq % Hkv == 0, (Hq, Hkv)
        return {
            "x": _w((lambda *s: torch.randn(*s, dtype=torch.bfloat16) * 0.8)(B, Sq, D)),
            "k_cache": _w((lambda *s: torch.randn(*s, dtype=torch.bfloat16) * 0.8)(B, Hkv, Sk, Dh)),
            "v_cache": _w((lambda *s: torch.randn(*s, dtype=torch.bfloat16) * 0.05)(B, Hkv, Sk, Dh)),
            "wq": _w((lambda *s: torch.randn(*s, dtype=torch.bfloat16) * 0.8)(D, Hq * Dh) * (D ** -0.5)),
            "wo": _w((lambda *s: torch.randn(*s, dtype=torch.bfloat16) * 0.05)(Hq * Dh, D) * ((Hq * Dh) ** -0.5)),
        }
    _A_in = _A_setup()

    def _B_setup():
        B, Sq, D = 8, 96, 640
        H, Sk, Dh = 32, 512, 128
        return {
            "x": _w((lambda *s: torch.randn(*s, dtype=torch.bfloat16) * 0.8)(B, Sq, D)),
            "k_cache": _w((lambda *s: torch.randn(*s, dtype=torch.bfloat16) * 0.8)(B, H, Sk, Dh)),
            "v_cache": _w((lambda *s: torch.randn(*s, dtype=torch.bfloat16) * 0.05)(B, H, Sk, Dh)),
            "wq": _w((lambda *s: torch.randn(*s, dtype=torch.bfloat16) * 0.8)(D, H * Dh) * (D ** -0.5)),
            "wo": _w((lambda *s: torch.randn(*s, dtype=torch.bfloat16) * 0.05)(H * Dh, D) * ((H * Dh) ** -0.5)),
        }
    _B_in = _B_setup()

    return {
        "A_x": _A_in["x"],
        "A_k_cache": _A_in["k_cache"],
        "A_v_cache": _A_in["v_cache"],
        "A_wq": _A_in["wq"],
        "A_wo": _A_in["wo"],
        "B_x": _B_in["x"],
        "B_k_cache": _B_in["k_cache"],
        "B_v_cache": _B_in["v_cache"],
        "B_wq": _B_in["wq"],
        "B_wo": _B_in["wo"],
    }

def reference(A_x, A_k_cache, A_v_cache, A_wq, A_wo, B_x, B_k_cache, B_v_cache, B_wq, B_wo):
    def _A_ref(x, k_cache, v_cache, wq, wo):
        B, Sq, D = x.shape
        Hq, Dh = 32, 128
        Hkv = k_cache.shape[1]
        rep = Hq // Hkv
        q = (lambda x, *d: x.permute(*d))((x @ wq).reshape(B, Sq, Hq, Dh), 0, 2, 1, 3)
        k = (lambda x, n, axis: torch.repeat_interleave(x, n, dim=axis))(k_cache, rep, axis=1)
        v = (lambda x, n, axis: torch.repeat_interleave(x, n, dim=axis))(v_cache, rep, axis=1)
        scores = torch.einsum("bhqd,bhkd->bhqk", q, k) * (Dh ** -0.5)
        p = _softmax(scores, axis=-1)
        o = torch.einsum("bhqk,bhkd->bhqd", p, v)
        return (lambda x, *d: x.permute(*d))(o, 0, 2, 1, 3).reshape(B, Sq, Hq * Dh) @ wo

    def _B_ref(x, k_cache, v_cache, wq, wo):
        B, Sq, D = x.shape
        H, Dh = 32, 128
        q = (lambda x, *d: x.permute(*d))((x @ wq).reshape(B, Sq, H, Dh), 0, 2, 1, 3)
        scores = torch.einsum("bhqd,bhkd->bhqk", q, k_cache) * (Dh ** -0.5)
        p = _softmax(scores, axis=-1)
        o = torch.einsum("bhqk,bhkd->bhqd", p, v_cache)
        return (lambda x, *d: x.permute(*d))(o, 0, 2, 1, 3).reshape(B, Sq, H * Dh) @ wo

    a = _A_ref(A_x, A_k_cache, A_v_cache, A_wq, A_wo)
    b = _B_ref(B_x, B_k_cache, B_v_cache, B_wq, B_wo)
    return torch.concatenate([a, b], axis=-1)
```

```asm
; @launch grid=(256,1,1) block=(256,1,1) lds=163840
.amdgcn_target "amdgcn-amd-amdhsa--gfx950"
.text
.globl concat_heads__gqa_block_cached__mha_block_cached__near_ridge_kernel
.p2align 8
.type concat_heads__gqa_block_cached__mha_block_cached__near_ridge_kernel,@function
concat_heads__gqa_block_cached__mha_block_cached__near_ridge_kernel:
s_cmp_ge_u32 s2, 256
s_cbranch_scc1 L_exit
s_and_b32 s41, s2, 7
s_lshr_b32 s40, s41, 2
s_mul_i32 s42, s40, 40
s_add_u32 s98, s0, s42
s_addc_u32 s99, s1, 0
s_load_dwordx8 s[88:95], s[98:99], 0
s_load_dwordx2 s[28:29], s[98:99], 32
s_load_dwordx2 s[32:33], s[0:1], 80
s_load_dwordx2 s[4:5], s[0:1], 88
s_load_dwordx2 s[24:25], s[0:1], 96
v_lshrrev_b32 v1, 6, v0
s_and_b32 s39, s41, 3
v_readfirstlane_b32 s36, v1
s_lshr_b32 s41, s2, 3
s_and_b32 s37, s41, 7
s_lshr_b32 s38, s41, 3
s_lshl_b32 s45, s40, 3
s_add_u32 s45, s45, s37
s_lshl_b32 s42, s39, 3
s_lshl_b32 s41, s38, 1
s_add_u32 s42, s42, s41
s_lshl_b32 s43, s37, 5
s_add_u32 s43, s43, s42
s_cmp_eq_u32 s36, 3
s_cbranch_scc1 L_loader
s_getpc_b64 s[96:97]
L_pc:
s_mov_b32 s41, L_exit-L_pc
s_lshr_b32 s44, s2, 3
s_lshl_b32 s44, s44, 7
v_lshlrev_b32 v2, 12, v0
v_add_u32 v2, s44, v2
v_cmp_gt_u32 vcc, s41, v2
s_and_saveexec_b64 s[46:47], vcc
s_cbranch_execz L_nopf0
global_load_dword v47, v2, s[96:97]
L_nopf0:
s_mov_b64 exec, s[46:47]
s_branch L_awave
L_loader:
v_and_b32 v0, 63, v0
v_lshrrev_b32 v1, 3, v0
v_and_b32 v2, 7, v0
v_add_u32 v3, 0, v1
v_bfe_u32 v23, v3, 1, 3
v_xor_b32 v23, v23, v2
v_lshlrev_b32 v23, 4, v23
v_mul_u32_u24 v3, 1280, v3
v_add_u32 v23, v23, v3
v_subrev_u32 v13, 0, v23
v_add_u32 v15, 18432, v13
v_add_u32 v3, 8, v1
v_bfe_u32 v23, v3, 1, 3
v_xor_b32 v23, v23, v2
v_lshlrev_b32 v23, 4, v23
v_mul_u32_u24 v3, 1280, v3
v_add_u32 v23, v23, v3
v_subrev_u32 v14, 1024, v23
v_add_u32 v16, 18432, v14
v_lshrrev_b32 v1, 4, v0
v_and_b32 v2, 15, v0
v_lshlrev_b32 v3, 2, v1
v_xor_b32 v3, v3, v2
v_lshlrev_b32 v3, 4, v3
v_lshl_add_u32 v8, v1, 8, v3
v_lshl_add_u32 v9, v1, 13, v3
v_add_u32 v10, 31744, v9
v_add_u32 v11, 63488, v9
v_add_u32 v12, 95232, v9
v_xor_b32 v3, v1, v2
v_lshlrev_b32 v3, 4, v3
v_lshl_add_u32 v4, v1, 8, v3
v_xor_b32 v5, 64, v4
v_xor_b32 v6, 128, v4
v_xor_b32 v7, 192, v4
s_mul_i32 s41, s37, 5
s_lshr_b32 s41, s41, 2
s_mul_i32 s44, s38, 5
s_lshr_b32 s44, s44, 1
s_add_u32 s41, s41, s44
s_cmp_ge_u32 s41, 10
s_cselect_b32 s44, 10, 0
s_sub_u32 s41, s41, s44
s_lshl_b32 s50, s42, 8
s_add_u32 s51, s50, 5242880
s_lshl_b32 s44, s41, 19
s_add_u32 s50, s50, s44
s_mul_i32 s52, s37, 122880
s_add_u32 s53, s52, 1280
s_lshl_b32 s44, s41, 7
s_add_u32 s52, s52, s44
s_lshl_b32 s54, s43, 17
s_mov_b32 s55, s54
s_mul_i32 s58, s2, 0x9E3779B1
s_lshr_b32 s58, s58, 27
s_lshl_b32 s58, s58, 12
s_mov_b32 s59, s58
s_mov_b32 s60, 4096
s_mov_b32 s10, 983040
s_mov_b32 s11, 0x20000
s_mov_b32 s22, 5242880
s_mov_b32 s23, 0x20000
s_mov_b32 s14, 33554432
s_mov_b32 s15, 0x20000
s_mov_b32 s18, 33554432
s_mov_b32 s19, 0x20000
s_waitcnt lgkmcnt(0)
s_mov_b32 s8, s88
s_and_b32 s9, s89, 0xffff
s_mov_b32 s20, s94
s_and_b32 s21, s95, 0xffff
s_mov_b32 s12, s90
s_and_b32 s13, s91, 0xffff
s_mov_b32 s16, s92
s_and_b32 s17, s93, 0xffff
L_schedE:
s_mov_b32 m0, 40960
s_nop 0
buffer_load_dwordx4 v13, s[8:11], s52 offen offset:0 lds
buffer_load_dwordx4 v14, s[8:11], s52 offen offset:1024 lds
buffer_load_dwordx4 v15, s[8:11], s52 offen offset:2048 lds
buffer_load_dwordx4 v16, s[8:11], s52 offen offset:3072 lds
s_add_u32 m0, m0, 4096
s_add_u32 s41, s52, 40960
buffer_load_dwordx4 v13, s[8:11], s41 offen offset:0 lds
buffer_load_dwordx4 v14, s[8:11], s41 offen offset:1024 lds
s_mov_b32 m0, 45056
s_add_u32 s41, s52, 40960
buffer_load_dwordx4 v15, s[8:11], s41 offen offset:2048 lds
buffer_load_dwordx4 v16, s[8:11], s41 offen offset:3072 lds
s_add_u32 m0, m0, 4096
s_add_u32 s41, s52, 81920
buffer_load_dwordx4 v13, s[8:11], s41 offen offset:0 lds
buffer_load_dwordx4 v14, s[8:11], s41 offen offset:1024 lds
buffer_load_dwordx4 v15, s[8:11], s41 offen offset:2048 lds
buffer_load_dwordx4 v16, s[8:11], s41 offen offset:3072 lds
s_add_u32 s52, s52, 128
s_cmp_ge_u32 s52, s53
s_cselect_b32 s41, 1280, 0
s_sub_u32 s52, s52, s41
s_mov_b32 m0, 0
s_nop 0
buffer_load_dwordx4 v9, s[20:23], s50 offen offset:0 lds
buffer_load_dwordx4 v10, s[20:23], s50 offen offset:1024 lds
buffer_load_dwordx4 v11, s[20:23], s50 offen offset:2048 lds
buffer_load_dwordx4 v12, s[20:23], s50 offen offset:3072 lds
s_add_u32 m0, m0, 4096
s_add_u32 s41, s50, 131072
buffer_load_dwordx4 v9, s[20:23], s41 offen offset:0 lds
buffer_load_dwordx4 v10, s[20:23], s41 offen offset:1024 lds
buffer_load_dwordx4 v11, s[20:23], s41 offen offset:2048 lds
buffer_load_dwordx4 v12, s[20:23], s41 offen offset:3072 lds
s_add_u32 s50, s50, 262144
s_cmp_ge_u32 s50, s51
s_cselect_b32 s41, 5242880, 0
s_sub_u32 s50, s50, s41
s_mov_b32 m0, 8192
s_nop 0
buffer_load_dwordx4 v9, s[20:23], s50 offen offset:0 lds
buffer_load_dwordx4 v10, s[20:23], s50 offen offset:1024 lds
buffer_load_dwordx4 v11, s[20:23], s50 offen offset:2048 lds
buffer_load_dwordx4 v12, s[20:23], s50 offen offset:3072 lds
s_add_u32 m0, m0, 4096
s_add_u32 s41, s50, 131072
buffer_load_dwordx4 v9, s[20:23], s41 offen offset:0 lds
buffer_load_dwordx4 v10, s[20:23], s41 offen offset:1024 lds
buffer_load_dwordx4 v11, s[20:23], s41 offen offset:2048 lds
buffer_load_dwordx4 v12, s[20:23], s41 offen offset:3072 lds
s_add_u32 s50, s50, 262144
s_cmp_ge_u32 s50, s51
s_cselect_b32 s41, 5242880, 0
s_sub_u32 s50, s50, s41
s_waitcnt vmcnt(8)
s_barrier
s_mov_b32 m0, 53248
s_nop 0
buffer_load_dwordx4 v13, s[8:11], s52 offen offset:0 lds
buffer_load_dwordx4 v14, s[8:11], s52 offen offset:1024 lds
buffer_load_dwordx4 v15, s[8:11], s52 offen offset:2048 lds
buffer_load_dwordx4 v16, s[8:11], s52 offen offset:3072 lds
s_add_u32 m0, m0, 4096
s_add_u32 s41, s52, 40960
buffer_load_dwordx4 v13, s[8:11], s41 offen offset:0 lds
buffer_load_dwordx4 v14, s[8:11], s41 offen offset:1024 lds
s_mov_b32 m0, 57344
s_add_u32 s41, s52, 40960
buffer_load_dwordx4 v15, s[8:11], s41 offen offset:2048 lds
buffer_load_dwordx4 v16, s[8:11], s41 offen offset:3072 lds
s_add_u32 m0, m0, 4096
s_add_u32 s41, s52, 81920
buffer_load_dwordx4 v13, s[8:11], s41 offen offset:0 lds
buffer_load_dwordx4 v14, s[8:11], s41 offen offset:1024 lds
buffer_load_dwordx4 v15, s[8:11], s41 offen offset:2048 lds
buffer_load_dwordx4 v16, s[8:11], s41 offen offset:3072 lds
s_add_u32 s52, s52, 128
s_cmp_ge_u32 s52, s53
s_cselect_b32 s41, 1280, 0
s_sub_u32 s52, s52, s41
s_mov_b32 m0, 16384
s_nop 0
buffer_load_dwordx4 v9, s[20:23], s50 offen offset:0 lds
buffer_load_dwordx4 v10, s[20:23], s50 offen offset:1024 lds
buffer_load_dwordx4 v11, s[20:23], s50 offen offset:2048 lds
buffer_load_dwordx4 v12, s[20:23], s50 offen offset:3072 lds
s_add_u32 m0, m0, 4096
s_add_u32 s41, s50, 131072
buffer_load_dwordx4 v9, s[20:23], s41 offen offset:0 lds
buffer_load_dwordx4 v10, s[20:23], s41 offen offset:1024 lds
buffer_load_dwordx4 v11, s[20:23], s41 offen offset:2048 lds
buffer_load_dwordx4 v12, s[20:23], s41 offen offset:3072 lds
s_add_u32 s50, s50, 262144
s_cmp_ge_u32 s50, s51
s_cselect_b32 s41, 5242880, 0
s_sub_u32 s50, s50, s41
s_waitcnt vmcnt(20)
s_barrier
s_mov_b32 m0, 24576
s_nop 0
buffer_load_dwordx4 v9, s[20:23], s50 offen offset:0 lds
buffer_load_dwordx4 v10, s[20:23], s50 offen offset:1024 lds
buffer_load_dwordx4 v11, s[20:23], s50 offen offset:2048 lds
buffer_load_dwordx4 v12, s[20:23], s50 offen offset:3072 lds
s_add_u32 m0, m0, 4096
s_add_u32 s41, s50, 131072
buffer_load_dwordx4 v9, s[20:23], s41 offen offset:0 lds
buffer_load_dwordx4 v10, s[20:23], s41 offen offset:1024 lds
buffer_load_dwordx4 v11, s[20:23], s41 offen offset:2048 lds
buffer_load_dwordx4 v12, s[20:23], s41 offen offset:3072 lds
s_add_u32 s50, s50, 262144
s_cmp_ge_u32 s50, s51
s_cselect_b32 s41, 5242880, 0
s_sub_u32 s50, s50, s41
s_mov_b32 m0, 65536
s_nop 0
buffer_load_dwordx4 v13, s[8:11], s52 offen offset:0 lds
buffer_load_dwordx4 v14, s[8:11], s52 offen offset:1024 lds
buffer_load_dwordx4 v15, s[8:11], s52 offen offset:2048 lds
buffer_load_dwordx4 v16, s[8:11], s52 offen offset:3072 lds
s_add_u32 m0, m0, 4096
s_add_u32 s41, s52, 40960
buffer_load_dwordx4 v13, s[8:11], s41 offen offset:0 lds
buffer_load_dwordx4 v14, s[8:11], s41 offen offset:1024 lds
s_mov_b32 m0, 69632
s_add_u32 s41, s52, 40960
buffer_load_dwordx4 v15, s[8:11], s41 offen offset:2048 lds
buffer_load_dwordx4 v16, s[8:11], s41 offen offset:3072 lds
s_add_u32 m0, m0, 4096
s_add_u32 s41, s52, 81920
buffer_load_dwordx4 v13, s[8:11], s41 offen offset:0 lds
buffer_load_dwordx4 v14, s[8:11], s41 offen offset:1024 lds
buffer_load_dwordx4 v15, s[8:11], s41 offen offset:2048 lds
buffer_load_dwordx4 v16, s[8:11], s41 offen offset:3072 lds
s_add_u32 s52, s52, 128
s_cmp_ge_u32 s52, s53
s_cselect_b32 s41, 1280, 0
s_sub_u32 s52, s52, s41
s_mov_b32 m0, 32768
s_nop 0
buffer_load_dwordx4 v9, s[20:23], s50 offen offset:0 lds
buffer_load_dwordx4 v10, s[20:23], s50 offen offset:1024 lds
buffer_load_dwordx4 v11, s[20:23], s50 offen offset:2048 lds
buffer_load_dwordx4 v12, s[20:23], s50 offen offset:3072 lds
s_add_u32 m0, m0, 4096
s_add_u32 s41, s50, 131072
buffer_load_dwordx4 v9, s[20:23], s41 offen offset:0 lds
buffer_load_dwordx4 v10, s[20:23], s41 offen offset:1024 lds
buffer_load_dwordx4 v11, s[20:23], s41 offen offset:2048 lds
buffer_load_dwordx4 v12, s[20:23], s41 offen offset:3072 lds
s_add_u32 s50, s50, 262144
s_cmp_ge_u32 s50, s51
s_cselect_b32 s41, 5242880, 0
s_sub_u32 s50, s50, s41
s_mov_b32 m0, 0
s_nop 0
buffer_load_dwordx4 v9, s[20:23], s50 offen offset:0 lds
buffer_load_dwordx4 v10, s[20:23], s50 offen offset:1024 lds
buffer_load_dwordx4 v11, s[20:23], s50 offen offset:2048 lds
buffer_load_dwordx4 v12, s[20:23], s50 offen offset:3072 lds
s_add_u32 m0, m0, 4096
s_add_u32 s41, s50, 131072
buffer_load_dwordx4 v9, s[20:23], s41 offen offset:0 lds
buffer_load_dwordx4 v10, s[20:23], s41 offen offset:1024 lds
buffer_load_dwordx4 v11, s[20:23], s41 offen offset:2048 lds
buffer_load_dwordx4 v12, s[20:23], s41 offen offset:3072 lds
s_add_u32 s50, s50, 262144
s_cmp_ge_u32 s50, s51
s_cselect_b32 s41, 5242880, 0
s_sub_u32 s50, s50, s41
s_waitcnt vmcnt(36)
s_barrier
s_mov_b32 m0, 40960
s_nop 0
buffer_load_dwordx4 v13, s[8:11], s52 offen offset:0 lds
buffer_load_dwordx4 v14, s[8:11], s52 offen offset:1024 lds
buffer_load_dwordx4 v15, s[8:11], s52 offen offset:2048 lds
buffer_load_dwordx4 v16, s[8:11], s52 offen offset:3072 lds
s_add_u32 m0, m0, 4096
s_add_u32 s41, s52, 40960
buffer_load_dwordx4 v13, s[8:11], s41 offen offset:0 lds
buffer_load_dwordx4 v14, s[8:11], s41 offen offset:1024 lds
s_mov_b32 m0, 8192
s_nop 0
buffer_load_dwordx4 v9, s[20:23], s50 offen offset:0 lds
buffer_load_dwordx4 v10, s[20:23], s50 offen offset:1024 lds
buffer_load_dwordx4 v11, s[20:23], s50 offen offset:2048 lds
buffer_load_dwordx4 v12, s[20:23], s50 offen offset:3072 lds
s_add_u32 m0, m0, 4096
s_add_u32 s41, s50, 131072
buffer_load_dwordx4 v9, s[20:23], s41 offen offset:0 lds
buffer_load_dwordx4 v10, s[20:23], s41 offen offset:1024 lds
buffer_load_dwordx4 v11, s[20:23], s41 offen offset:2048 lds
buffer_load_dwordx4 v12, s[20:23], s41 offen offset:3072 lds
s_add_u32 s50, s50, 262144
s_cmp_ge_u32 s50, s51
s_cselect_b32 s41, 5242880, 0
s_sub_u32 s50, s50, s41
s_mov_b32 m0, 114688
s_call_b64 s[46:47], L_issK
s_waitcnt vmcnt(58)
s_barrier
s_mov_b32 m0, 45056
s_add_u32 s41, s52, 40960
buffer_load_dwordx4 v15, s[8:11], s41 offen offset:2048 lds
buffer_load_dwordx4 v16, s[8:11], s41 offen offset:3072 lds
s_add_u32 m0, m0, 4096
s_add_u32 s41, s52, 81920
buffer_load_dwordx4 v13, s[8:11], s41 offen offset:0 lds
buffer_load_dwordx4 v14, s[8:11], s41 offen offset:1024 lds
buffer_load_dwordx4 v15, s[8:11], s41 offen offset:2048 lds
buffer_load_dwordx4 v16, s[8:11], s41 offen offset:3072 lds
s_add_u32 s52, s52, 128
s_cmp_ge_u32 s52, s53
s_cselect_b32 s41, 1280, 0
s_sub_u32 s52, s52, s41
s_mov_b32 m0, 16384
s_nop 0
buffer_load_dwordx4 v9, s[20:23], s50 offen offset:0 lds
buffer_load_dwordx4 v10, s[20:23], s50 offen offset:1024 lds
buffer_load_dwordx4 v11, s[20:23], s50 offen offset:2048 lds
buffer_load_dwordx4 v12, s[20:23], s50 offen offset:3072 lds
s_add_u32 m0, m0, 4096
s_add_u32 s41, s50, 131072
buffer_load_dwordx4 v9, s[20:23], s41 offen offset:0 lds
buffer_load_dwordx4 v10, s[20:23], s41 offen offset:1024 lds
buffer_load_dwordx4 v11, s[20:23], s41 offen offset:2048 lds
buffer_load_dwordx4 v12, s[20:23], s41 offen offset:3072 lds
s_add_u32 s50, s50, 262144
s_cmp_ge_u32 s50, s51
s_cselect_b32 s41, 5242880, 0
s_sub_u32 s50, s50, s41
s_waitcnt vmcnt(52)
s_barrier
s_mov_b32 m0, 53248
s_nop 0
buffer_load_dwordx4 v13, s[8:11], s52 offen offset:0 lds
buffer_load_dwordx4 v14, s[8:11], s52 offen offset:1024 lds
buffer_load_dwordx4 v15, s[8:11], s52 offen offset:2048 lds
buffer_load_dwordx4 v16, s[8:11], s52 offen offset:3072 lds
s_add_u32 m0, m0, 4096
s_add_u32 s41, s52, 40960
buffer_load_dwordx4 v13, s[8:11], s41 offen offset:0 lds
buffer_load_dwordx4 v14, s[8:11], s41 offen offset:1024 lds
s_mov_b32 m0, 24576
s_nop 0
buffer_load_dwordx4 v9, s[20:23], s50 offen offset:0 lds
buffer_load_dwordx4 v10, s[20:23], s50 offen offset:1024 lds
buffer_load_dwordx4 v11, s[20:23], s50 offen offset:2048 lds
buffer_load_dwordx4 v12, s[20:23], s50 offen offset:3072 lds
s_add_u32 m0, m0, 4096
s_add_u32 s41, s50, 131072
buffer_load_dwordx4 v9, s[20:23], s41 offen offset:0 lds
buffer_load_dwordx4 v10, s[20:23], s41 offen offset:1024 lds
buffer_load_dwordx4 v11, s[20:23], s41 offen offset:2048 lds
buffer_load_dwordx4 v12, s[20:23], s41 offen offset:3072 lds
s_add_u32 s50, s50, 262144
s_cmp_ge_u32 s50, s51
s_cselect_b32 s41, 5242880, 0
s_sub_u32 s50, s50, s41
s_waitcnt vmcnt(58)
s_barrier
s_mov_b32 m0, 57344
s_add_u32 s41, s52, 40960
buffer_load_dwordx4 v15, s[8:11], s41 offen offset:2048 lds
buffer_load_dwordx4 v16, s[8:11], s41 offen offset:3072 lds
s_add_u32 m0, m0, 4096
s_add_u32 s41, s52, 81920
buffer_load_dwordx4 v13, s[8:11], s41 offen offset:0 lds
buffer_load_dwordx4 v14, s[8:11], s41 offen offset:1024 lds
buffer_load_dwordx4 v15, s[8:11], s41 offen offset:2048 lds
buffer_load_dwordx4 v16, s[8:11], s41 offen offset:3072 lds
s_add_u32 s52, s52, 128
s_cmp_ge_u32 s52, s53
s_cselect_b32 s41, 1280, 0
s_sub_u32 s52, s52, s41
s_mov_b32 m0, 32768
s_nop 0
buffer_load_dwordx4 v9, s[20:23], s50 offen offset:0 lds
buffer_load_dwordx4 v10, s[20:23], s50 offen offset:1024 lds
buffer_load_dwordx4 v11, s[20:23], s50 offen offset:2048 lds
buffer_load_dwordx4 v12, s[20:23], s50 offen offset:3072 lds
s_add_u32 m0, m0, 4096
s_add_u32 s41, s50, 131072
buffer_load_dwordx4 v9, s[20:23], s41 offen offset:0 lds
buffer_load_dwordx4 v10, s[20:23], s41 offen offset:1024 lds
buffer_load_dwordx4 v11, s[20:23], s41 offen offset:2048 lds
buffer_load_dwordx4 v12, s[20:23], s41 offen offset:3072 lds
s_add_u32 s50, s50, 262144
s_cmp_ge_u32 s50, s51
s_cselect_b32 s41, 5242880, 0
s_sub_u32 s50, s50, s41
s_waitcnt vmcnt(36)
s_barrier
s_mov_b32 m0, 65536
s_nop 0
buffer_load_dwordx4 v13, s[8:11], s52 offen offset:0 lds
buffer_load_dwordx4 v14, s[8:11], s52 offen offset:1024 lds
buffer_load_dwordx4 v15, s[8:11], s52 offen offset:2048 lds
buffer_load_dwordx4 v16, s[8:11], s52 offen offset:3072 lds
s_add_u32 m0, m0, 4096
s_add_u32 s41, s52, 40960
buffer_load_dwordx4 v13, s[8:11], s41 offen offset:0 lds
buffer_load_dwordx4 v14, s[8:11], s41 offen offset:1024 lds
s_mov_b32 m0, 0
s_nop 0
buffer_load_dwordx4 v9, s[20:23], s50 offen offset:0 lds
buffer_load_dwordx4 v10, s[20:23], s50 offen offset:1024 lds
buffer_load_dwordx4 v11, s[20:23], s50 offen offset:2048 lds
buffer_load_dwordx4 v12, s[20:23], s50 offen offset:3072 lds
s_add_u32 m0, m0, 4096
s_add_u32 s41, s50, 131072
buffer_load_dwordx4 v9, s[20:23], s41 offen offset:0 lds
buffer_load_dwordx4 v10, s[20:23], s41 offen offset:1024 lds
buffer_load_dwordx4 v11, s[20:23], s41 offen offset:2048 lds
buffer_load_dwordx4 v12, s[20:23], s41 offen offset:3072 lds
s_add_u32 s50, s50, 262144
s_cmp_ge_u32 s50, s51
s_cselect_b32 s41, 5242880, 0
s_sub_u32 s50, s50, s41
s_mov_b32 m0, 131072
s_call_b64 s[46:47], L_issK
s_waitcnt vmcnt(58)
s_barrier
s_mov_b32 m0, 69632
s_add_u32 s41, s52, 40960
buffer_load_dwordx4 v15, s[8:11], s41 offen offset:2048 lds
buffer_load_dwordx4 v16, s[8:11], s41 offen offset:3072 lds
s_add_u32 m0, m0, 4096
s_add_u32 s41, s52, 81920
buffer_load_dwordx4 v13, s[8:11], s41 offen offset:0 lds
buffer_load_dwordx4 v14, s[8:11], s41 offen offset:1024 lds
buffer_load_dwordx4 v15, s[8:11], s41 offen offset:2048 lds
buffer_load_dwordx4 v16, s[8:11], s41 offen offset:3072 lds
s_add_u32 s52, s52, 128
s_cmp_ge_u32 s52, s53
s_cselect_b32 s41, 1280, 0
s_sub_u32 s52, s52, s41
s_mov_b32 m0, 8192
s_nop 0
buffer_load_dwordx4 v9, s[20:23], s50 offen offset:0 lds
buffer_load_dwordx4 v10, s[20:23], s50 offen offset:1024 lds
buffer_load_dwordx4 v11, s[20:23], s50 offen offset:2048 lds
buffer_load_dwordx4 v12, s[20:23], s50 offen offset:3072 lds
s_add_u32 m0, m0, 4096
s_add_u32 s41, s50, 131072
buffer_load_dwordx4 v9, s[20:23], s41 offen offset:0 lds
buffer_load_dwordx4 v10, s[20:23], s41 offen offset:1024 lds
buffer_load_dwordx4 v11, s[20:23], s41 offen offset:2048 lds
buffer_load_dwordx4 v12, s[20:23], s41 offen offset:3072 lds
s_add_u32 s50, s50, 262144
s_cmp_ge_u32 s50, s51
s_cselect_b32 s41, 5242880, 0
s_sub_u32 s50, s50, s41
s_waitcnt vmcnt(52)
s_barrier
s_mov_b32 m0, 40960
s_nop 0
buffer_load_dwordx4 v13, s[8:11], s52 offen offset:0 lds
buffer_load_dwordx4 v14, s[8:11], s52 offen offset:1024 lds
buffer_load_dwordx4 v15, s[8:11], s52 offen offset:2048 lds
buffer_load_dwordx4 v16, s[8:11], s52 offen offset:3072 lds
s_add_u32 m0, m0, 4096
s_add_u32 s41, s52, 40960
buffer_load_dwordx4 v13, s[8:11], s41 offen offset:0 lds
buffer_load_dwordx4 v14, s[8:11], s41 offen offset:1024 lds
s_mov_b32 m0, 16384
s_nop 0
buffer_load_dwordx4 v9, s[20:23], s50 offen offset:0 lds
buffer_load_dwordx4 v10, s[20:23], s50 offen offset:1024 lds
buffer_load_dwordx4 v11, s[20:23], s50 offen offset:2048 lds
buffer_load_dwordx4 v12, s[20:23], s50 offen offset:3072 lds
s_add_u32 m0, m0, 4096
s_add_u32 s41, s50, 131072
buffer_load_dwordx4 v9, s[20:23], s41 offen offset:0 lds
buffer_load_dwordx4 v10, s[20:23], s41 offen offset:1024 lds
buffer_load_dwordx4 v11, s[20:23], s41 offen offset:2048 lds
buffer_load_dwordx4 v12, s[20:23], s41 offen offset:3072 lds
s_add_u32 s50, s50, 262144
s_cmp_ge_u32 s50, s51
s_cselect_b32 s41, 5242880, 0
s_sub_u32 s50, s50, s41
s_waitcnt vmcnt(58)
s_barrier
s_mov_b32 m0, 45056
s_add_u32 s41, s52, 40960
buffer_load_dwordx4 v15, s[8:11], s41 offen offset:2048 lds
buffer_load_dwordx4 v16, s[8:11], s41 offen offset:3072 lds
s_add_u32 m0, m0, 4096
s_add_u32 s41, s52, 81920
buffer_load_dwordx4 v13, s[8:11], s41 offen offset:0 lds
buffer_load_dwordx4 v14, s[8:11], s41 offen offset:1024 lds
buffer_load_dwordx4 v15, s[8:11], s41 offen offset:2048 lds
buffer_load_dwordx4 v16, s[8:11], s41 offen offset:3072 lds
s_add_u32 s52, s52, 128
s_cmp_ge_u32 s52, s53
s_cselect_b32 s41, 1280, 0
s_sub_u32 s52, s52, s41
s_mov_b32 m0, 24576
s_nop 0
buffer_load_dwordx4 v9, s[20:23], s50 offen offset:0 lds
buffer_load_dwordx4 v10, s[20:23], s50 offen offset:1024 lds
buffer_load_dwordx4 v11, s[20:23], s50 offen offset:2048 lds
buffer_load_dwordx4 v12, s[20:23], s50 offen offset:3072 lds
s_add_u32 m0, m0, 4096
s_add_u32 s41, s50, 131072
buffer_load_dwordx4 v9, s[20:23], s41 offen offset:0 lds
buffer_load_dwordx4 v10, s[20:23], s41 offen offset:1024 lds
buffer_load_dwordx4 v11, s[20:23], s41 offen offset:2048 lds
buffer_load_dwordx4 v12, s[20:23], s41 offen offset:3072 lds
s_add_u32 s50, s50, 262144
s_cmp_ge_u32 s50, s51
s_cselect_b32 s41, 5242880, 0
s_sub_u32 s50, s50, s41
s_waitcnt vmcnt(36)
s_barrier
s_mov_b32 m0, 53248
s_nop 0
buffer_load_dwordx4 v13, s[8:11], s52 offen offset:0 lds
buffer_load_dwordx4 v14, s[8:11], s52 offen offset:1024 lds
buffer_load_dwordx4 v15, s[8:11], s52 offen offset:2048 lds
buffer_load_dwordx4 v16, s[8:11], s52 offen offset:3072 lds
s_add_u32 m0, m0, 4096
s_add_u32 s41, s52, 40960
buffer_load_dwordx4 v13, s[8:11], s41 offen offset:0 lds
buffer_load_dwordx4 v14, s[8:11], s41 offen offset:1024 lds
s_mov_b32 m0, 32768
s_nop 0
buffer_load_dwordx4 v9, s[20:23], s50 offen offset:0 lds
buffer_load_dwordx4 v10, s[20:23], s50 offen offset:1024 lds
buffer_load_dwordx4 v11, s[20:23], s50 offen offset:2048 lds
buffer_load_dwordx4 v12, s[20:23], s50 offen offset:3072 lds
s_add_u32 m0, m0, 4096
s_add_u32 s41, s50, 131072
buffer_load_dwordx4 v9, s[20:23], s41 offen offset:0 lds
buffer_load_dwordx4 v10, s[20:23], s41 offen offset:1024 lds
buffer_load_dwordx4 v11, s[20:23], s41 offen offset:2048 lds
buffer_load_dwordx4 v12, s[20:23], s41 offen offset:3072 lds
s_add_u32 s50, s50, 262144
s_cmp_ge_u32 s50, s51
s_cselect_b32 s41, 5242880, 0
s_sub_u32 s50, s50, s41
s_mov_b32 m0, 81920
s_call_b64 s[46:47], L_issV
s_waitcnt vmcnt(58)
s_barrier
s_mov_b32 m0, 57344
s_add_u32 s41, s52, 40960
buffer_load_dwordx4 v15, s[8:11], s41 offen offset:2048 lds
buffer_load_dwordx4 v16, s[8:11], s41 offen offset:3072 lds
s_add_u32 m0, m0, 4096
s_add_u32 s41, s52, 81920
buffer_load_dwordx4 v13, s[8:11], s41 offen offset:0 lds
buffer_load_dwordx4 v14, s[8:11], s41 offen offset:1024 lds
buffer_load_dwordx4 v15, s[8:11], s41 offen offset:2048 lds
buffer_load_dwordx4 v16, s[8:11], s41 offen offset:3072 lds
s_add_u32 s52, s52, 128
s_cmp_ge_u32 s52, s53
s_cselect_b32 s41, 1280, 0
s_sub_u32 s52, s52, s41
s_mov_b32 m0, 0
s_nop 0
buffer_load_dwordx4 v9, s[20:23], s50 offen offset:0 lds
buffer_load_dwordx4 v10, s[20:23], s50 offen offset:1024 lds
buffer_load_dwordx4 v11, s[20:23], s50 offen offset:2048 lds
buffer_load_dwordx4 v12, s[20:23], s50 offen offset:3072 lds
s_add_u32 m0, m0, 4096
s_add_u32 s41, s50, 131072
buffer_load_dwordx4 v9, s[20:23], s41 offen offset:0 lds
buffer_load_dwordx4 v10, s[20:23], s41 offen offset:1024 lds
buffer_load_dwordx4 v11, s[20:23], s41 offen offset:2048 lds
buffer_load_dwordx4 v12, s[20:23], s41 offen offset:3072 lds
s_add_u32 s50, s50, 262144
s_cmp_ge_u32 s50, s51
s_cselect_b32 s41, 5242880, 0
s_sub_u32 s50, s50, s41
s_waitcnt vmcnt(52)
s_barrier
s_mov_b32 m0, 65536
s_nop 0
buffer_load_dwordx4 v13, s[8:11], s52 offen offset:0 lds
buffer_load_dwordx4 v14, s[8:11], s52 offen offset:1024 lds
buffer_load_dwordx4 v15, s[8:11], s52 offen offset:2048 lds
buffer_load_dwordx4 v16, s[8:11], s52 offen offset:3072 lds
s_add_u32 m0, m0, 4096
s_add_u32 s41, s52, 40960
buffer_load_dwordx4 v13, s[8:11], s41 offen offset:0 lds
buffer_load_dwordx4 v14, s[8:11], s41 offen offset:1024 lds
s_mov_b32 m0, 8192
s_nop 0
buffer_load_dwordx4 v9, s[20:23], s50 offen offset:0 lds
buffer_load_dwordx4 v10, s[20:23], s50 offen offset:1024 lds
buffer_load_dwordx4 v11, s[20:23], s50 offen offset:2048 lds
buffer_load_dwordx4 v12, s[20:23], s50 offen offset:3072 lds
s_add_u32 m0, m0, 4096
s_add_u32 s41, s50, 131072
buffer_load_dwordx4 v9, s[20:23], s41 offen offset:0 lds
buffer_load_dwordx4 v10, s[20:23], s41 offen offset:1024 lds
buffer_load_dwordx4 v11, s[20:23], s41 offen offset:2048 lds
buffer_load_dwordx4 v12, s[20:23], s41 offen offset:3072 lds
s_add_u32 s50, s50, 262144
s_cmp_ge_u32 s50, s51
s_cselect_b32 s41, 5242880, 0
s_sub_u32 s50, s50, s41
s_waitcnt vmcnt(58)
s_barrier
s_mov_b32 m0, 69632
s_add_u32 s41, s52, 40960
buffer_load_dwordx4 v15, s[8:11], s41 offen offset:2048 lds
buffer_load_dwordx4 v16, s[8:11], s41 offen offset:3072 lds
s_add_u32 m0, m0, 4096
s_add_u32 s41, s52, 81920
buffer_load_dwordx4 v13, s[8:11], s41 offen offset:0 lds
buffer_load_dwordx4 v14, s[8:11], s41 offen offset:1024 lds
buffer_load_dwordx4 v15, s[8:11], s41 offen offset:2048 lds
buffer_load_dwordx4 v16, s[8:11], s41 offen offset:3072 lds
s_add_u32 s52, s52, 128
s_cmp_ge_u32 s52, s53
s_cselect_b32 s41, 1280, 0
s_sub_u32 s52, s52, s41
s_mov_b32 m0, 16384
s_nop 0
buffer_load_dwordx4 v9, s[20:23], s50 offen offset:0 lds
buffer_load_dwordx4 v10, s[20:23], s50 offen offset:1024 lds
buffer_load_dwordx4 v11, s[20:23], s50 offen offset:2048 lds
buffer_load_dwordx4 v12, s[20:23], s50 offen offset:3072 lds
s_add_u32 m0, m0, 4096
s_add_u32 s41, s50, 131072
buffer_load_dwordx4 v9, s[20:23], s41 offen offset:0 lds
buffer_load_dwordx4 v10, s[20:23], s41 offen offset:1024 lds
buffer_load_dwordx4 v11, s[20:23], s41 offen offset:2048 lds
buffer_load_dwordx4 v12, s[20:23], s41 offen offset:3072 lds
s_add_u32 s50, s50, 262144
s_cmp_ge_u32 s50, s51
s_cselect_b32 s41, 5242880, 0
s_sub_u32 s50, s50, s41
s_waitcnt vmcnt(36)
s_barrier
s_mov_b32 m0, 40960
s_nop 0
buffer_load_dwordx4 v13, s[8:11], s52 offen offset:0 lds
buffer_load_dwordx4 v14, s[8:11], s52 offen offset:1024 lds
buffer_load_dwordx4 v15, s[8:11], s52 offen offset:2048 lds
buffer_load_dwordx4 v16, s[8:11], s52 offen offset:3072 lds
s_add_u32 m0, m0, 4096
s_add_u32 s41, s52, 40960
buffer_load_dwordx4 v13, s[8:11], s41 offen offset:0 lds
buffer_load_dwordx4 v14, s[8:11], s41 offen offset:1024 lds
s_mov_b32 m0, 24576
s_nop 0
buffer_load_dwordx4 v9, s[20:23], s50 offen offset:0 lds
buffer_load_dwordx4 v10, s[20:23], s50 offen offset:1024 lds
buffer_load_dwordx4 v11, s[20:23], s50 offen offset:2048 lds
buffer_load_dwordx4 v12, s[20:23], s50 offen offset:3072 lds
s_add_u32 m0, m0, 4096
s_add_u32 s41, s50, 131072
buffer_load_dwordx4 v9, s[20:23], s41 offen offset:0 lds
buffer_load_dwordx4 v10, s[20:23], s41 offen offset:1024 lds
buffer_load_dwordx4 v11, s[20:23], s41 offen offset:2048 lds
buffer_load_dwordx4 v12, s[20:23], s41 offen offset:3072 lds
s_add_u32 s50, s50, 262144
s_cmp_ge_u32 s50, s51
s_cselect_b32 s41, 5242880, 0
s_sub_u32 s50, s50, s41
s_mov_b32 m0, 147456
s_call_b64 s[46:47], L_issK
s_waitcnt vmcnt(58)
s_barrier
s_mov_b32 m0, 45056
s_add_u32 s41, s52, 40960
buffer_load_dwordx4 v15, s[8:11], s41 offen offset:2048 lds
buffer_load_dwordx4 v16, s[8:11], s41 offen offset:3072 lds
s_add_u32 m0, m0, 4096
s_add_u32 s41, s52, 81920
buffer_load_dwordx4 v13, s[8:11], s41 offen offset:0 lds
buffer_load_dwordx4 v14, s[8:11], s41 offen offset:1024 lds
buffer_load_dwordx4 v15, s[8:11], s41 offen offset:2048 lds
buffer_load_dwordx4 v16, s[8:11], s41 offen offset:3072 lds
s_add_u32 s52, s52, 128
s_cmp_ge_u32 s52, s53
s_cselect_b32 s41, 1280, 0
s_sub_u32 s52, s52, s41
s_mov_b32 m0, 32768
s_nop 0
buffer_load_dwordx4 v9, s[20:23], s50 offen offset:0 lds
buffer_load_dwordx4 v10, s[20:23], s50 offen offset:1024 lds
buffer_load_dwordx4 v11, s[20:23], s50 offen offset:2048 lds
buffer_load_dwordx4 v12, s[20:23], s50 offen offset:3072 lds
s_add_u32 m0, m0, 4096
s_add_u32 s41, s50, 131072
buffer_load_dwordx4 v9, s[20:23], s41 offen offset:0 lds
buffer_load_dwordx4 v10, s[20:23], s41 offen offset:1024 lds
buffer_load_dwordx4 v11, s[20:23], s41 offen offset:2048 lds
buffer_load_dwordx4 v12, s[20:23], s41 offen offset:3072 lds
s_add_u32 s50, s50, 262144
s_cmp_ge_u32 s50, s51
s_cselect_b32 s41, 5242880, 0
s_sub_u32 s50, s50, s41
s_waitcnt vmcnt(52)
s_barrier
s_call_b64 s[46:47], L_late_setup
s_waitcnt vmcnt(44)
s_barrier
s_mov_b32 m0, 53248
s_call_b64 s[46:47], L_issX0
s_mov_b32 m0, 57344
s_call_b64 s[46:47], L_issX1
s_mov_b32 m0, 0
s_add_u32 s50, s50, 256
s_add_u32 s51, s51, 256
s_call_b64 s[46:47], L_issW
s_waitcnt vmcnt(28)
s_barrier
s_mov_b32 m0, 8192
s_call_b64 s[46:47], L_issW
s_mov_b32 m0, 98304
s_call_b64 s[46:47], L_issV
s_waitcnt vmcnt(44)
s_barrier
s_mov_b32 m0, 65536
s_call_b64 s[46:47], L_issX0
s_mov_b32 m0, 69632
s_call_b64 s[46:47], L_issX1
s_mov_b32 m0, 16384
s_call_b64 s[46:47], L_issW
s_mov_b32 m0, 24576
s_call_b64 s[46:47], L_issW
s_waitcnt vmcnt(63)
s_barrier
s_mov_b32 m0, 40960
s_call_b64 s[46:47], L_issX0
s_mov_b32 m0, 45056
s_call_b64 s[46:47], L_issX1
s_mov_b32 m0, 32768
s_call_b64 s[46:47], L_issW
buffer_load_dword v28, v23, s[28:31], s44 offen
s_add_u32 s44, s44, 8192
buffer_load_dword v28, v23, s[28:31], s44 offen
s_add_u32 s44, s44, 8192
s_waitcnt vmcnt(63)
s_barrier
s_mov_b32 m0, 114688
s_call_b64 s[46:47], L_issK
buffer_load_dword v28, v23, s[28:31], s44 offen
s_add_u32 s44, s44, 8192
buffer_load_dword v28, v23, s[28:31], s44 offen
s_add_u32 s44, s44, 8192
s_waitcnt vmcnt(63)
s_barrier
s_mov_b32 m0, 0
s_call_b64 s[46:47], L_issW
s_waitcnt vmcnt(48)
s_barrier
s_mov_b32 m0, 53248
s_call_b64 s[46:47], L_issX0
s_mov_b32 m0, 57344
s_call_b64 s[46:47], L_issX1
s_mov_b32 m0, 8192
s_call_b64 s[46:47], L_issW
s_mov_b32 m0, 81920
s_call_b64 s[46:47], L_issV
s_mov_b32 m0, 131072
s_call_b64 s[46:47], L_issK
buffer_load_dword v28, v23, s[28:31], s44 offen
s_add_u32 s44, s44, 8192
s_waitcnt vmcnt(63)
s_barrier
s_load_dwordx4 s[72:75], s[4:5], s45 glc
s_mov_b32 m0, 16384
s_call_b64 s[46:47], L_issW
s_mov_b32 m0, 65536
s_call_b64 s[46:47], L_issX0
s_mov_b32 m0, 69632
s_call_b64 s[46:47], L_issX1
s_mov_b32 m0, 24576
s_call_b64 s[46:47], L_issW
s_waitcnt vmcnt(61)
s_barrier
s_mov_b32 m0, 32768
s_call_b64 s[46:47], L_issW
s_mov_b32 m0, 98304
s_call_b64 s[46:47], L_issV
s_mov_b32 m0, 147456
s_call_b64 s[46:47], L_issK
s_waitcnt vmcnt(60)
s_barrier
s_mov_b32 m0, 40960
s_call_b64 s[46:47], L_issX0
s_mov_b32 m0, 45056
s_call_b64 s[46:47], L_issX1
s_mov_b32 m0, 0
s_call_b64 s[46:47], L_issW
s_mov_b32 m0, 8192
s_call_b64 s[46:47], L_issW
s_waitcnt vmcnt(60)
s_barrier
s_mov_b32 m0, 53248
s_call_b64 s[46:47], L_issX0
s_mov_b32 m0, 57344
s_call_b64 s[46:47], L_issX1
s_mov_b32 m0, 16384
s_call_b64 s[46:47], L_issW
s_mov_b32 m0, 81920
s_call_b64 s[46:47], L_issV
s_mov_b32 m0, 114688
s_call_b64 s[46:47], L_issK
s_waitcnt vmcnt(60)
s_barrier
s_mov_b32 m0, 24576
s_call_b64 s[46:47], L_issW
s_mov_b32 m0, 65536
s_call_b64 s[46:47], L_issX0
s_mov_b32 m0, 69632
s_call_b64 s[46:47], L_issX1
s_mov_b32 m0, 32768
s_call_b64 s[46:47], L_issW
s_waitcnt vmcnt(60)
s_barrier
s_mov_b32 m0, 0
s_call_b64 s[46:47], L_issW
s_mov_b32 m0, 98304
s_call_b64 s[46:47], L_issV
s_mov_b32 m0, 131072
s_call_b64 s[46:47], L_issK
s_waitcnt vmcnt(60)
s_barrier
s_mov_b32 m0, 40960
s_call_b64 s[46:47], L_issX0
s_mov_b32 m0, 45056
s_call_b64 s[46:47], L_issX1
s_mov_b32 m0, 8192
s_call_b64 s[46:47], L_issW
s_mov_b32 m0, 16384
s_call_b64 s[46:47], L_issW
s_waitcnt vmcnt(60)
s_barrier
s_mov_b32 m0, 53248
s_call_b64 s[46:47], L_issX0
s_mov_b32 m0, 57344
s_call_b64 s[46:47], L_issX1
s_mov_b32 m0, 24576
s_call_b64 s[46:47], L_issW
s_mov_b32 m0, 81920
s_call_b64 s[46:47], L_issV
s_mov_b32 m0, 147456
s_add_u32 s54, s54, 0x20000
s_call_b64 s[46:47], L_issK
s_waitcnt vmcnt(60)
s_barrier
s_mov_b32 m0, 32768
s_call_b64 s[46:47], L_issW
s_waitcnt vmcnt(40)
s_barrier
s_mov_b32 m0, 98304
s_call_b64 s[46:47], L_issV
s_mov_b32 m0, 114688
s_call_b64 s[46:47], L_issK
s_waitcnt vmcnt(32)
s_barrier
s_waitcnt lgkmcnt(0)
s_cmp_eq_u32 s72, 1
s_cbranch_scc1 L_cg_1
s_call_b64 s[46:47], L_spinG
L_cg_1:
v_mov_b32 v36, s73
v_mov_b32 v37, s74
v_mov_b32 v38, 77824
ds_write_b64 v38, v[36:37]
s_waitcnt lgkmcnt(0)
s_waitcnt vmcnt(32)
s_barrier
s_mov_b32 m0, 81920
s_add_u32 s55, s55, 0x20000
s_call_b64 s[46:47], L_issV
s_mov_b32 m0, 131072
s_call_b64 s[46:47], L_issK
s_waitcnt vmcnt(48)
s_barrier
s_mov_b32 m0, 0
s_add_u32 s41, s38, 0
s_and_b32 s41, s41, 3
s_mul_i32 s41, s41, 327680
s_add_u32 s56, s57, s41
s_call_b64 s[46:47], L_issO
s_waitcnt vmcnt(42)
s_barrier
s_mov_b32 m0, 10240
s_call_b64 s[46:47], L_issO
s_mov_b32 m0, 98304
s_call_b64 s[46:47], L_issV
s_mov_b32 m0, 147456
s_call_b64 s[46:47], L_issK
s_waitcnt vmcnt(63)
s_barrier
s_mov_b32 m0, 20480
s_call_b64 s[46:47], L_issO
s_waitcnt vmcnt(52)
s_barrier
s_mov_b32 m0, 40960
s_call_b64 s[46:47], L_issO
s_mov_b32 m0, 81920
s_call_b64 s[46:47], L_issV
s_mov_b32 m0, 114688
s_call_b64 s[46:47], L_issK
s_waitcnt vmcnt(63)
s_barrier
s_mov_b32 m0, 30720
s_add_u32 s41, s38, 0
s_and_b32 s41, s41, 3
s_mul_i32 s41, s41, 327680
s_add_u32 s56, s57, s41
s_add_u32 s56, s56, 163840
s_call_b64 s[46:47], L_issO
s_waitcnt vmcnt(62)
s_barrier
s_mov_b32 m0, 51200
s_call_b64 s[46:47], L_issO
s_mov_b32 m0, 98304
s_call_b64 s[46:47], L_issV
s_mov_b32 m0, 131072
s_call_b64 s[46:47], L_issK
s_waitcnt vmcnt(63)
s_barrier
s_mov_b32 m0, 61440
s_call_b64 s[46:47], L_issO
s_waitcnt vmcnt(62)
s_barrier
s_mov_b32 m0, 71680
s_call_b64 s[46:47], L_issO
s_mov_b32 m0, 81920
s_call_b64 s[46:47], L_issV
s_mov_b32 m0, 147456
s_call_b64 s[46:47], L_issK
s_waitcnt vmcnt(63)
s_barrier
s_mov_b32 m0, 0
s_add_u32 s41, s38, 1
s_and_b32 s41, s41, 3
s_mul_i32 s41, s41, 327680
s_add_u32 s56, s57, s41
s_call_b64 s[46:47], L_issO
s_waitcnt vmcnt(62)
s_barrier
s_mov_b32 m0, 10240
s_call_b64 s[46:47], L_issO
s_mov_b32 m0, 98304
s_call_b64 s[46:47], L_issV
s_mov_b32 m0, 114688
s_call_b64 s[46:47], L_issK
s_waitcnt vmcnt(63)
s_barrier
s_mov_b32 m0, 20480
s_call_b64 s[46:47], L_issO
s_waitcnt vmcnt(62)
s_barrier
s_mov_b32 m0, 40960
s_call_b64 s[46:47], L_issO
s_mov_b32 m0, 81920
s_call_b64 s[46:47], L_issV
s_waitcnt vmcnt(52)
s_barrier
s_mov_b32 m0, 153600
s_add_u32 s41, s38, 2
s_and_b32 s41, s41, 3
s_mul_i32 s41, s41, 327680
s_add_u32 s56, s57, s41
s_call_b64 s[46:47], L_issO
s_mov_b32 m0, 131072
s_call_b64 s[46:47], L_issV
s_waitcnt vmcnt(62)
s_barrier
s_add_u32 s42, s49, 32
s_load_dwordx8 s[88:95], s[24:25], s49 glc
s_load_dwordx4 s[72:75], s[24:25], s42 glc
s_waitcnt vmcnt(26)
s_barrier
s_mov_b32 s42, s49
s_mov_b32 s76, 1
s_call_b64 s[46:47], L_chkF
s_waitcnt vmcnt(26)
s_barrier
s_mov_b32 m0, 102400
s_call_b64 s[46:47], L_issO
s_waitcnt vmcnt(10)
s_barrier
s_mov_b32 m0, 112640
s_call_b64 s[46:47], L_issO
s_waitcnt vmcnt(20)
s_barrier
s_mov_b32 m0, 81920
s_call_b64 s[46:47], L_issO
s_waitcnt vmcnt(30)
s_barrier
s_mov_b32 m0, 92160
s_add_u32 s41, s38, 3
s_and_b32 s41, s41, 3
s_mul_i32 s41, s41, 327680
s_add_u32 s56, s57, s41
s_call_b64 s[46:47], L_issO
s_waitcnt vmcnt(40)
s_barrier
s_mov_b32 m0, 30720
s_call_b64 s[46:47], L_issO
s_waitcnt vmcnt(50)
s_barrier
s_mov_b32 m0, 122880
s_call_b64 s[46:47], L_issO
s_waitcnt vmcnt(60)
s_barrier
s_mov_b32 m0, 133120
s_call_b64 s[46:47], L_issO
s_waitcnt vmcnt(63)
s_barrier
s_mov_b32 m0, 143360
s_add_u32 s41, s38, 1
s_and_b32 s41, s41, 3
s_mul_i32 s41, s41, 327680
s_add_u32 s56, s57, s41
s_add_u32 s56, s56, 163840
s_call_b64 s[46:47], L_issO
s_waitcnt vmcnt(63)
s_barrier
s_mov_b32 m0, 51200
s_call_b64 s[46:47], L_issO
s_waitcnt vmcnt(63)
s_barrier
s_mov_b32 m0, 61440
s_call_b64 s[46:47], L_issO
s_waitcnt vmcnt(63)
s_barrier
s_add_u32 s42, s49, 32
s_load_dwordx8 s[88:95], s[24:25], s49 glc
s_load_dwordx4 s[72:75], s[24:25], s42 glc
s_mov_b32 m0, 71680
s_call_b64 s[46:47], L_issO
s_waitcnt vmcnt(63)
s_barrier
s_mov_b32 m0, 0
s_add_u32 s41, s38, 2
s_and_b32 s41, s41, 3
s_mul_i32 s41, s41, 327680
s_add_u32 s56, s57, s41
s_add_u32 s56, s56, 163840
s_call_b64 s[46:47], L_issO
s_waitcnt vmcnt(63)
s_barrier
s_mov_b32 m0, 10240
s_call_b64 s[46:47], L_issO
s_mov_b32 s42, s49
s_mov_b32 s76, 2
s_call_b64 s[46:47], L_chkF
s_waitcnt vmcnt(63)
s_barrier
s_mov_b32 m0, 20480
s_call_b64 s[46:47], L_issO
s_waitcnt vmcnt(63)
s_barrier
s_mov_b32 m0, 40960
s_call_b64 s[46:47], L_issO
s_waitcnt vmcnt(63)
s_barrier
s_mov_b32 m0, 153600
s_add_u32 s41, s38, 3
s_and_b32 s41, s41, 3
s_mul_i32 s41, s41, 327680
s_add_u32 s56, s57, s41
s_add_u32 s56, s56, 163840
s_call_b64 s[46:47], L_issO
s_waitcnt vmcnt(63)
s_barrier
s_mov_b32 m0, 102400
s_call_b64 s[46:47], L_issO
s_waitcnt vmcnt(63)
s_barrier
s_mov_b32 m0, 112640
s_call_b64 s[46:47], L_issO
s_waitcnt vmcnt(63)
s_barrier
s_mov_b32 m0, 81920
s_call_b64 s[46:47], L_issO
s_waitcnt vmcnt(63)
s_barrier
s_waitcnt vmcnt(0)
s_barrier
s_endpgm
L_issK:
s_add_u32 s41, s54, s58
buffer_load_dwordx4 v4, s[12:15], s41 offen offset:0 nt lds
s_add_u32 s58, s58, s60
buffer_load_dwordx4 v5, s[12:15], s41 offen offset:1024 nt lds
s_and_b32 s58, s58, 0x1ffff
buffer_load_dwordx4 v6, s[12:15], s41 offen offset:2048 nt lds
buffer_load_dwordx4 v7, s[12:15], s41 offen offset:3072 nt lds
s_add_u32 m0, m0, 4096
s_add_u32 s41, s54, s58
buffer_load_dwordx4 v4, s[12:15], s41 offen offset:0 nt lds
s_add_u32 s58, s58, s60
buffer_load_dwordx4 v5, s[12:15], s41 offen offset:1024 nt lds
s_and_b32 s58, s58, 0x1ffff
buffer_load_dwordx4 v6, s[12:15], s41 offen offset:2048 nt lds
buffer_load_dwordx4 v7, s[12:15], s41 offen offset:3072 nt lds
s_add_u32 m0, m0, 4096
s_add_u32 s41, s54, s58
buffer_load_dwordx4 v4, s[12:15], s41 offen offset:0 nt lds
s_add_u32 s58, s58, s60
buffer_load_dwordx4 v5, s[12:15], s41 offen offset:1024 nt lds
s_and_b32 s58, s58, 0x1ffff
buffer_load_dwordx4 v6, s[12:15], s41 offen offset:2048 nt lds
buffer_load_dwordx4 v7, s[12:15], s41 offen offset:3072 nt lds
s_add_u32 m0, m0, 4096
s_add_u32 s41, s54, s58
buffer_load_dwordx4 v4, s[12:15], s41 offen offset:0 nt lds
s_add_u32 s58, s58, s60
buffer_load_dwordx4 v5, s[12:15], s41 offen offset:1024 nt lds
s_and_b32 s58, s58, 0x1ffff
buffer_load_dwordx4 v6, s[12:15], s41 offen offset:2048 nt lds
buffer_load_dwordx4 v7, s[12:15], s41 offen offset:3072 nt lds
s_setpc_b64 s[46:47]
L_issV:
s_add_u32 s41, s55, s59
buffer_load_dwordx4 v8, s[16:19], s41 offen offset:0 nt lds
s_add_u32 s59, s59, s60
buffer_load_dwordx4 v8, s[16:19], s41 offen offset:1024 nt lds
s_and_b32 s59, s59, 0x1ffff
buffer_load_dwordx4 v8, s[16:19], s41 offen offset:2048 nt lds
buffer_load_dwordx4 v8, s[16:19], s41 offen offset:3072 nt lds
s_add_u32 m0, m0, 4096
s_add_u32 s41, s55, s59
buffer_load_dwordx4 v8, s[16:19], s41 offen offset:0 nt lds
s_add_u32 s59, s59, s60
buffer_load_dwordx4 v8, s[16:19], s41 offen offset:1024 nt lds
s_and_b32 s59, s59, 0x1ffff
buffer_load_dwordx4 v8, s[16:19], s41 offen offset:2048 nt lds
buffer_load_dwordx4 v8, s[16:19], s41 offen offset:3072 nt lds
s_add_u32 m0, m0, 4096
s_add_u32 s41, s55, s59
buffer_load_dwordx4 v8, s[16:19], s41 offen offset:0 nt lds
s_add_u32 s59, s59, s60
buffer_load_dwordx4 v8, s[16:19], s41 offen offset:1024 nt lds
s_and_b32 s59, s59, 0x1ffff
buffer_load_dwordx4 v8, s[16:19], s41 offen offset:2048 nt lds
buffer_load_dwordx4 v8, s[16:19], s41 offen offset:3072 nt lds
s_add_u32 m0, m0, 4096
s_add_u32 s41, s55, s59
buffer_load_dwordx4 v8, s[16:19], s41 offen offset:0 nt lds
s_add_u32 s59, s59, s60
buffer_load_dwordx4 v8, s[16:19], s41 offen offset:1024 nt lds
s_and_b32 s59, s59, 0x1ffff
buffer_load_dwordx4 v8, s[16:19], s41 offen offset:2048 nt lds
buffer_load_dwordx4 v8, s[16:19], s41 offen offset:3072 nt lds
s_setpc_b64 s[46:47]
L_late_setup:
s_and_b32 s25, s25, 0xffff
s_mov_b32 s26, 268435456
s_mov_b32 s27, 0x20000
s_and_b32 s29, s29, 0xffff
s_mov_b32 s30, 5242880
s_mov_b32 s31, 0x20000
s_and_b32 s5, s5, 0xffff
s_mov_b32 s6, 256
s_mov_b32 s7, 0x20000
v_add_u32 v1, 0, v0
v_mul_u32_u24 v2, 3277, v1
v_lshrrev_b32 v2, 16, v2
v_mul_u32_u24 v3, 20, v2
v_sub_u32 v3, v1, v3
v_mul_u32_u24 v2, 1280, v2
v_lshl_add_u32 v2, v3, 4, v2
v_subrev_u32 v17, 0, v2
v_add_u32 v1, 64, v0
v_mul_u32_u24 v2, 3277, v1
v_lshrrev_b32 v2, 16, v2
v_mul_u32_u24 v3, 20, v2
v_sub_u32 v3, v1, v3
v_mul_u32_u24 v2, 1280, v2
v_lshl_add_u32 v2, v3, 4, v2
v_subrev_u32 v18, 1024, v2
v_add_u32 v1, 128, v0
v_mul_u32_u24 v2, 3277, v1
v_lshrrev_b32 v2, 16, v2
v_mul_u32_u24 v3, 20, v2
v_sub_u32 v3, v1, v3
v_mul_u32_u24 v2, 1280, v2
v_lshl_add_u32 v2, v3, 4, v2
v_subrev_u32 v19, 2048, v2
v_add_u32 v1, 192, v0
v_mul_u32_u24 v2, 3277, v1
v_lshrrev_b32 v2, 16, v2
v_mul_u32_u24 v3, 20, v2
v_sub_u32 v3, v1, v3
v_mul_u32_u24 v2, 1280, v2
v_lshl_add_u32 v2, v3, 4, v2
v_subrev_u32 v20, 3072, v2
v_add_u32 v1, 256, v0
v_mul_u32_u24 v2, 3277, v1
v_lshrrev_b32 v2, 16, v2
v_mul_u32_u24 v3, 20, v2
v_sub_u32 v3, v1, v3
v_mul_u32_u24 v2, 1280, v2
v_lshl_add_u32 v2, v3, 4, v2
v_subrev_u32 v21, 0, v2
v_mov_b32 v26, 0
s_getpc_b64 s[96:97]
L_pc2:
s_add_u32 s96, s96, L_awave-L_pc2
s_addc_u32 s97, s97, 0
s_mov_b32 s98, L_exit-L_awave
v_lshlrev_b32 v23, 7, v0
s_mov_b32 s48, 1
s_mul_i32 s57, s39, 1310720
s_lshr_b32 s44, s2, 3
s_mul_i32 s44, s44, 40960
s_add_u32 s44, s44, s57
s_mul_i32 s41, s38, 320
s_add_u32 s57, s57, s41
s_mul_i32 s41, s38, 327680
s_add_u32 s56, s57, s41
s_lshl_b32 s41, s45, 2
s_add_u32 s49, s41, s39
s_lshl_b32 s49, s49, 7
s_add_u32 s49, s49, 33554432
s_add_u32 s63, s41, s38
s_lshl_b32 s63, s63, 7
s_add_u32 s63, s63, 33619968
v_min_u32 v27, 11, v0
v_lshlrev_b32 v27, 2, v27
s_lshl_b32 s45, s45, 4
v_lshrrev_b32 v2, 3, v0
v_lshlrev_b32 v2, 13, v2
v_bfe_u32 v1, v0, 1, 2
v_lshl_add_u32 v2, v1, 9, v2
v_and_b32 v1, 1, v0
v_lshl_add_u32 v2, v1, 7, v2
s_lshr_b32 s43, s2, 3
s_mul_i32 s43, s43, 163840
s_lshl_b32 s41, s39, 11
s_add_u32 s43, s43, s41
s_add_u32 s43, s43, 256
s_setpc_b64 s[46:47]
L_issW:
buffer_load_dwordx4 v9, s[20:23], s50 offen offset:0 lds
buffer_load_dwordx4 v10, s[20:23], s50 offen offset:1024 lds
buffer_load_dwordx4 v11, s[20:23], s50 offen offset:2048 lds
buffer_load_dwordx4 v12, s[20:23], s50 offen offset:3072 lds
s_add_u32 m0, m0, 4096
s_add_u32 s41, s50, 131072
buffer_load_dwordx4 v9, s[20:23], s41 offen offset:0 lds
buffer_load_dwordx4 v10, s[20:23], s41 offen offset:1024 lds
buffer_load_dwordx4 v11, s[20:23], s41 offen offset:2048 lds
buffer_load_dwordx4 v12, s[20:23], s41 offen offset:3072 lds
s_add_u32 s50, s50, 262144
s_cmp_ge_u32 s50, s51
s_cselect_b32 s41, 5242880, 0
s_sub_u32 s50, s50, s41
s_setpc_b64 s[46:47]
L_issX0:
buffer_load_dwordx4 v13, s[8:11], s52 offen offset:0 lds
buffer_load_dwordx4 v14, s[8:11], s52 offen offset:1024 lds
buffer_load_dwordx4 v15, s[8:11], s52 offen offset:2048 lds
buffer_load_dwordx4 v16, s[8:11], s52 offen offset:3072 lds
s_add_u32 m0, m0, 4096
s_add_u32 s41, s52, 40960
buffer_load_dwordx4 v13, s[8:11], s41 offen offset:0 lds
buffer_load_dwordx4 v14, s[8:11], s41 offen offset:1024 lds
s_setpc_b64 s[46:47]
L_issX1:
s_add_u32 s41, s52, 40960
buffer_load_dwordx4 v15, s[8:11], s41 offen offset:2048 lds
buffer_load_dwordx4 v16, s[8:11], s41 offen offset:3072 lds
s_add_u32 m0, m0, 4096
s_add_u32 s41, s52, 81920
buffer_load_dwordx4 v13, s[8:11], s41 offen offset:0 lds
buffer_load_dwordx4 v14, s[8:11], s41 offen offset:1024 lds
buffer_load_dwordx4 v15, s[8:11], s41 offen offset:2048 lds
buffer_load_dwordx4 v16, s[8:11], s41 offen offset:3072 lds
s_add_u32 s52, s52, 128
s_cmp_ge_u32 s52, s53
s_cselect_b32 s41, 1280, 0
s_sub_u32 s52, s52, s41
s_setpc_b64 s[46:47]
L_issO:
buffer_load_dwordx4 v17, s[28:31], s56 offen offset:0 lds
buffer_load_dwordx4 v18, s[28:31], s56 offen offset:1024 lds
buffer_load_dwordx4 v19, s[28:31], s56 offen offset:2048 lds
buffer_load_dwordx4 v20, s[28:31], s56 offen offset:3072 lds
s_add_u32 m0, m0, 4096
s_nop 0
buffer_load_dwordx4 v21, s[28:31], s56 offen lds
s_add_u32 m0, m0, 1024
s_add_u32 s41, s56, 20480
buffer_load_dwordx4 v17, s[28:31], s41 offen offset:0 lds
buffer_load_dwordx4 v18, s[28:31], s41 offen offset:1024 lds
buffer_load_dwordx4 v19, s[28:31], s41 offen offset:2048 lds
buffer_load_dwordx4 v20, s[28:31], s41 offen offset:3072 lds
s_add_u32 m0, m0, 4096
s_nop 0
buffer_load_dwordx4 v21, s[28:31], s41 offen lds
s_add_u32 s56, s56, 40960
s_setpc_b64 s[46:47]
L_spinG:
s_mov_b32 s41, 0
L_spinlG:
buffer_load_dwordx4 v[36:39], v26, s[4:7], s45 offen sc1
s_add_u32 s41, s41, 1
s_cmp_ge_u32 s41, 65536
s_cbranch_scc1 L_spindG
s_waitcnt vmcnt(0)
v_cmp_ne_u32 vcc, s48, v36
s_cbranch_vccnz L_spinlG
L_spindG:
s_waitcnt vmcnt(0)
v_readfirstlane_b32 s73, v37
v_readfirstlane_b32 s74, v38
s_nop 1
s_setpc_b64 s[46:47]
L_chkF:
s_mov_b32 s77, 0
L_chklF:
s_waitcnt lgkmcnt(0)
s_min_u32 s72, s72, s73
s_min_u32 s72, s72, s74
s_min_u32 s72, s72, s75
s_min_u32 s72, s72, s88
s_min_u32 s72, s72, s89
s_min_u32 s72, s72, s90
s_min_u32 s72, s72, s91
s_min_u32 s72, s72, s92
s_min_u32 s72, s72, s93
s_min_u32 s72, s72, s94
s_min_u32 s72, s72, s95
s_cmp_ge_u32 s72, s76
s_cbranch_scc1 L_retF
s_add_u32 s77, s77, 1
s_cmp_ge_u32 s77, 64
s_cbranch_scc1 L_spinF
s_add_u32 s41, s42, 32
s_load_dwordx8 s[88:95], s[24:25], s42 glc
s_load_dwordx4 s[72:75], s[24:25], s41 glc
s_branch L_chklF
L_spinF:
s_mov_b32 s41, 0
L_spinlF:
buffer_load_dword v25, v27, s[24:27], s42 offen sc1
s_add_u32 s41, s41, 1
s_cmp_ge_u32 s41, 65536
s_cbranch_scc1 L_spindF
s_waitcnt vmcnt(0)
v_cmp_gt_u32 vcc, s76, v25
s_cbranch_vccnz L_spinlF
L_spindF:
s_waitcnt vmcnt(0)
L_retF:
s_setpc_b64 s[46:47]
L_awave:
v_and_b32 v0, 63, v0
v_mov_b32 v22, 0
s_lshl_b32 s41, s45, 2
s_add_u32 s49, s41, s39
s_lshl_b32 s49, s49, 7
s_add_u32 s63, s41, s38
s_lshl_b32 s63, s63, 7
s_lshl_b32 s41, s36, 4
s_lshl_b32 s44, s38, 2
s_add_u32 s44, s44, s41
s_add_u32 s49, s49, s44
s_add_u32 s49, s49, 33554432
s_lshl_b32 s44, s39, 2
s_add_u32 s44, s44, s41
s_add_u32 s63, s63, s44
s_add_u32 s63, s63, 33619968
s_waitcnt lgkmcnt(0)
s_and_b32 s25, s25, 0xffff
s_mov_b32 s26, 268435456
s_mov_b32 s27, 0x20000
s_and_b32 s33, s33, 0xffff
s_mov_b32 s34, 1966080
s_mov_b32 s35, 0x20000
s_and_b32 s5, s5, 0xffff
s_mov_b32 s6, 256
s_mov_b32 s7, 0x20000
s_or_b32 s59, s39, s38
s_or_b32 s59, s59, s36
s_cmp_lg_u32 s59, 0
s_cbranch_scc1 L_noclr
s_memrealtime s[60:61]
v_lshlrev_b32 v64, 3, v0
v_mov_b32 v66, 0
v_mov_b32 v67, 0
buffer_store_dwordx2 v[66:67], v64, s[24:27], s49 offen sc1
L_noclr:
s_lshl_b32 s41, s40, 8
s_add_u32 s41, s41, s43
s_mul_i32 s50, s41, 24576
s_lshl_b32 s41, s36, 11
s_add_u32 s50, s50, s41
s_mul_i32 s41, s38, 49152
s_sub_u32 s55, s50, s41
s_lshl_b32 s41, s45, 2
s_add_u32 s41, s41, s38
s_mul_i32 s56, s41, 122880
s_mul_i32 s41, s36, 10240
s_add_u32 s56, s56, s41
s_add_u32 s56, s56, 16777216
s_mul_i32 s41, s39, 30720
s_add_u32 s54, s56, s41
s_lshl_b32 s41, s39, 7
s_add_u32 s56, s56, s41
s_mul_i32 s57, s37, 96
s_lshl_b32 s41, s36, 5
s_add_u32 s57, s57, s41
s_lshl_b32 s41, s39, 3
s_add_u32 s57, s57, s41
s_mul_i32 s57, s57, 2560
s_mul_i32 s41, s40, 1280
s_add_u32 s57, s57, s41
s_mul_i32 s41, s38, 320
s_add_u32 s57, s57, s41
s_mov_b32 s58, 0xffff0000
s_mov_b32 s51, 1090519040
s_mov_b32 s52, 1040356334
s_mov_b32 s53, 1040356334
v_mov_b32 v24, 0
v_mov_b32 v25, 0
v_lshlrev_b32 v23, 4, v0
v_and_b32 v64, 31, v0
v_lshrrev_b32 v65, 5, v0
v_and_b32 v66, 15, v64
v_xor_b32 v66, v66, v65
v_lshlrev_b32 v66, 4, v66
v_lshl_add_u32 v66, v64, 8, v66
v_add_u32 v66, 114688, v66
v_xor_b32 v1, 0, v66
v_xor_b32 v2, 32, v66
v_xor_b32 v3, 64, v66
v_xor_b32 v4, 96, v66
v_xor_b32 v5, 128, v66
v_xor_b32 v6, 160, v66
v_xor_b32 v7, 192, v66
v_xor_b32 v8, 224, v66
v_bfe_u32 v66, v64, 1, 3
v_xor_b32 v66, v66, v65
v_lshlrev_b32 v66, 4, v66
v_lshl_add_u32 v66, v64, 7, v66
s_lshl_b32 s41, s36, 12
s_add_u32 s41, s41, 40960
v_add_u32 v66, s41, v66
v_xor_b32 v17, 0, v66
v_xor_b32 v18, 32, v66
v_xor_b32 v19, 64, v66
v_xor_b32 v20, 96, v66
v_bfe_u32 v67, v0, 2, 2
v_and_b32 v68, 1, v0
v_lshlrev_b32 v68, 4, v68
v_bfe_u32 v69, v0, 1, 1
v_lshl_add_u32 v68, v69, 3, v68
v_bfe_u32 v69, v0, 4, 1
v_lshl_add_u32 v68, v69, 5, v68
v_lshl_add_u32 v69, v65, 2, v67
v_lshl_add_u32 v69, v69, 8, v68
v_lshl_add_u32 v69, v67, 6, v69
v_add_u32 v69, 81920, v69
v_xor_b32 v9, 0, v69
v_xor_b32 v10, 64, v69
v_xor_b32 v11, 128, v69
v_xor_b32 v12, 192, v69
v_lshl_add_u32 v70, v65, 3, v67
v_lshl_add_u32 v69, v70, 8, v68
v_lshl_add_u32 v69, v67, 6, v69
v_xor_b32 v13, 0, v69
v_xor_b32 v14, 64, v69
v_xor_b32 v15, 128, v69
v_xor_b32 v16, 192, v69
v_mul_u32_u24 v70, 320, v70
v_add_u32 v21, v70, v68
s_barrier
ds_read_b128 v[224:227], v17 offset:0
ds_read_b64_tr_b16 v[192:193], v13 offset:0
ds_read_b64_tr_b16 v[194:195], v13 offset:1024
ds_read_b64_tr_b16 v[196:197], v14 offset:0
ds_read_b64_tr_b16 v[198:199], v14 offset:1024
ds_read_b64_tr_b16 v[200:201], v15 offset:0
ds_read_b64_tr_b16 v[202:203], v15 offset:1024
ds_read_b64_tr_b16 v[204:205], v16 offset:0
ds_read_b64_tr_b16 v[206:207], v16 offset:1024
ds_read_b128 v[228:231], v18 offset:0
ds_read_b64_tr_b16 v[208:209], v13 offset:4096
ds_read_b64_tr_b16 v[210:211], v13 offset:5120
ds_read_b64_tr_b16 v[212:213], v14 offset:4096
ds_read_b64_tr_b16 v[214:215], v14 offset:5120
ds_read_b64_tr_b16 v[216:217], v15 offset:4096
ds_read_b64_tr_b16 v[218:219], v15 offset:5120
ds_read_b64_tr_b16 v[220:221], v16 offset:4096
ds_read_b64_tr_b16 v[222:223], v16 offset:5120
s_waitcnt lgkmcnt(0)
s_barrier
v_mfma_f32_32x32x16_bf16 v[128:143], v[192:195], v[224:227], 0
ds_read_b128 v[232:235], v19 offset:0
ds_read_b64_tr_b16 a[96:97], v13 offset:8192
ds_read_b64_tr_b16 a[98:99], v13 offset:9216
v_mfma_f32_32x32x16_bf16 v[144:159], v[196:199], v[224:227], 0
ds_read_b64_tr_b16 a[100:101], v14 offset:8192
ds_read_b64_tr_b16 a[102:103], v14 offset:9216
ds_read_b64_tr_b16 a[104:105], v15 offset:8192
v_mfma_f32_32x32x16_bf16 v[160:175], v[200:203], v[224:227], 0
ds_read_b64_tr_b16 a[106:107], v15 offset:9216
ds_read_b64_tr_b16 a[108:109], v16 offset:8192
ds_read_b64_tr_b16 a[110:111], v16 offset:9216
v_mfma_f32_32x32x16_bf16 v[176:191], v[204:207], v[224:227], 0
ds_read_b128 v[236:239], v20 offset:0
ds_read_b64_tr_b16 a[112:113], v13 offset:12288
ds_read_b64_tr_b16 a[114:115], v13 offset:13312
v_mfma_f32_32x32x16_bf16 v[128:143], v[208:211], v[228:231], v[128:143]
ds_read_b64_tr_b16 a[116:117], v14 offset:12288
ds_read_b64_tr_b16 a[118:119], v14 offset:13312
ds_read_b64_tr_b16 a[120:121], v15 offset:12288
v_mfma_f32_32x32x16_bf16 v[144:159], v[212:215], v[228:231], v[144:159]
ds_read_b64_tr_b16 a[122:123], v15 offset:13312
ds_read_b64_tr_b16 a[124:125], v16 offset:12288
ds_read_b64_tr_b16 a[126:127], v16 offset:13312
v_mfma_f32_32x32x16_bf16 v[160:175], v[216:219], v[228:231], v[160:175]
v_mfma_f32_32x32x16_bf16 v[176:191], v[220:223], v[228:231], v[176:191]
s_waitcnt lgkmcnt(0)
s_barrier
v_mfma_f32_32x32x16_bf16 v[128:143], a[96:99], v[232:235], v[128:143]
ds_read_b128 v[224:227], v17 offset:12288
ds_read_b64_tr_b16 v[192:193], v13 offset:16384
ds_read_b64_tr_b16 v[194:195], v13 offset:17408
v_mfma_f32_32x32x16_bf16 v[144:159], a[100:103], v[232:235], v[144:159]
ds_read_b64_tr_b16 v[196:197], v14 offset:16384
ds_read_b64_tr_b16 v[198:199], v14 offset:17408
ds_read_b64_tr_b16 v[200:201], v15 offset:16384
v_mfma_f32_32x32x16_bf16 v[160:175], a[104:107], v[232:235], v[160:175]
ds_read_b64_tr_b16 v[202:203], v15 offset:17408
ds_read_b64_tr_b16 v[204:205], v16 offset:16384
ds_read_b64_tr_b16 v[206:207], v16 offset:17408
v_mfma_f32_32x32x16_bf16 v[176:191], a[108:111], v[232:235], v[176:191]
ds_read_b128 v[228:231], v18 offset:12288
ds_read_b64_tr_b16 v[208:209], v13 offset:20480
ds_read_b64_tr_b16 v[210:211], v13 offset:21504
v_mfma_f32_32x32x16_bf16 v[128:143], a[112:115], v[236:239], v[128:143]
ds_read_b64_tr_b16 v[212:213], v14 offset:20480
ds_read_b64_tr_b16 v[214:215], v14 offset:21504
ds_read_b64_tr_b16 v[216:217], v15 offset:20480
v_mfma_f32_32x32x16_bf16 v[144:159], a[116:119], v[236:239], v[144:159]
ds_read_b64_tr_b16 v[218:219], v15 offset:21504
ds_read_b64_tr_b16 v[220:221], v16 offset:20480
ds_read_b64_tr_b16 v[222:223], v16 offset:21504
v_mfma_f32_32x32x16_bf16 v[160:175], a[120:123], v[236:239], v[160:175]
v_mfma_f32_32x32x16_bf16 v[176:191], a[124:127], v[236:239], v[176:191]
s_waitcnt lgkmcnt(0)
s_barrier
v_mfma_f32_32x32x16_bf16 v[128:143], v[192:195], v[224:227], v[128:143]
ds_read_b128 v[232:235], v19 offset:12288
ds_read_b64_tr_b16 a[96:97], v13 offset:24576
ds_read_b64_tr_b16 a[98:99], v13 offset:25600
v_mfma_f32_32x32x16_bf16 v[144:159], v[196:199], v[224:227], v[144:159]
ds_read_b64_tr_b16 a[100:101], v14 offset:24576
ds_read_b64_tr_b16 a[102:103], v14 offset:25600
ds_read_b64_tr_b16 a[104:105], v15 offset:24576
v_mfma_f32_32x32x16_bf16 v[160:175], v[200:203], v[224:227], v[160:175]
ds_read_b64_tr_b16 a[106:107], v15 offset:25600
ds_read_b64_tr_b16 a[108:109], v16 offset:24576
ds_read_b64_tr_b16 a[110:111], v16 offset:25600
v_mfma_f32_32x32x16_bf16 v[176:191], v[204:207], v[224:227], v[176:191]
ds_read_b128 v[236:239], v20 offset:12288
ds_read_b64_tr_b16 a[112:113], v13 offset:28672
ds_read_b64_tr_b16 a[114:115], v13 offset:29696
v_mfma_f32_32x32x16_bf16 v[128:143], v[208:211], v[228:231], v[128:143]
ds_read_b64_tr_b16 a[116:117], v14 offset:28672
ds_read_b64_tr_b16 a[118:119], v14 offset:29696
ds_read_b64_tr_b16 a[120:121], v15 offset:28672
v_mfma_f32_32x32x16_bf16 v[144:159], v[212:215], v[228:231], v[144:159]
ds_read_b64_tr_b16 a[122:123], v15 offset:29696
ds_read_b64_tr_b16 a[124:125], v16 offset:28672
ds_read_b64_tr_b16 a[126:127], v16 offset:29696
v_mfma_f32_32x32x16_bf16 v[160:175], v[216:219], v[228:231], v[160:175]
v_mfma_f32_32x32x16_bf16 v[176:191], v[220:223], v[228:231], v[176:191]
s_waitcnt lgkmcnt(0)
s_barrier
v_mfma_f32_32x32x16_bf16 v[128:143], a[96:99], v[232:235], v[128:143]
ds_read_b128 v[224:227], v17 offset:24576
ds_read_b64_tr_b16 v[192:193], v13 offset:32768
ds_read_b64_tr_b16 v[194:195], v13 offset:33792
v_mfma_f32_32x32x16_bf16 v[144:159], a[100:103], v[232:235], v[144:159]
ds_read_b64_tr_b16 v[196:197], v14 offset:32768
ds_read_b64_tr_b16 v[198:199], v14 offset:33792
ds_read_b64_tr_b16 v[200:201], v15 offset:32768
v_mfma_f32_32x32x16_bf16 v[160:175], a[104:107], v[232:235], v[160:175]
ds_read_b64_tr_b16 v[202:203], v15 offset:33792
ds_read_b64_tr_b16 v[204:205], v16 offset:32768
ds_read_b64_tr_b16 v[206:207], v16 offset:33792
v_mfma_f32_32x32x16_bf16 v[176:191], a[108:111], v[232:235], v[176:191]
ds_read_b128 v[228:231], v18 offset:24576
ds_read_b64_tr_b16 v[208:209], v13 offset:36864
ds_read_b64_tr_b16 v[210:211], v13 offset:37888
v_mfma_f32_32x32x16_bf16 v[128:143], a[112:115], v[236:239], v[128:143]
ds_read_b64_tr_b16 v[212:213], v14 offset:36864
ds_read_b64_tr_b16 v[214:215], v14 offset:37888
ds_read_b64_tr_b16 v[216:217], v15 offset:36864
v_mfma_f32_32x32x16_bf16 v[144:159], a[116:119], v[236:239], v[144:159]
ds_read_b64_tr_b16 v[218:219], v15 offset:37888
ds_read_b64_tr_b16 v[220:221], v16 offset:36864
ds_read_b64_tr_b16 v[222:223], v16 offset:37888
v_mfma_f32_32x32x16_bf16 v[160:175], a[120:123], v[236:239], v[160:175]
v_mfma_f32_32x32x16_bf16 v[176:191], a[124:127], v[236:239], v[176:191]
s_waitcnt lgkmcnt(0)
s_barrier
v_mfma_f32_32x32x16_bf16 v[128:143], v[192:195], v[224:227], v[128:143]
ds_read_b128 v[232:235], v19 offset:24576
ds_read_b64_tr_b16 a[96:97], v13 offset:0
ds_read_b64_tr_b16 a[98:99], v13 offset:1024
v_mfma_f32_32x32x16_bf16 v[144:159], v[196:199], v[224:227], v[144:159]
ds_read_b64_tr_b16 a[100:101], v14 offset:0
ds_read_b64_tr_b16 a[102:103], v14 offset:1024
ds_read_b64_tr_b16 a[104:105], v15 offset:0
v_mfma_f32_32x32x16_bf16 v[160:175], v[200:203], v[224:227], v[160:175]
ds_read_b64_tr_b16 a[106:107], v15 offset:1024
ds_read_b64_tr_b16 a[108:109], v16 offset:0
ds_read_b64_tr_b16 a[110:111], v16 offset:1024
v_mfma_f32_32x32x16_bf16 v[176:191], v[204:207], v[224:227], v[176:191]
ds_read_b128 v[236:239], v20 offset:24576
ds_read_b64_tr_b16 a[112:113], v13 offset:4096
ds_read_b64_tr_b16 a[114:115], v13 offset:5120
v_mfma_f32_32x32x16_bf16 v[128:143], v[208:211], v[228:231], v[128:143]
ds_read_b64_tr_b16 a[116:117], v14 offset:4096
ds_read_b64_tr_b16 a[118:119], v14 offset:5120
ds_read_b64_tr_b16 a[120:121], v15 offset:4096
v_mfma_f32_32x32x16_bf16 v[144:159], v[212:215], v[228:231], v[144:159]
ds_read_b64_tr_b16 a[122:123], v15 offset:5120
ds_read_b64_tr_b16 a[124:125], v16 offset:4096
ds_read_b64_tr_b16 a[126:127], v16 offset:5120
v_mfma_f32_32x32x16_bf16 v[160:175], v[216:219], v[228:231], v[160:175]
v_mfma_f32_32x32x16_bf16 v[176:191], v[220:223], v[228:231], v[176:191]
s_waitcnt lgkmcnt(0)
s_barrier
v_mfma_f32_32x32x16_bf16 v[128:143], a[96:99], v[232:235], v[128:143]
ds_read_b128 v[224:227], v17 offset:0
ds_read_b64_tr_b16 v[192:193], v13 offset:8192
ds_read_b64_tr_b16 v[194:195], v13 offset:9216
v_mfma_f32_32x32x16_bf16 v[144:159], a[100:103], v[232:235], v[144:159]
ds_read_b64_tr_b16 v[196:197], v14 offset:8192
ds_read_b64_tr_b16 v[198:199], v14 offset:9216
ds_read_b64_tr_b16 v[200:201], v15 offset:8192
v_mfma_f32_32x32x16_bf16 v[160:175], a[104:107], v[232:235], v[160:175]
ds_read_b64_tr_b16 v[202:203], v15 offset:9216
ds_read_b64_tr_b16 v[204:205], v16 offset:8192
ds_read_b64_tr_b16 v[206:207], v16 offset:9216
v_mfma_f32_32x32x16_bf16 v[176:191], a[108:111], v[232:235], v[176:191]
ds_read_b128 v[228:231], v18 offset:0
ds_read_b64_tr_b16 v[208:209], v13 offset:12288
ds_read_b64_tr_b16 v[210:211], v13 offset:13312
v_mfma_f32_32x32x16_bf16 v[128:143], a[112:115], v[236:239], v[128:143]
ds_read_b64_tr_b16 v[212:213], v14 offset:12288
ds_read_b64_tr_b16 v[214:215], v14 offset:13312
ds_read_b64_tr_b16 v[216:217], v15 offset:12288
v_mfma_f32_32x32x16_bf16 v[144:159], a[116:119], v[236:239], v[144:159]
ds_read_b64_tr_b16 v[218:219], v15 offset:13312
ds_read_b64_tr_b16 v[220:221], v16 offset:12288
ds_read_b64_tr_b16 v[222:223], v16 offset:13312
v_mfma_f32_32x32x16_bf16 v[160:175], a[120:123], v[236:239], v[160:175]
v_mfma_f32_32x32x16_bf16 v[176:191], a[124:127], v[236:239], v[176:191]
s_waitcnt lgkmcnt(0)
s_barrier
v_mfma_f32_32x32x16_bf16 v[128:143], v[192:195], v[224:227], v[128:143]
ds_read_b128 v[232:235], v19 offset:0
ds_read_b64_tr_b16 a[96:97], v13 offset:16384
ds_read_b64_tr_b16 a[98:99], v13 offset:17408
v_mfma_f32_32x32x16_bf16 v[144:159], v[196:199], v[224:227], v[144:159]
ds_read_b64_tr_b16 a[100:101], v14 offset:16384
ds_read_b64_tr_b16 a[102:103], v14 offset:17408
ds_read_b64_tr_b16 a[104:105], v15 offset:16384
v_mfma_f32_32x32x16_bf16 v[160:175], v[200:203], v[224:227], v[160:175]
ds_read_b64_tr_b16 a[106:107], v15 offset:17408
ds_read_b64_tr_b16 a[108:109], v16 offset:16384
ds_read_b64_tr_b16 a[110:111], v16 offset:17408
v_mfma_f32_32x32x16_bf16 v[176:191], v[204:207], v[224:227], v[176:191]
ds_read_b128 v[236:239], v20 offset:0
ds_read_b64_tr_b16 a[112:113], v13 offset:20480
ds_read_b64_tr_b16 a[114:115], v13 offset:21504
v_mfma_f32_32x32x16_bf16 v[128:143], v[208:211], v[228:231], v[128:143]
ds_read_b64_tr_b16 a[116:117], v14 offset:20480
ds_read_b64_tr_b16 a[118:119], v14 offset:21504
ds_read_b64_tr_b16 a[120:121], v15 offset:20480
v_mfma_f32_32x32x16_bf16 v[144:159], v[212:215], v[228:231], v[144:159]
ds_read_b64_tr_b16 a[122:123], v15 offset:21504
ds_read_b64_tr_b16 a[124:125], v16 offset:20480
ds_read_b64_tr_b16 a[126:127], v16 offset:21504
v_mfma_f32_32x32x16_bf16 v[160:175], v[216:219], v[228:231], v[160:175]
v_mfma_f32_32x32x16_bf16 v[176:191], v[220:223], v[228:231], v[176:191]
s_waitcnt lgkmcnt(0)
s_barrier
v_mfma_f32_32x32x16_bf16 v[128:143], a[96:99], v[232:235], v[128:143]
ds_read_b128 v[224:227], v17 offset:12288
ds_read_b64_tr_b16 v[192:193], v13 offset:24576
ds_read_b64_tr_b16 v[194:195], v13 offset:25600
v_mfma_f32_32x32x16_bf16 v[144:159], a[100:103], v[232:235], v[144:159]
ds_read_b64_tr_b16 v[196:197], v14 offset:24576
ds_read_b64_tr_b16 v[198:199], v14 offset:25600
ds_read_b64_tr_b16 v[200:201], v15 offset:24576
v_mfma_f32_32x32x16_bf16 v[160:175], a[104:107], v[232:235], v[160:175]
ds_read_b64_tr_b16 v[202:203], v15 offset:25600
ds_read_b64_tr_b16 v[204:205], v16 offset:24576
ds_read_b64_tr_b16 v[206:207], v16 offset:25600
v_mfma_f32_32x32x16_bf16 v[176:191], a[108:111], v[232:235], v[176:191]
ds_read_b128 v[228:231], v18 offset:12288
ds_read_b64_tr_b16 v[208:209], v13 offset:28672
ds_read_b64_tr_b16 v[210:211], v13 offset:29696
v_mfma_f32_32x32x16_bf16 v[128:143], a[112:115], v[236:239], v[128:143]
ds_read_b64_tr_b16 v[212:213], v14 offset:28672
ds_read_b64_tr_b16 v[214:215], v14 offset:29696
ds_read_b64_tr_b16 v[216:217], v15 offset:28672
v_mfma_f32_32x32x16_bf16 v[144:159], a[116:119], v[236:239], v[144:159]
ds_read_b64_tr_b16 v[218:219], v15 offset:29696
ds_read_b64_tr_b16 v[220:221], v16 offset:28672
ds_read_b64_tr_b16 v[222:223], v16 offset:29696
v_mfma_f32_32x32x16_bf16 v[160:175], a[120:123], v[236:239], v[160:175]
v_mfma_f32_32x32x16_bf16 v[176:191], a[124:127], v[236:239], v[176:191]
s_waitcnt lgkmcnt(0)
s_barrier
v_mfma_f32_32x32x16_bf16 v[128:143], v[192:195], v[224:227], v[128:143]
ds_read_b128 v[232:235], v19 offset:12288
ds_read_b64_tr_b16 a[96:97], v13 offset:32768
ds_read_b64_tr_b16 a[98:99], v13 offset:33792
v_mfma_f32_32x32x16_bf16 v[144:159], v[196:199], v[224:227], v[144:159]
ds_read_b64_tr_b16 a[100:101], v14 offset:32768
ds_read_b64_tr_b16 a[102:103], v14 offset:33792
ds_read_b64_tr_b16 a[104:105], v15 offset:32768
v_mfma_f32_32x32x16_bf16 v[160:175], v[200:203], v[224:227], v[160:175]
ds_read_b64_tr_b16 a[106:107], v15 offset:33792
ds_read_b64_tr_b16 a[108:109], v16 offset:32768
ds_read_b64_tr_b16 a[110:111], v16 offset:33792
v_mfma_f32_32x32x16_bf16 v[176:191], v[204:207], v[224:227], v[176:191]
ds_read_b128 v[236:239], v20 offset:12288
ds_read_b64_tr_b16 a[112:113], v13 offset:36864
ds_read_b64_tr_b16 a[114:115], v13 offset:37888
v_mfma_f32_32x32x16_bf16 v[128:143], v[208:211], v[228:231], v[128:143]
ds_read_b64_tr_b16 a[116:117], v14 offset:36864
ds_read_b64_tr_b16 a[118:119], v14 offset:37888
ds_read_b64_tr_b16 a[120:121], v15 offset:36864
v_mfma_f32_32x32x16_bf16 v[144:159], v[212:215], v[228:231], v[144:159]
ds_read_b64_tr_b16 a[122:123], v15 offset:37888
ds_read_b64_tr_b16 a[124:125], v16 offset:36864
ds_read_b64_tr_b16 a[126:127], v16 offset:37888
v_mfma_f32_32x32x16_bf16 v[160:175], v[216:219], v[228:231], v[160:175]
v_mfma_f32_32x32x16_bf16 v[176:191], v[220:223], v[228:231], v[176:191]
s_waitcnt lgkmcnt(0)
s_barrier
v_mfma_f32_32x32x16_bf16 v[128:143], a[96:99], v[232:235], v[128:143]
ds_read_b128 v[224:227], v17 offset:24576
ds_read_b64_tr_b16 v[192:193], v13 offset:0
ds_read_b64_tr_b16 v[194:195], v13 offset:1024
v_mfma_f32_32x32x16_bf16 v[144:159], a[100:103], v[232:235], v[144:159]
ds_read_b64_tr_b16 v[196:197], v14 offset:0
ds_read_b64_tr_b16 v[198:199], v14 offset:1024
ds_read_b64_tr_b16 v[200:201], v15 offset:0
v_mfma_f32_32x32x16_bf16 v[160:175], a[104:107], v[232:235], v[160:175]
ds_read_b64_tr_b16 v[202:203], v15 offset:1024
ds_read_b64_tr_b16 v[204:205], v16 offset:0
ds_read_b64_tr_b16 v[206:207], v16 offset:1024
v_mfma_f32_32x32x16_bf16 v[176:191], a[108:111], v[232:235], v[176:191]
ds_read_b128 v[228:231], v18 offset:24576
ds_read_b64_tr_b16 v[208:209], v13 offset:4096
ds_read_b64_tr_b16 v[210:211], v13 offset:5120
v_mfma_f32_32x32x16_bf16 v[128:143], a[112:115], v[236:239], v[128:143]
ds_read_b64_tr_b16 v[212:213], v14 offset:4096
ds_read_b64_tr_b16 v[214:215], v14 offset:5120
ds_read_b64_tr_b16 v[216:217], v15 offset:4096
v_mfma_f32_32x32x16_bf16 v[144:159], a[116:119], v[236:239], v[144:159]
ds_read_b64_tr_b16 v[218:219], v15 offset:5120
ds_read_b64_tr_b16 v[220:221], v16 offset:4096
ds_read_b64_tr_b16 v[222:223], v16 offset:5120
v_mfma_f32_32x32x16_bf16 v[160:175], a[120:123], v[236:239], v[160:175]
v_mfma_f32_32x32x16_bf16 v[176:191], a[124:127], v[236:239], v[176:191]
s_waitcnt lgkmcnt(0)
s_barrier
v_mfma_f32_32x32x16_bf16 v[128:143], v[192:195], v[224:227], v[128:143]
ds_read_b128 v[232:235], v19 offset:24576
ds_read_b64_tr_b16 a[96:97], v13 offset:8192
ds_read_b64_tr_b16 a[98:99], v13 offset:9216
v_mfma_f32_32x32x16_bf16 v[144:159], v[196:199], v[224:227], v[144:159]
ds_read_b64_tr_b16 a[100:101], v14 offset:8192
ds_read_b64_tr_b16 a[102:103], v14 offset:9216
ds_read_b64_tr_b16 a[104:105], v15 offset:8192
v_mfma_f32_32x32x16_bf16 v[160:175], v[200:203], v[224:227], v[160:175]
ds_read_b64_tr_b16 a[106:107], v15 offset:9216
ds_read_b64_tr_b16 a[108:109], v16 offset:8192
ds_read_b64_tr_b16 a[110:111], v16 offset:9216
v_mfma_f32_32x32x16_bf16 v[176:191], v[204:207], v[224:227], v[176:191]
ds_read_b128 v[236:239], v20 offset:24576
ds_read_b64_tr_b16 a[112:113], v13 offset:12288
ds_read_b64_tr_b16 a[114:115], v13 offset:13312
v_mfma_f32_32x32x16_bf16 v[128:143], v[208:211], v[228:231], v[128:143]
ds_read_b64_tr_b16 a[116:117], v14 offset:12288
ds_read_b64_tr_b16 a[118:119], v14 offset:13312
ds_read_b64_tr_b16 a[120:121], v15 offset:12288
v_mfma_f32_32x32x16_bf16 v[144:159], v[212:215], v[228:231], v[144:159]
ds_read_b64_tr_b16 a[122:123], v15 offset:13312
ds_read_b64_tr_b16 a[124:125], v16 offset:12288
ds_read_b64_tr_b16 a[126:127], v16 offset:13312
v_mfma_f32_32x32x16_bf16 v[160:175], v[216:219], v[228:231], v[160:175]
v_mfma_f32_32x32x16_bf16 v[176:191], v[220:223], v[228:231], v[176:191]
s_waitcnt lgkmcnt(0)
s_barrier
v_mfma_f32_32x32x16_bf16 v[128:143], a[96:99], v[232:235], v[128:143]
ds_read_b128 v[224:227], v17 offset:0
ds_read_b64_tr_b16 v[192:193], v13 offset:16384
ds_read_b64_tr_b16 v[194:195], v13 offset:17408
v_mfma_f32_32x32x16_bf16 v[144:159], a[100:103], v[232:235], v[144:159]
ds_read_b64_tr_b16 v[196:197], v14 offset:16384
ds_read_b64_tr_b16 v[198:199], v14 offset:17408
ds_read_b64_tr_b16 v[200:201], v15 offset:16384
v_mfma_f32_32x32x16_bf16 v[160:175], a[104:107], v[232:235], v[160:175]
ds_read_b64_tr_b16 v[202:203], v15 offset:17408
ds_read_b64_tr_b16 v[204:205], v16 offset:16384
ds_read_b64_tr_b16 v[206:207], v16 offset:17408
v_mfma_f32_32x32x16_bf16 v[176:191], a[108:111], v[232:235], v[176:191]
ds_read_b128 v[228:231], v18 offset:0
ds_read_b64_tr_b16 v[208:209], v13 offset:20480
ds_read_b64_tr_b16 v[210:211], v13 offset:21504
v_mfma_f32_32x32x16_bf16 v[128:143], a[112:115], v[236:239], v[128:143]
ds_read_b64_tr_b16 v[212:213], v14 offset:20480
ds_read_b64_tr_b16 v[214:215], v14 offset:21504
ds_read_b64_tr_b16 v[216:217], v15 offset:20480
v_mfma_f32_32x32x16_bf16 v[144:159], a[116:119], v[236:239], v[144:159]
ds_read_b64_tr_b16 v[218:219], v15 offset:21504
ds_read_b64_tr_b16 v[220:221], v16 offset:20480
ds_read_b64_tr_b16 v[222:223], v16 offset:21504
v_mfma_f32_32x32x16_bf16 v[160:175], a[120:123], v[236:239], v[160:175]
v_mfma_f32_32x32x16_bf16 v[176:191], a[124:127], v[236:239], v[176:191]
s_waitcnt lgkmcnt(0)
s_barrier
v_mfma_f32_32x32x16_bf16 v[128:143], v[192:195], v[224:227], v[128:143]
ds_read_b128 v[232:235], v19 offset:0
ds_read_b64_tr_b16 a[96:97], v13 offset:24576
ds_read_b64_tr_b16 a[98:99], v13 offset:25600
v_mfma_f32_32x32x16_bf16 v[144:159], v[196:199], v[224:227], v[144:159]
ds_read_b64_tr_b16 a[100:101], v14 offset:24576
ds_read_b64_tr_b16 a[102:103], v14 offset:25600
ds_read_b64_tr_b16 a[104:105], v15 offset:24576
v_mfma_f32_32x32x16_bf16 v[160:175], v[200:203], v[224:227], v[160:175]
ds_read_b64_tr_b16 a[106:107], v15 offset:25600
ds_read_b64_tr_b16 a[108:109], v16 offset:24576
ds_read_b64_tr_b16 a[110:111], v16 offset:25600
v_mfma_f32_32x32x16_bf16 v[176:191], v[204:207], v[224:227], v[176:191]
ds_read_b128 v[236:239], v20 offset:0
ds_read_b64_tr_b16 a[112:113], v13 offset:28672
ds_read_b64_tr_b16 a[114:115], v13 offset:29696
v_mfma_f32_32x32x16_bf16 v[128:143], v[208:211], v[228:231], v[128:143]
ds_read_b64_tr_b16 a[116:117], v14 offset:28672
ds_read_b64_tr_b16 a[118:119], v14 offset:29696
ds_read_b64_tr_b16 a[120:121], v15 offset:28672
v_mfma_f32_32x32x16_bf16 v[144:159], v[212:215], v[228:231], v[144:159]
ds_read_b64_tr_b16 a[122:123], v15 offset:29696
ds_read_b64_tr_b16 a[124:125], v16 offset:28672
ds_read_b64_tr_b16 a[126:127], v16 offset:29696
v_mfma_f32_32x32x16_bf16 v[160:175], v[216:219], v[228:231], v[160:175]
v_mfma_f32_32x32x16_bf16 v[176:191], v[220:223], v[228:231], v[176:191]
s_waitcnt lgkmcnt(0)
s_barrier
v_mfma_f32_32x32x16_bf16 v[128:143], a[96:99], v[232:235], v[128:143]
ds_read_b128 v[224:227], v17 offset:12288
ds_read_b64_tr_b16 v[192:193], v13 offset:32768
ds_read_b64_tr_b16 v[194:195], v13 offset:33792
v_mfma_f32_32x32x16_bf16 v[144:159], a[100:103], v[232:235], v[144:159]
ds_read_b64_tr_b16 v[196:197], v14 offset:32768
ds_read_b64_tr_b16 v[198:199], v14 offset:33792
ds_read_b64_tr_b16 v[200:201], v15 offset:32768
v_mfma_f32_32x32x16_bf16 v[160:175], a[104:107], v[232:235], v[160:175]
ds_read_b64_tr_b16 v[202:203], v15 offset:33792
ds_read_b64_tr_b16 v[204:205], v16 offset:32768
ds_read_b64_tr_b16 v[206:207], v16 offset:33792
v_mfma_f32_32x32x16_bf16 v[176:191], a[108:111], v[232:235], v[176:191]
ds_read_b128 v[228:231], v18 offset:12288
ds_read_b64_tr_b16 v[208:209], v13 offset:36864
ds_read_b64_tr_b16 v[210:211], v13 offset:37888
v_mfma_f32_32x32x16_bf16 v[128:143], a[112:115], v[236:239], v[128:143]
ds_read_b64_tr_b16 v[212:213], v14 offset:36864
ds_read_b64_tr_b16 v[214:215], v14 offset:37888
ds_read_b64_tr_b16 v[216:217], v15 offset:36864
v_mfma_f32_32x32x16_bf16 v[144:159], a[116:119], v[236:239], v[144:159]
ds_read_b64_tr_b16 v[218:219], v15 offset:37888
ds_read_b64_tr_b16 v[220:221], v16 offset:36864
ds_read_b64_tr_b16 v[222:223], v16 offset:37888
v_mfma_f32_32x32x16_bf16 v[160:175], a[120:123], v[236:239], v[160:175]
v_mfma_f32_32x32x16_bf16 v[176:191], a[124:127], v[236:239], v[176:191]
s_waitcnt lgkmcnt(0)
s_barrier
v_mfma_f32_32x32x16_bf16 v[128:143], v[192:195], v[224:227], v[128:143]
ds_read_b128 v[232:235], v19 offset:12288
ds_read_b64_tr_b16 a[96:97], v13 offset:0
ds_read_b64_tr_b16 a[98:99], v13 offset:1024
v_mfma_f32_32x32x16_bf16 v[144:159], v[196:199], v[224:227], v[144:159]
ds_read_b64_tr_b16 a[100:101], v14 offset:0
ds_read_b64_tr_b16 a[102:103], v14 offset:1024
ds_read_b64_tr_b16 a[104:105], v15 offset:0
v_mfma_f32_32x32x16_bf16 v[160:175], v[200:203], v[224:227], v[160:175]
ds_read_b64_tr_b16 a[106:107], v15 offset:1024
ds_read_b64_tr_b16 a[108:109], v16 offset:0
ds_read_b64_tr_b16 a[110:111], v16 offset:1024
v_mfma_f32_32x32x16_bf16 v[176:191], v[204:207], v[224:227], v[176:191]
ds_read_b128 v[236:239], v20 offset:12288
ds_read_b64_tr_b16 a[112:113], v13 offset:4096
ds_read_b64_tr_b16 a[114:115], v13 offset:5120
v_mfma_f32_32x32x16_bf16 v[128:143], v[208:211], v[228:231], v[128:143]
ds_read_b64_tr_b16 a[116:117], v14 offset:4096
ds_read_b64_tr_b16 a[118:119], v14 offset:5120
ds_read_b64_tr_b16 a[120:121], v15 offset:4096
v_mfma_f32_32x32x16_bf16 v[144:159], v[212:215], v[228:231], v[144:159]
ds_read_b64_tr_b16 a[122:123], v15 offset:5120
ds_read_b64_tr_b16 a[124:125], v16 offset:4096
ds_read_b64_tr_b16 a[126:127], v16 offset:5120
v_mfma_f32_32x32x16_bf16 v[160:175], v[216:219], v[228:231], v[160:175]
v_mfma_f32_32x32x16_bf16 v[176:191], v[220:223], v[228:231], v[176:191]
s_waitcnt lgkmcnt(0)
s_barrier
v_mfma_f32_32x32x16_bf16 v[128:143], a[96:99], v[232:235], v[128:143]
ds_read_b128 v[224:227], v17 offset:24576
ds_read_b64_tr_b16 v[192:193], v13 offset:8192
ds_read_b64_tr_b16 v[194:195], v13 offset:9216
v_mfma_f32_32x32x16_bf16 v[144:159], a[100:103], v[232:235], v[144:159]
ds_read_b64_tr_b16 v[196:197], v14 offset:8192
ds_read_b64_tr_b16 v[198:199], v14 offset:9216
ds_read_b64_tr_b16 v[200:201], v15 offset:8192
v_mfma_f32_32x32x16_bf16 v[160:175], a[104:107], v[232:235], v[160:175]
ds_read_b64_tr_b16 v[202:203], v15 offset:9216
ds_read_b64_tr_b16 v[204:205], v16 offset:8192
ds_read_b64_tr_b16 v[206:207], v16 offset:9216
v_mfma_f32_32x32x16_bf16 v[176:191], a[108:111], v[232:235], v[176:191]
ds_read_b128 v[228:231], v18 offset:24576
ds_read_b64_tr_b16 v[208:209], v13 offset:12288
ds_read_b64_tr_b16 v[210:211], v13 offset:13312
v_mfma_f32_32x32x16_bf16 v[128:143], a[112:115], v[236:239], v[128:143]
ds_read_b64_tr_b16 v[212:213], v14 offset:12288
ds_read_b64_tr_b16 v[214:215], v14 offset:13312
ds_read_b64_tr_b16 v[216:217], v15 offset:12288
v_mfma_f32_32x32x16_bf16 v[144:159], a[116:119], v[236:239], v[144:159]
ds_read_b64_tr_b16 v[218:219], v15 offset:13312
ds_read_b64_tr_b16 v[220:221], v16 offset:12288
ds_read_b64_tr_b16 v[222:223], v16 offset:13312
v_mfma_f32_32x32x16_bf16 v[160:175], a[120:123], v[236:239], v[160:175]
v_mfma_f32_32x32x16_bf16 v[176:191], a[124:127], v[236:239], v[176:191]
s_waitcnt lgkmcnt(0)
s_barrier
v_mfma_f32_32x32x16_bf16 v[128:143], v[192:195], v[224:227], v[128:143]
ds_read_b128 v[232:235], v19 offset:24576
ds_read_b64_tr_b16 a[96:97], v13 offset:16384
ds_read_b64_tr_b16 a[98:99], v13 offset:17408
v_mfma_f32_32x32x16_bf16 v[144:159], v[196:199], v[224:227], v[144:159]
ds_read_b64_tr_b16 a[100:101], v14 offset:16384
ds_read_b64_tr_b16 a[102:103], v14 offset:17408
ds_read_b64_tr_b16 a[104:105], v15 offset:16384
v_mfma_f32_32x32x16_bf16 v[160:175], v[200:203], v[224:227], v[160:175]
ds_read_b64_tr_b16 a[106:107], v15 offset:17408
ds_read_b64_tr_b16 a[108:109], v16 offset:16384
ds_read_b64_tr_b16 a[110:111], v16 offset:17408
v_mfma_f32_32x32x16_bf16 v[176:191], v[204:207], v[224:227], v[176:191]
ds_read_b128 v[236:239], v20 offset:24576
ds_read_b64_tr_b16 a[112:113], v13 offset:20480
ds_read_b64_tr_b16 a[114:115], v13 offset:21504
v_mfma_f32_32x32x16_bf16 v[128:143], v[208:211], v[228:231], v[128:143]
ds_read_b64_tr_b16 a[116:117], v14 offset:20480
ds_read_b64_tr_b16 a[118:119], v14 offset:21504
ds_read_b64_tr_b16 a[120:121], v15 offset:20480
v_mfma_f32_32x32x16_bf16 v[144:159], v[212:215], v[228:231], v[144:159]
ds_read_b64_tr_b16 a[122:123], v15 offset:21504
ds_read_b64_tr_b16 a[124:125], v16 offset:20480
ds_read_b64_tr_b16 a[126:127], v16 offset:21504
v_mfma_f32_32x32x16_bf16 v[160:175], v[216:219], v[228:231], v[160:175]
v_mfma_f32_32x32x16_bf16 v[176:191], v[220:223], v[228:231], v[176:191]
s_waitcnt lgkmcnt(0)
s_barrier
v_mfma_f32_32x32x16_bf16 v[128:143], a[96:99], v[232:235], v[128:143]
ds_read_b128 v[224:227], v17 offset:0
ds_read_b64_tr_b16 v[192:193], v13 offset:24576
ds_read_b64_tr_b16 v[194:195], v13 offset:25600
v_mfma_f32_32x32x16_bf16 v[144:159], a[100:103], v[232:235], v[144:159]
ds_read_b64_tr_b16 v[196:197], v14 offset:24576
ds_read_b64_tr_b16 v[198:199], v14 offset:25600
ds_read_b64_tr_b16 v[200:201], v15 offset:24576
v_mfma_f32_32x32x16_bf16 v[160:175], a[104:107], v[232:235], v[160:175]
ds_read_b64_tr_b16 v[202:203], v15 offset:25600
ds_read_b64_tr_b16 v[204:205], v16 offset:24576
ds_read_b64_tr_b16 v[206:207], v16 offset:25600
v_mfma_f32_32x32x16_bf16 v[176:191], a[108:111], v[232:235], v[176:191]
ds_read_b128 v[228:231], v18 offset:0
ds_read_b64_tr_b16 v[208:209], v13 offset:28672
ds_read_b64_tr_b16 v[210:211], v13 offset:29696
v_mfma_f32_32x32x16_bf16 v[128:143], a[112:115], v[236:239], v[128:143]
ds_read_b64_tr_b16 v[212:213], v14 offset:28672
ds_read_b64_tr_b16 v[214:215], v14 offset:29696
ds_read_b64_tr_b16 v[216:217], v15 offset:28672
v_mfma_f32_32x32x16_bf16 v[144:159], a[116:119], v[236:239], v[144:159]
ds_read_b64_tr_b16 v[218:219], v15 offset:29696
ds_read_b64_tr_b16 v[220:221], v16 offset:28672
ds_read_b64_tr_b16 v[222:223], v16 offset:29696
v_mfma_f32_32x32x16_bf16 v[160:175], a[120:123], v[236:239], v[160:175]
v_mfma_f32_32x32x16_bf16 v[176:191], a[124:127], v[236:239], v[176:191]
s_waitcnt lgkmcnt(0)
s_waitcnt vmcnt(0)
s_barrier
v_mfma_f32_32x32x16_bf16 v[128:143], v[192:195], v[224:227], v[128:143]
ds_read_b128 v[232:235], v19 offset:0
ds_read_b64_tr_b16 a[96:97], v13 offset:32768
ds_read_b64_tr_b16 a[98:99], v13 offset:33792
v_mfma_f32_32x32x16_bf16 v[144:159], v[196:199], v[224:227], v[144:159]
ds_read_b64_tr_b16 a[100:101], v14 offset:32768
ds_read_b64_tr_b16 a[102:103], v14 offset:33792
ds_read_b64_tr_b16 a[104:105], v15 offset:32768
v_mfma_f32_32x32x16_bf16 v[160:175], v[200:203], v[224:227], v[160:175]
ds_read_b64_tr_b16 a[106:107], v15 offset:33792
ds_read_b64_tr_b16 a[108:109], v16 offset:32768
ds_read_b64_tr_b16 a[110:111], v16 offset:33792
v_mfma_f32_32x32x16_bf16 v[176:191], v[204:207], v[224:227], v[176:191]
ds_read_b128 v[236:239], v20 offset:0
ds_read_b64_tr_b16 a[112:113], v13 offset:36864
ds_read_b64_tr_b16 a[114:115], v13 offset:37888
v_mfma_f32_32x32x16_bf16 v[128:143], v[208:211], v[228:231], v[128:143]
ds_read_b64_tr_b16 a[116:117], v14 offset:36864
ds_read_b64_tr_b16 a[118:119], v14 offset:37888
ds_read_b64_tr_b16 a[120:121], v15 offset:36864
v_mfma_f32_32x32x16_bf16 v[144:159], v[212:215], v[228:231], v[144:159]
ds_read_b64_tr_b16 a[122:123], v15 offset:37888
ds_read_b64_tr_b16 a[124:125], v16 offset:36864
ds_read_b64_tr_b16 a[126:127], v16 offset:37888
v_mfma_f32_32x32x16_bf16 v[160:175], v[216:219], v[228:231], v[160:175]
v_mfma_f32_32x32x16_bf16 v[176:191], v[220:223], v[228:231], v[176:191]
s_waitcnt lgkmcnt(0)
s_barrier
v_mfma_f32_32x32x16_bf16 v[128:143], a[96:99], v[232:235], v[128:143]
ds_read_b128 a[128:131], v1 offset:0
ds_read_b128 a[132:135], v2 offset:0
ds_read_b128 a[136:139], v3 offset:0
v_mfma_f32_32x32x16_bf16 v[144:159], a[100:103], v[232:235], v[144:159]
ds_read_b128 a[140:143], v4 offset:0
ds_read_b128 a[144:147], v5 offset:0
v_mfma_f32_32x32x16_bf16 v[160:175], a[104:107], v[232:235], v[160:175]
ds_read_b128 a[148:151], v6 offset:0
ds_read_b128 a[152:155], v7 offset:0
ds_read_b128 a[156:159], v8 offset:0
v_mfma_f32_32x32x16_bf16 v[176:191], a[108:111], v[232:235], v[176:191]
ds_read_b128 a[160:163], v1 offset:8192
ds_read_b128 a[164:167], v2 offset:8192
ds_read_b128 a[168:171], v3 offset:8192
v_mfma_f32_32x32x16_bf16 v[128:143], a[112:115], v[236:239], v[128:143]
ds_read_b128 a[172:175], v4 offset:8192
ds_read_b128 a[176:179], v5 offset:8192
v_mfma_f32_32x32x16_bf16 v[144:159], a[116:119], v[236:239], v[144:159]
ds_read_b128 a[180:183], v6 offset:8192
ds_read_b128 a[184:187], v7 offset:8192
ds_read_b128 a[188:191], v8 offset:8192
v_mfma_f32_32x32x16_bf16 v[160:175], a[120:123], v[236:239], v[160:175]
v_mfma_f32_32x32x16_bf16 v[176:191], a[124:127], v[236:239], v[176:191]
s_cmp_lg_u32 s59, 0
s_cbranch_scc1 L_noann
s_lshl_b32 s41, s45, 4
s_mul_i32 s62, s60, 0x9E3779B1
s_mul_i32 s60, s60, 0x85EBCA6B
s_add_u32 s60, s60, s61
v_mov_b32 v32, 1
v_mov_b32 v33, s62
v_mov_b32 v34, s60
v_mov_b32 v35, 0
buffer_store_dwordx4 v[32:35], v22, s[4:7], s41 offen sc1
L_noann:
s_nop 7
s_waitcnt lgkmcnt(0)
v_pk_mul_f32 v[128:129], v[128:129], s[52:53]
v_pk_mul_f32 v[130:131], v[130:131], s[52:53]
v_pk_mul_f32 v[132:133], v[132:133], s[52:53]
v_pk_mul_f32 v[134:135], v[134:135], s[52:53]
v_pk_mul_f32 v[136:137], v[136:137], s[52:53]
v_pk_mul_f32 v[138:139], v[138:139], s[52:53]
v_pk_mul_f32 v[140:141], v[140:141], s[52:53]
v_pk_mul_f32 v[142:143], v[142:143], s[52:53]
v_cvt_pk_bf16_f32 v128, v128, v129
v_cvt_pk_bf16_f32 v129, v130, v131
v_cvt_pk_bf16_f32 v130, v132, v133
v_cvt_pk_bf16_f32 v131, v134, v135
v_cvt_pk_bf16_f32 v132, v136, v137
v_cvt_pk_bf16_f32 v133, v138, v139
v_cvt_pk_bf16_f32 v134, v140, v141
v_cvt_pk_bf16_f32 v135, v142, v143
v_accvgpr_write_b32 a64, v128
v_accvgpr_write_b32 a65, v129
v_accvgpr_write_b32 a66, v130
v_accvgpr_write_b32 a67, v131
v_accvgpr_write_b32 a68, v132
v_accvgpr_write_b32 a69, v133
v_accvgpr_write_b32 a70, v134
v_accvgpr_write_b32 a71, v135
s_nop 1
v_mfma_f32_32x32x16_bf16 v[64:79], a[128:131], a[64:67], 0
v_pk_mul_f32 v[144:145], v[144:145], s[52:53]
v_pk_mul_f32 v[146:147], v[146:147], s[52:53]
v_pk_mul_f32 v[148:149], v[148:149], s[52:53]
v_pk_mul_f32 v[150:151], v[150:151], s[52:53]
v_pk_mul_f32 v[152:153], v[152:153], s[52:53]
v_pk_mul_f32 v[154:155], v[154:155], s[52:53]
v_mfma_f32_32x32x16_bf16 v[80:95], a[160:163], a[64:67], 0
v_pk_mul_f32 v[156:157], v[156:157], s[52:53]
v_pk_mul_f32 v[158:159], v[158:159], s[52:53]
v_cvt_pk_bf16_f32 v144, v144, v145
v_cvt_pk_bf16_f32 v145, v146, v147
v_cvt_pk_bf16_f32 v146, v148, v149
v_cvt_pk_bf16_f32 v147, v150, v151
v_mfma_f32_32x32x16_bf16 v[64:79], a[132:135], a[68:71], v[64:79]
v_cvt_pk_bf16_f32 v148, v152, v153
v_cvt_pk_bf16_f32 v149, v154, v155
v_cvt_pk_bf16_f32 v150, v156, v157
v_cvt_pk_bf16_f32 v151, v158, v159
v_accvgpr_write_b32 a72, v144
v_accvgpr_write_b32 a73, v145
v_mfma_f32_32x32x16_bf16 v[80:95], a[164:167], a[68:71], v[80:95]
v_accvgpr_write_b32 a74, v146
v_accvgpr_write_b32 a75, v147
v_accvgpr_write_b32 a76, v148
v_accvgpr_write_b32 a77, v149
v_accvgpr_write_b32 a78, v150
v_accvgpr_write_b32 a79, v151
s_nop 1
v_mfma_f32_32x32x16_bf16 v[64:79], a[136:139], a[72:75], v[64:79]
v_pk_mul_f32 v[160:161], v[160:161], s[52:53]
v_pk_mul_f32 v[162:163], v[162:163], s[52:53]
v_pk_mul_f32 v[164:165], v[164:165], s[52:53]
v_pk_mul_f32 v[166:167], v[166:167], s[52:53]
v_pk_mul_f32 v[168:169], v[168:169], s[52:53]
v_pk_mul_f32 v[170:171], v[170:171], s[52:53]
v_mfma_f32_32x32x16_bf16 v[80:95], a[168:171], a[72:75], v[80:95]
v_pk_mul_f32 v[172:173], v[172:173], s[52:53]
v_pk_mul_f32 v[174:175], v[174:175], s[52:53]
v_cvt_pk_bf16_f32 v160, v160, v161
v_cvt_pk_bf16_f32 v161, v162, v163
v_cvt_pk_bf16_f32 v162, v164, v165
v_cvt_pk_bf16_f32 v163, v166, v167
v_mfma_f32_32x32x16_bf16 v[64:79], a[140:143], a[76:79], v[64:79]
v_cvt_pk_bf16_f32 v164, v168, v169
v_cvt_pk_bf16_f32 v165, v170, v171
v_cvt_pk_bf16_f32 v166, v172, v173
v_cvt_pk_bf16_f32 v167, v174, v175
v_accvgpr_write_b32 a80, v160
v_accvgpr_write_b32 a81, v161
v_mfma_f32_32x32x16_bf16 v[80:95], a[172:175], a[76:79], v[80:95]
v_accvgpr_write_b32 a82, v162
v_accvgpr_write_b32 a83, v163
v_accvgpr_write_b32 a84, v164
v_accvgpr_write_b32 a85, v165
v_accvgpr_write_b32 a86, v166
v_accvgpr_write_b32 a87, v167
s_nop 1
v_mfma_f32_32x32x16_bf16 v[64:79], a[144:147], a[80:83], v[64:79]
v_pk_mul_f32 v[176:177], v[176:177], s[52:53]
v_pk_mul_f32 v[178:179], v[178:179], s[52:53]
v_pk_mul_f32 v[180:181], v[180:181], s[52:53]
v_pk_mul_f32 v[182:183], v[182:183], s[52:53]
v_pk_mul_f32 v[184:185], v[184:185], s[52:53]
v_pk_mul_f32 v[186:187], v[186:187], s[52:53]
v_mfma_f32_32x32x16_bf16 v[80:95], a[176:179], a[80:83], v[80:95]
v_pk_mul_f32 v[188:189], v[188:189], s[52:53]
v_pk_mul_f32 v[190:191], v[190:191], s[52:53]
v_cvt_pk_bf16_f32 v176, v176, v177
v_cvt_pk_bf16_f32 v177, v178, v179
v_cvt_pk_bf16_f32 v178, v180, v181
v_cvt_pk_bf16_f32 v179, v182, v183
v_mfma_f32_32x32x16_bf16 v[64:79], a[148:151], a[84:87], v[64:79]
v_cvt_pk_bf16_f32 v180, v184, v185
v_cvt_pk_bf16_f32 v181, v186, v187
v_cvt_pk_bf16_f32 v182, v188, v189
v_cvt_pk_bf16_f32 v183, v190, v191
v_accvgpr_write_b32 a88, v176
v_accvgpr_write_b32 a89, v177
v_mfma_f32_32x32x16_bf16 v[80:95], a[180:183], a[84:87], v[80:95]
v_accvgpr_write_b32 a90, v178
v_accvgpr_write_b32 a91, v179
v_accvgpr_write_b32 a92, v180
v_accvgpr_write_b32 a93, v181
v_accvgpr_write_b32 a94, v182
v_accvgpr_write_b32 a95, v183
s_nop 1
v_mfma_f32_32x32x16_bf16 v[64:79], a[152:155], a[88:91], v[64:79]
v_mfma_f32_32x32x16_bf16 v[80:95], a[184:187], a[88:91], v[80:95]
v_mfma_f32_32x32x16_bf16 v[64:79], a[156:159], a[92:95], v[64:79]
v_mfma_f32_32x32x16_bf16 v[80:95], a[188:191], a[92:95], v[80:95]
s_barrier
ds_read_b128 v[224:227], v17 offset:12288
ds_read_b64_tr_b16 v[192:193], v13 offset:0
ds_read_b64_tr_b16 v[194:195], v13 offset:1024
ds_read_b64_tr_b16 v[196:197], v14 offset:0
ds_read_b64_tr_b16 v[198:199], v14 offset:1024
ds_read_b64_tr_b16 v[200:201], v15 offset:0
ds_read_b64_tr_b16 v[202:203], v15 offset:1024
ds_read_b64_tr_b16 v[204:205], v16 offset:0
ds_read_b64_tr_b16 v[206:207], v16 offset:1024
ds_read_b128 v[228:231], v18 offset:12288
ds_read_b64_tr_b16 v[208:209], v13 offset:4096
ds_read_b64_tr_b16 v[210:211], v13 offset:5120
ds_read_b64_tr_b16 v[212:213], v14 offset:4096
ds_read_b64_tr_b16 v[214:215], v14 offset:5120
ds_read_b64_tr_b16 v[216:217], v15 offset:4096
ds_read_b64_tr_b16 v[218:219], v15 offset:5120
ds_read_b64_tr_b16 v[220:221], v16 offset:4096
ds_read_b64_tr_b16 v[222:223], v16 offset:5120
ds_read_b128 a[128:131], v1 offset:16384
ds_read_b128 a[132:135], v2 offset:16384
ds_read_b128 a[136:139], v3 offset:16384
ds_read_b128 a[140:143], v4 offset:16384
ds_read_b128 a[144:147], v5 offset:16384
ds_read_b128 a[148:151], v6 offset:16384
ds_read_b128 a[152:155], v7 offset:16384
ds_read_b128 a[156:159], v8 offset:16384
ds_read_b128 a[160:163], v1 offset:24576
ds_read_b128 a[164:167], v2 offset:24576
ds_read_b128 a[168:171], v3 offset:24576
ds_read_b128 a[172:175], v4 offset:24576
ds_read_b128 a[176:179], v5 offset:24576
ds_read_b128 a[180:183], v6 offset:24576
ds_read_b128 a[184:187], v7 offset:24576
ds_read_b128 a[188:191], v8 offset:24576
v_max3_f32 v26, v64, v65, v66
v_max3_f32 v26, v26, v67, v68
v_max3_f32 v26, v26, v69, v70
v_max3_f32 v26, v26, v71, v72
v_max3_f32 v26, v26, v73, v74
v_max3_f32 v26, v26, v75, v76
v_max3_f32 v26, v26, v77, v78
v_max3_f32 v27, v80, v81, v82
v_max3_f32 v27, v27, v83, v84
v_max3_f32 v27, v27, v85, v86
v_max3_f32 v27, v27, v87, v88
v_max3_f32 v27, v27, v89, v90
v_max3_f32 v27, v27, v91, v92
v_max3_f32 v27, v27, v93, v94
v_max3_f32 v26, v26, v79, v95
v_max_f32 v26, v26, v27
v_mov_b32 v28, v26
s_nop 1
v_permlane32_swap_b32 v26, v28
s_nop 0
s_waitcnt lgkmcnt(15)
v_mfma_f32_32x32x16_bf16 v[128:143], v[192:195], v[224:227], 0
v_max_f32 v26, v26, v28
v_sub_f32 v48, 0, v26
v_sub_f32 v49, 0, v26
v_sub_f32 v50, 0, v26
v_sub_f32 v51, 0, v26
v_sub_f32 v52, 0, v26
v_mfma_f32_32x32x16_bf16 v[144:159], v[196:199], v[224:227], 0
v_sub_f32 v53, 0, v26
v_sub_f32 v54, 0, v26
v_sub_f32 v55, 0, v26
v_sub_f32 v56, 0, v26
v_sub_f32 v57, 0, v26
v_sub_f32 v58, 0, v26
v_mfma_f32_32x32x16_bf16 v[160:175], v[200:203], v[224:227], 0
v_sub_f32 v59, 0, v26
v_sub_f32 v60, 0, v26
v_sub_f32 v61, 0, v26
v_sub_f32 v62, 0, v26
v_sub_f32 v63, 0, v26
v_sub_f32 v64, v64, v26
v_mfma_f32_32x32x16_bf16 v[176:191], v[204:207], v[224:227], 0
v_sub_f32 v65, v65, v26
v_sub_f32 v66, v66, v26
v_sub_f32 v67, v67, v26
v_sub_f32 v68, v68, v26
v_sub_f32 v69, v69, v26
v_sub_f32 v70, v70, v26
v_mfma_f32_32x32x16_bf16 v[128:143], v[208:211], v[228:231], v[128:143]
v_sub_f32 v71, v71, v26
v_sub_f32 v72, v72, v26
v_sub_f32 v73, v73, v26
v_sub_f32 v74, v74, v26
v_sub_f32 v75, v75, v26
v_sub_f32 v76, v76, v26
v_sub_f32 v77, v77, v26
v_mfma_f32_32x32x16_bf16 v[144:159], v[212:215], v[228:231], v[144:159]
v_sub_f32 v78, v78, v26
v_sub_f32 v79, v79, v26
v_sub_f32 v80, v80, v26
v_sub_f32 v81, v81, v26
v_sub_f32 v82, v82, v26
v_sub_f32 v83, v83, v26
v_mfma_f32_32x32x16_bf16 v[160:175], v[216:219], v[228:231], v[160:175]
v_sub_f32 v84, v84, v26
v_sub_f32 v85, v85, v26
v_sub_f32 v86, v86, v26
v_sub_f32 v87, v87, v26
v_sub_f32 v88, v88, v26
v_sub_f32 v89, v89, v26
v_mfma_f32_32x32x16_bf16 v[176:191], v[220:223], v[228:231], v[176:191]
v_sub_f32 v90, v90, v26
v_sub_f32 v91, v91, v26
v_sub_f32 v92, v92, v26
v_sub_f32 v93, v93, v26
v_sub_f32 v94, v94, v26
v_sub_f32 v95, v95, v26
s_waitcnt lgkmcnt(0)
s_barrier
v_mfma_f32_32x32x16_bf16 v[96:111], a[128:131], a[64:67], v[48:63]
ds_read_b128 v[224:227], v19 offset:12288
ds_read_b64_tr_b16 v[192:193], v13 offset:8192
v_exp_f32 v64, v64
v_exp_f32 v65, v65
v_mfma_f32_32x32x16_bf16 v[96:111], a[132:135], a[68:71], v[96:111]
ds_read_b64_tr_b16 v[194:195], v13 offset:9216
ds_read_b64_tr_b16 v[196:197], v14 offset:8192
ds_read_b64_tr_b16 v[198:199], v14 offset:9216
v_exp_f32 v66, v66
v_exp_f32 v67, v67
v_mfma_f32_32x32x16_bf16 v[96:111], a[136:139], a[72:75], v[96:111]
ds_read_b64_tr_b16 v[200:201], v15 offset:8192
ds_read_b64_tr_b16 v[202:203], v15 offset:9216
v_add_f32 v24, v24, v64
v_add_f32 v25, v25, v65
v_cvt_pk_bf16_f32 v32, v64, v65
v_mfma_f32_32x32x16_bf16 v[96:111], a[140:143], a[76:79], v[96:111]
ds_read_b64_tr_b16 v[204:205], v16 offset:8192
ds_read_b64_tr_b16 v[206:207], v16 offset:9216
v_exp_f32 v68, v68
v_exp_f32 v69, v69
v_mfma_f32_32x32x16_bf16 v[96:111], a[144:147], a[80:83], v[96:111]
ds_read_b128 v[228:231], v20 offset:12288
ds_read_b64_tr_b16 v[208:209], v13 offset:12288
v_add_f32 v24, v24, v66
v_add_f32 v25, v25, v67
v_cvt_pk_bf16_f32 v33, v66, v67
v_mfma_f32_32x32x16_bf16 v[96:111], a[148:151], a[84:87], v[96:111]
ds_read_b64_tr_b16 v[210:211], v13 offset:13312
ds_read_b64_tr_b16 v[212:213], v14 offset:12288
ds_read_b64_tr_b16 v[214:215], v14 offset:13312
v_exp_f32 v70, v70
v_exp_f32 v71, v71
v_mfma_f32_32x32x16_bf16 v[96:111], a[152:155], a[88:91], v[96:111]
ds_read_b64_tr_b16 v[216:217], v15 offset:12288
ds_read_b64_tr_b16 v[218:219], v15 offset:13312
v_add_f32 v24, v24, v68
v_add_f32 v25, v25, v69
v_cvt_pk_bf16_f32 v34, v68, v69
v_mfma_f32_32x32x16_bf16 v[96:111], a[156:159], a[92:95], v[96:111]
ds_read_b64_tr_b16 v[220:221], v16 offset:12288
ds_read_b64_tr_b16 v[222:223], v16 offset:13312
v_exp_f32 v72, v72
v_exp_f32 v73, v73
v_mfma_f32_32x32x16_bf16 v[112:127], a[160:163], a[64:67], v[48:63]
ds_read_b64_tr_b16 a[192:193], v9 offset:0
ds_read_b64_tr_b16 a[194:195], v9 offset:2048
v_add_f32 v24, v24, v70
v_add_f32 v25, v25, v71
v_cvt_pk_bf16_f32 v35, v70, v71
v_mfma_f32_32x32x16_bf16 v[112:127], a[164:167], a[68:71], v[112:127]
ds_read_b64_tr_b16 a[196:197], v10 offset:0
ds_read_b64_tr_b16 a[198:199], v10 offset:2048
ds_read_b64_tr_b16 a[200:201], v11 offset:0
v_exp_f32 v74, v74
v_exp_f32 v75, v75
v_mfma_f32_32x32x16_bf16 v[112:127], a[168:171], a[72:75], v[112:127]
ds_read_b64_tr_b16 a[202:203], v11 offset:2048
ds_read_b64_tr_b16 a[204:205], v12 offset:0
v_add_f32 v24, v24, v72
v_add_f32 v25, v25, v73
v_cvt_pk_bf16_f32 v36, v72, v73
v_mfma_f32_32x32x16_bf16 v[112:127], a[172:175], a[76:79], v[112:127]
ds_read_b64_tr_b16 a[206:207], v12 offset:2048
ds_read_b64_tr_b16 a[208:209], v9 offset:4096
v_exp_f32 v76, v76
v_exp_f32 v77, v77
v_mfma_f32_32x32x16_bf16 v[112:127], a[176:179], a[80:83], v[112:127]
ds_read_b64_tr_b16 a[210:211], v9 offset:6144
ds_read_b64_tr_b16 a[212:213], v10 offset:4096
ds_read_b64_tr_b16 a[214:215], v10 offset:6144
v_add_f32 v24, v24, v74
v_add_f32 v25, v25, v75
v_cvt_pk_bf16_f32 v37, v74, v75
v_mfma_f32_32x32x16_bf16 v[112:127], a[180:183], a[84:87], v[112:127]
ds_read_b64_tr_b16 a[216:217], v11 offset:4096
ds_read_b64_tr_b16 a[218:219], v11 offset:6144
v_exp_f32 v78, v78
v_exp_f32 v79, v79
v_mfma_f32_32x32x16_bf16 v[112:127], a[184:187], a[88:91], v[112:127]
ds_read_b64_tr_b16 a[220:221], v12 offset:4096
ds_read_b64_tr_b16 a[222:223], v12 offset:6144
v_add_f32 v24, v24, v76
v_add_f32 v25, v25, v77
v_cvt_pk_bf16_f32 v38, v76, v77
v_mfma_f32_32x32x16_bf16 v[112:127], a[188:191], a[92:95], v[112:127]
ds_read_b64_tr_b16 a[224:225], v9 offset:8192
ds_read_b64_tr_b16 a[226:227], v9 offset:10240
v_exp_f32 v80, v80
v_exp_f32 v81, v81
s_waitcnt lgkmcnt(15)
v_mfma_f32_32x32x16_bf16 v[128:143], v[192:195], v[224:227], v[128:143]
ds_read_b64_tr_b16 a[228:229], v10 offset:8192
ds_read_b64_tr_b16 a[230:231], v10 offset:10240
ds_read_b64_tr_b16 a[232:233], v11 offset:8192
v_add_f32 v24, v24, v78
v_add_f32 v25, v25, v79
v_cvt_pk_bf16_f32 v39, v78, v79
v_mfma_f32_32x32x16_bf16 v[144:159], v[196:199], v[224:227], v[144:159]
ds_read_b64_tr_b16 a[234:235], v11 offset:10240
ds_read_b64_tr_b16 a[236:237], v12 offset:8192
v_exp_f32 v82, v82
v_exp_f32 v83, v83
v_mfma_f32_32x32x16_bf16 v[160:175], v[200:203], v[224:227], v[160:175]
ds_read_b64_tr_b16 a[238:239], v12 offset:10240
ds_read_b64_tr_b16 a[240:241], v9 offset:12288
v_add_f32 v24, v24, v80
v_add_f32 v25, v25, v81
v_cvt_pk_bf16_f32 v40, v80, v81
v_mfma_f32_32x32x16_bf16 v[176:191], v[204:207], v[224:227], v[176:191]
ds_read_b64_tr_b16 a[242:243], v9 offset:14336
ds_read_b64_tr_b16 a[244:245], v10 offset:12288
v_exp_f32 v84, v84
v_exp_f32 v85, v85
v_mfma_f32_32x32x16_bf16 v[128:143], v[208:211], v[228:231], v[128:143]
ds_read_b64_tr_b16 a[246:247], v10 offset:14336
ds_read_b64_tr_b16 a[248:249], v11 offset:12288
ds_read_b64_tr_b16 a[250:251], v11 offset:14336
v_add_f32 v24, v24, v82
v_add_f32 v25, v25, v83
v_cvt_pk_bf16_f32 v41, v82, v83
v_mfma_f32_32x32x16_bf16 v[144:159], v[212:215], v[228:231], v[144:159]
ds_read_b64_tr_b16 a[252:253], v12 offset:12288
ds_read_b64_tr_b16 a[254:255], v12 offset:14336
v_exp_f32 v86, v86
v_exp_f32 v87, v87
v_mfma_f32_32x32x16_bf16 v[160:175], v[216:219], v[228:231], v[160:175]
v_add_f32 v24, v24, v84
v_add_f32 v25, v25, v85
v_cvt_pk_bf16_f32 v42, v84, v85
v_mfma_f32_32x32x16_bf16 v[176:191], v[220:223], v[228:231], v[176:191]
s_nop 0
v_add_f32 v24, v24, v86
v_add_f32 v25, v25, v87
v_cvt_pk_bf16_f32 v43, v86, v87
s_waitcnt lgkmcnt(0)
s_barrier
v_mfma_f32_32x32x16_bf16 a[0:15], a[192:195], v[32:35], 0
ds_read_b128 v[224:227], v17 offset:24576
ds_read_b64_tr_b16 v[192:193], v13 offset:16384
v_exp_f32 v88, v88
v_mfma_f32_32x32x16_bf16 a[16:31], a[196:199], v[32:35], 0
ds_read_b64_tr_b16 v[194:195], v13 offset:17408
v_exp_f32 v89, v89
v_exp_f32 v90, v90
v_mfma_f32_32x32x16_bf16 a[32:47], a[200:203], v[32:35], 0
ds_read_b64_tr_b16 v[196:197], v14 offset:16384
ds_read_b64_tr_b16 v[198:199], v14 offset:17408
v_exp_f32 v91, v91
v_add_f32 v24, v24, v88
v_mfma_f32_32x32x16_bf16 a[48:63], a[204:207], v[32:35], 0
ds_read_b64_tr_b16 v[200:201], v15 offset:16384
ds_read_b64_tr_b16 v[202:203], v15 offset:17408
v_add_f32 v25, v25, v89
v_cvt_pk_bf16_f32 v44, v88, v89
v_mfma_f32_32x32x16_bf16 a[0:15], a[208:211], v[36:39], a[0:15]
ds_read_b64_tr_b16 v[204:205], v16 offset:16384
ds_read_b64_tr_b16 v[206:207], v16 offset:17408
v_exp_f32 v92, v92
v_exp_f32 v93, v93
v_mfma_f32_32x32x16_bf16 a[16:31], a[212:215], v[36:39], a[16:31]
ds_read_b128 v[228:231], v18 offset:24576
v_add_f32 v24, v24, v90
v_add_f32 v25, v25, v91
v_mfma_f32_32x32x16_bf16 a[32:47], a[216:219], v[36:39], a[32:47]
ds_read_b64_tr_b16 v[208:209], v13 offset:20480
ds_read_b64_tr_b16 v[210:211], v13 offset:21504
v_cvt_pk_bf16_f32 v45, v90, v91
v_exp_f32 v94, v94
v_mfma_f32_32x32x16_bf16 a[48:63], a[220:223], v[36:39], a[48:63]
ds_read_b64_tr_b16 v[212:213], v14 offset:20480
ds_read_b64_tr_b16 v[214:215], v14 offset:21504
v_exp_f32 v95, v95
v_add_f32 v24, v24, v92
v_mfma_f32_32x32x16_bf16 a[0:15], a[224:227], v[40:43], a[0:15]
ds_read_b64_tr_b16 v[216:217], v15 offset:20480
ds_read_b64_tr_b16 v[218:219], v15 offset:21504
v_add_f32 v25, v25, v93
v_cvt_pk_bf16_f32 v46, v92, v93
s_nop 0
v_mfma_f32_32x32x16_bf16 a[16:31], a[228:231], v[40:43], a[16:31]
ds_read_b64_tr_b16 v[220:221], v16 offset:20480
v_add_f32 v24, v24, v94
v_add_f32 v25, v25, v95
v_cvt_pk_bf16_f32 v47, v94, v95
v_mfma_f32_32x32x16_bf16 a[32:47], a[232:235], v[40:43], a[32:47]
ds_read_b64_tr_b16 v[222:223], v16 offset:21504
ds_read_b128 v[232:235], v19 offset:24576
v_max3_f32 v26, v96, v97, v98
v_mfma_f32_32x32x16_bf16 a[48:63], a[236:239], v[40:43], a[48:63]
ds_read_b64_tr_b16 a[96:97], v13 offset:24576
ds_read_b64_tr_b16 a[98:99], v13 offset:25600
v_mfma_f32_32x32x16_bf16 a[0:15], a[240:243], v[44:47], a[0:15]
ds_read_b64_tr_b16 a[100:101], v14 offset:24576
ds_read_b64_tr_b16 a[102:103], v14 offset:25600
v_max3_f32 v26, v26, v99, v100
v_mfma_f32_32x32x16_bf16 a[16:31], a[244:247], v[44:47], a[16:31]
ds_read_b64_tr_b16 a[104:105], v15 offset:24576
v_max3_f32 v26, v26, v101, v102
v_mfma_f32_32x32x16_bf16 a[32:47], a[248:251], v[44:47], a[32:47]
ds_read_b64_tr_b16 a[106:107], v15 offset:25600
ds_read_b64_tr_b16 a[108:109], v16 offset:24576
v_max3_f32 v26, v26, v103, v104
v_mfma_f32_32x32x16_bf16 a[48:63], a[252:255], v[44:47], a[48:63]
ds_read_b64_tr_b16 a[110:111], v16 offset:25600
ds_read_b128 v[236:239], v20 offset:24576
s_waitcnt lgkmcnt(15)
v_mfma_f32_32x32x16_bf16 v[128:143], v[192:195], v[224:227], v[128:143]
ds_read_b64_tr_b16 a[112:113], v13 offset:28672
v_max3_f32 v26, v26, v105, v106
v_mfma_f32_32x32x16_bf16 v[144:159], v[196:199], v[224:227], v[144:159]
ds_read_b64_tr_b16 a[114:115], v13 offset:29696
ds_read_b64_tr_b16 a[116:117], v14 offset:28672
v_max3_f32 v26, v26, v107, v108
v_mfma_f32_32x32x16_bf16 v[160:175], v[200:203], v[224:227], v[160:175]
ds_read_b64_tr_b16 a[118:119], v14 offset:29696
ds_read_b64_tr_b16 a[120:121], v15 offset:28672
v_max3_f32 v26, v26, v109, v110
v_mfma_f32_32x32x16_bf16 v[176:191], v[204:207], v[224:227], v[176:191]
ds_read_b64_tr_b16 a[122:123], v15 offset:29696
ds_read_b64_tr_b16 a[124:125], v16 offset:28672
v_mfma_f32_32x32x16_bf16 v[128:143], v[208:211], v[228:231], v[128:143]
ds_read_b64_tr_b16 a[126:127], v16 offset:29696
v_max3_f32 v27, v112, v113, v114
s_waitcnt lgkmcnt(15)
v_mfma_f32_32x32x16_bf16 v[144:159], v[212:215], v[228:231], v[144:159]
ds_read_b128 a[128:131], v1 offset:32768
ds_read_b128 a[132:135], v2 offset:32768
v_max3_f32 v27, v27, v115, v116
v_mfma_f32_32x32x16_bf16 v[160:175], v[216:219], v[228:231], v[160:175]
ds_read_b128 a[136:139], v3 offset:32768
ds_read_b128 a[140:143], v4 offset:32768
v_mfma_f32_32x32x16_bf16 v[176:191], v[220:223], v[228:231], v[176:191]
ds_read_b128 a[144:147], v5 offset:32768
ds_read_b128 a[148:151], v6 offset:32768
v_max3_f32 v27, v27, v117, v118
v_mfma_f32_32x32x16_bf16 v[128:143], a[96:99], v[232:235], v[128:143]
ds_read_b128 a[152:155], v7 offset:32768
v_max3_f32 v27, v27, v119, v120
s_waitcnt lgkmcnt(15)
v_mfma_f32_32x32x16_bf16 v[144:159], a[100:103], v[232:235], v[144:159]
ds_read_b128 a[156:159], v8 offset:32768
ds_read_b128 a[160:163], v1 offset:40960
v_max3_f32 v27, v27, v121, v122
v_mfma_f32_32x32x16_bf16 v[160:175], a[104:107], v[232:235], v[160:175]
ds_read_b128 a[164:167], v2 offset:40960
ds_read_b128 a[168:171], v3 offset:40960
v_mfma_f32_32x32x16_bf16 v[176:191], a[108:111], v[232:235], v[176:191]
ds_read_b128 a[172:175], v4 offset:40960
ds_read_b128 a[176:179], v5 offset:40960
v_max3_f32 v27, v27, v123, v124
s_waitcnt lgkmcnt(15)
v_mfma_f32_32x32x16_bf16 v[128:143], a[112:115], v[236:239], v[128:143]
ds_read_b128 a[180:183], v6 offset:40960
v_max3_f32 v27, v27, v125, v126
v_mfma_f32_32x32x16_bf16 v[144:159], a[116:119], v[236:239], v[144:159]
ds_read_b128 a[184:187], v7 offset:40960
ds_read_b128 a[188:191], v8 offset:40960
v_max3_f32 v26, v26, v111, v127
v_mfma_f32_32x32x16_bf16 v[160:175], a[120:123], v[236:239], v[160:175]
s_waitcnt lgkmcnt(15)
v_mfma_f32_32x32x16_bf16 v[176:191], a[124:127], v[236:239], v[176:191]
v_max_f32 v26, v26, v27
v_cmp_lt_f32 vcc, s51, v26
s_cbranch_vccz L_norare_2
s_call_b64 s[46:47], L_rare1
L_norare_2:
s_waitcnt lgkmcnt(0)
s_barrier
v_mfma_f32_32x32x16_bf16 v[64:79], a[128:131], a[64:67], v[48:63]
ds_read_b128 v[224:227], v17 offset:0
ds_read_b64_tr_b16 v[192:193], v13 offset:32768
v_exp_f32 v96, v96
v_exp_f32 v97, v97
v_mfma_f32_32x32x16_bf16 v[64:79], a[132:135], a[68:71], v[64:79]
ds_read_b64_tr_b16 v[194:195], v13 offset:33792
ds_read_b64_tr_b16 v[196:197], v14 offset:32768
ds_read_b64_tr_b16 v[198:199], v14 offset:33792
v_exp_f32 v98, v98
v_exp_f32 v99, v99
v_mfma_f32_32x32x16_bf16 v[64:79], a[136:139], a[72:75], v[64:79]
ds_read_b64_tr_b16 v[200:201], v15 offset:32768
ds_read_b64_tr_b16 v[202:203], v15 offset:33792
v_add_f32 v24, v24, v96
v_add_f32 v25, v25, v97
v_cvt_pk_bf16_f32 v32, v96, v97
v_mfma_f32_32x32x16_bf16 v[64:79], a[140:143], a[76:79], v[64:79]
ds_read_b64_tr_b16 v[204:205], v16 offset:32768
ds_read_b64_tr_b16 v[206:207], v16 offset:33792
v_exp_f32 v100, v100
v_exp_f32 v101, v101
v_mfma_f32_32x32x16_bf16 v[64:79], a[144:147], a[80:83], v[64:79]
ds_read_b128 v[228:231], v18 offset:0
ds_read_b64_tr_b16 v[208:209], v13 offset:36864
v_add_f32 v24, v24, v98
v_add_f32 v25, v25, v99
v_cvt_pk_bf16_f32 v33, v98, v99
v_mfma_f32_32x32x16_bf16 v[64:79], a[148:151], a[84:87], v[64:79]
ds_read_b64_tr_b16 v[210:211], v13 offset:37888
ds_read_b64_tr_b16 v[212:213], v14 offset:36864
ds_read_b64_tr_b16 v[214:215], v14 offset:37888
v_exp_f32 v102, v102
v_exp_f32 v103, v103
v_mfma_f32_32x32x16_bf16 v[64:79], a[152:155], a[88:91], v[64:79]
ds_read_b64_tr_b16 v[216:217], v15 offset:36864
ds_read_b64_tr_b16 v[218:219], v15 offset:37888
v_add_f32 v24, v24, v100
v_add_f32 v25, v25, v101
v_cvt_pk_bf16_f32 v34, v100, v101
v_mfma_f32_32x32x16_bf16 v[64:79], a[156:159], a[92:95], v[64:79]
ds_read_b64_tr_b16 v[220:221], v16 offset:36864
ds_read_b64_tr_b16 v[222:223], v16 offset:37888
v_exp_f32 v104, v104
v_exp_f32 v105, v105
v_mfma_f32_32x32x16_bf16 v[80:95], a[160:163], a[64:67], v[48:63]
ds_read_b64_tr_b16 a[192:193], v9 offset:16384
ds_read_b64_tr_b16 a[194:195], v9 offset:18432
v_add_f32 v24, v24, v102
v_add_f32 v25, v25, v103
v_cvt_pk_bf16_f32 v35, v102, v103
v_mfma_f32_32x32x16_bf16 v[80:95], a[164:167], a[68:71], v[80:95]
ds_read_b64_tr_b16 a[196:197], v10 offset:16384
ds_read_b64_tr_b16 a[198:199], v10 offset:18432
ds_read_b64_tr_b16 a[200:201], v11 offset:16384
v_exp_f32 v106, v106
v_exp_f32 v107, v107
v_mfma_f32_32x32x16_bf16 v[80:95], a[168:171], a[72:75], v[80:95]
ds_read_b64_tr_b16 a[202:203], v11 offset:18432
ds_read_b64_tr_b16 a[204:205], v12 offset:16384
v_add_f32 v24, v24, v104
v_add_f32 v25, v25, v105
v_cvt_pk_bf16_f32 v36, v104, v105
v_mfma_f32_32x32x16_bf16 v[80:95], a[172:175], a[76:79], v[80:95]
ds_read_b64_tr_b16 a[206:207], v12 offset:18432
ds_read_b64_tr_b16 a[208:209], v9 offset:20480
v_exp_f32 v108, v108
v_exp_f32 v109, v109
v_mfma_f32_32x32x16_bf16 v[80:95], a[176:179], a[80:83], v[80:95]
ds_read_b64_tr_b16 a[210:211], v9 offset:22528
ds_read_b64_tr_b16 a[212:213], v10 offset:20480
ds_read_b64_tr_b16 a[214:215], v10 offset:22528
v_add_f32 v24, v24, v106
v_add_f32 v25, v25, v107
v_cvt_pk_bf16_f32 v37, v106, v107
v_mfma_f32_32x32x16_bf16 v[80:95], a[180:183], a[84:87], v[80:95]
ds_read_b64_tr_b16 a[216:217], v11 offset:20480
ds_read_b64_tr_b16 a[218:219], v11 offset:22528
v_exp_f32 v110, v110
v_exp_f32 v111, v111
v_mfma_f32_32x32x16_bf16 v[80:95], a[184:187], a[88:91], v[80:95]
ds_read_b64_tr_b16 a[220:221], v12 offset:20480
ds_read_b64_tr_b16 a[222:223], v12 offset:22528
v_add_f32 v24, v24, v108
v_add_f32 v25, v25, v109
v_cvt_pk_bf16_f32 v38, v108, v109
v_mfma_f32_32x32x16_bf16 v[80:95], a[188:191], a[92:95], v[80:95]
ds_read_b64_tr_b16 a[224:225], v9 offset:24576
ds_read_b64_tr_b16 a[226:227], v9 offset:26624
v_exp_f32 v112, v112
v_exp_f32 v113, v113
s_waitcnt lgkmcnt(15)
v_mfma_f32_32x32x16_bf16 v[128:143], v[192:195], v[224:227], v[128:143]
ds_read_b64_tr_b16 a[228:229], v10 offset:24576
ds_read_b64_tr_b16 a[230:231], v10 offset:26624
ds_read_b64_tr_b16 a[232:233], v11 offset:24576
v_add_f32 v24, v24, v110
v_add_f32 v25, v25, v111
v_cvt_pk_bf16_f32 v39, v110, v111
v_mfma_f32_32x32x16_bf16 v[144:159], v[196:199], v[224:227], v[144:159]
ds_read_b64_tr_b16 a[234:235], v11 offset:26624
ds_read_b64_tr_b16 a[236:237], v12 offset:24576
v_exp_f32 v114, v114
v_exp_f32 v115, v115
v_mfma_f32_32x32x16_bf16 v[160:175], v[200:203], v[224:227], v[160:175]
ds_read_b64_tr_b16 a[238:239], v12 offset:26624
ds_read_b64_tr_b16 a[240:241], v9 offset:28672
v_add_f32 v24, v24, v112
v_add_f32 v25, v25, v113
v_cvt_pk_bf16_f32 v40, v112, v113
v_mfma_f32_32x32x16_bf16 v[176:191], v[204:207], v[224:227], v[176:191]
ds_read_b64_tr_b16 a[242:243], v9 offset:30720
ds_read_b64_tr_b16 a[244:245], v10 offset:28672
v_exp_f32 v116, v116
v_exp_f32 v117, v117
v_mfma_f32_32x32x16_bf16 v[128:143], v[208:211], v[228:231], v[128:143]
ds_read_b64_tr_b16 a[246:247], v10 offset:30720
ds_read_b64_tr_b16 a[248:249], v11 offset:28672
ds_read_b64_tr_b16 a[250:251], v11 offset:30720
v_add_f32 v24, v24, v114
v_add_f32 v25, v25, v115
v_cvt_pk_bf16_f32 v41, v114, v115
v_mfma_f32_32x32x16_bf16 v[144:159], v[212:215], v[228:231], v[144:159]
ds_read_b64_tr_b16 a[252:253], v12 offset:28672
ds_read_b64_tr_b16 a[254:255], v12 offset:30720
v_exp_f32 v118, v118
v_exp_f32 v119, v119
v_mfma_f32_32x32x16_bf16 v[160:175], v[216:219], v[228:231], v[160:175]
v_add_f32 v24, v24, v116
v_add_f32 v25, v25, v117
v_cvt_pk_bf16_f32 v42, v116, v117
v_mfma_f32_32x32x16_bf16 v[176:191], v[220:223], v[228:231], v[176:191]
s_nop 0
v_add_f32 v24, v24, v118
v_add_f32 v25, v25, v119
v_cvt_pk_bf16_f32 v43, v118, v119
s_waitcnt lgkmcnt(0)
s_barrier
v_mfma_f32_32x32x16_bf16 a[0:15], a[192:195], v[32:35], a[0:15]
ds_read_b128 v[224:227], v19 offset:0
ds_read_b64_tr_b16 v[192:193], v13 offset:0
v_exp_f32 v120, v120
v_mfma_f32_32x32x16_bf16 a[16:31], a[196:199], v[32:35], a[16:31]
ds_read_b64_tr_b16 v[194:195], v13 offset:1024
v_exp_f32 v121, v121
v_exp_f32 v122, v122
v_mfma_f32_32x32x16_bf16 a[32:47], a[200:203], v[32:35], a[32:47]
ds_read_b64_tr_b16 v[196:197], v14 offset:0
ds_read_b64_tr_b16 v[198:199], v14 offset:1024
v_exp_f32 v123, v123
v_add_f32 v24, v24, v120
v_mfma_f32_32x32x16_bf16 a[48:63], a[204:207], v[32:35], a[48:63]
ds_read_b64_tr_b16 v[200:201], v15 offset:0
ds_read_b64_tr_b16 v[202:203], v15 offset:1024
v_add_f32 v25, v25, v121
v_cvt_pk_bf16_f32 v44, v120, v121
v_mfma_f32_32x32x16_bf16 a[0:15], a[208:211], v[36:39], a[0:15]
ds_read_b64_tr_b16 v[204:205], v16 offset:0
ds_read_b64_tr_b16 v[206:207], v16 offset:1024
v_exp_f32 v124, v124
v_exp_f32 v125, v125
v_mfma_f32_32x32x16_bf16 a[16:31], a[212:215], v[36:39], a[16:31]
ds_read_b128 v[228:231], v20 offset:0
v_add_f32 v24, v24, v122
v_add_f32 v25, v25, v123
v_mfma_f32_32x32x16_bf16 a[32:47], a[216:219], v[36:39], a[32:47]
ds_read_b64_tr_b16 v[208:209], v13 offset:4096
ds_read_b64_tr_b16 v[210:211], v13 offset:5120
v_cvt_pk_bf16_f32 v45, v122, v123
v_exp_f32 v126, v126
v_mfma_f32_32x32x16_bf16 a[48:63], a[220:223], v[36:39], a[48:63]
ds_read_b64_tr_b16 v[212:213], v14 offset:4096
ds_read_b64_tr_b16 v[214:215], v14 offset:5120
v_exp_f32 v127, v127
v_add_f32 v24, v24, v124
v_mfma_f32_32x32x16_bf16 a[0:15], a[224:227], v[40:43], a[0:15]
ds_read_b64_tr_b16 v[216:217], v15 offset:4096
ds_read_b64_tr_b16 v[218:219], v15 offset:5120
v_add_f32 v25, v25, v125
v_cvt_pk_bf16_f32 v46, v124, v125
s_nop 0
v_mfma_f32_32x32x16_bf16 a[16:31], a[228:231], v[40:43], a[16:31]
ds_read_b64_tr_b16 v[220:221], v16 offset:4096
v_add_f32 v24, v24, v126
v_add_f32 v25, v25, v127
v_cvt_pk_bf16_f32 v47, v126, v127
v_mfma_f32_32x32x16_bf16 a[32:47], a[232:235], v[40:43], a[32:47]
ds_read_b64_tr_b16 v[222:223], v16 offset:5120
ds_read_b128 v[232:235], v17 offset:12288
v_max3_f32 v26, v64, v65, v66
v_mfma_f32_32x32x16_bf16 a[48:63], a[236:239], v[40:43], a[48:63]
ds_read_b64_tr_b16 a[96:97], v13 offset:8192
ds_read_b64_tr_b16 a[98:99], v13 offset:9216
v_mfma_f32_32x32x16_bf16 a[0:15], a[240:243], v[44:47], a[0:15]
ds_read_b64_tr_b16 a[100:101], v14 offset:8192
ds_read_b64_tr_b16 a[102:103], v14 offset:9216
v_max3_f32 v26, v26, v67, v68
v_mfma_f32_32x32x16_bf16 a[16:31], a[244:247], v[44:47], a[16:31]
ds_read_b64_tr_b16 a[104:105], v15 offset:8192
v_max3_f32 v26, v26, v69, v70
v_mfma_f32_32x32x16_bf16 a[32:47], a[248:251], v[44:47], a[32:47]
ds_read_b64_tr_b16 a[106:107], v15 offset:9216
ds_read_b64_tr_b16 a[108:109], v16 offset:8192
v_max3_f32 v26, v26, v71, v72
v_mfma_f32_32x32x16_bf16 a[48:63], a[252:255], v[44:47], a[48:63]
ds_read_b64_tr_b16 a[110:111], v16 offset:9216
ds_read_b128 v[236:239], v18 offset:12288
s_waitcnt lgkmcnt(15)
v_mfma_f32_32x32x16_bf16 v[128:143], v[192:195], v[224:227], v[128:143]
ds_read_b64_tr_b16 a[112:113], v13 offset:12288
v_max3_f32 v26, v26, v73, v74
v_mfma_f32_32x32x16_bf16 v[144:159], v[196:199], v[224:227], v[144:159]
ds_read_b64_tr_b16 a[114:115], v13 offset:13312
ds_read_b64_tr_b16 a[116:117], v14 offset:12288
v_max3_f32 v26, v26, v75, v76
v_mfma_f32_32x32x16_bf16 v[160:175], v[200:203], v[224:227], v[160:175]
ds_read_b64_tr_b16 a[118:119], v14 offset:13312
ds_read_b64_tr_b16 a[120:121], v15 offset:12288
v_max3_f32 v26, v26, v77, v78
v_mfma_f32_32x32x16_bf16 v[176:191], v[204:207], v[224:227], v[176:191]
ds_read_b64_tr_b16 a[122:123], v15 offset:13312
ds_read_b64_tr_b16 a[124:125], v16 offset:12288
v_mfma_f32_32x32x16_bf16 v[128:143], v[208:211], v[228:231], v[128:143]
ds_read_b64_tr_b16 a[126:127], v16 offset:13312
v_max3_f32 v27, v80, v81, v82
s_waitcnt lgkmcnt(15)
v_mfma_f32_32x32x16_bf16 v[144:159], v[212:215], v[228:231], v[144:159]
ds_read_b128 a[128:131], v1 offset:0
ds_read_b128 a[132:135], v2 offset:0
v_max3_f32 v27, v27, v83, v84
v_mfma_f32_32x32x16_bf16 v[160:175], v[216:219], v[228:231], v[160:175]
ds_read_b128 a[136:139], v3 offset:0
ds_read_b128 a[140:143], v4 offset:0
v_mfma_f32_32x32x16_bf16 v[176:191], v[220:223], v[228:231], v[176:191]
ds_read_b128 a[144:147], v5 offset:0
ds_read_b128 a[148:151], v6 offset:0
v_max3_f32 v27, v27, v85, v86
v_mfma_f32_32x32x16_bf16 v[128:143], a[96:99], v[232:235], v[128:143]
ds_read_b128 a[152:155], v7 offset:0
v_max3_f32 v27, v27, v87, v88
s_waitcnt lgkmcnt(15)
v_mfma_f32_32x32x16_bf16 v[144:159], a[100:103], v[232:235], v[144:159]
ds_read_b128 a[156:159], v8 offset:0
ds_read_b128 a[160:163], v1 offset:8192
v_max3_f32 v27, v27, v89, v90
v_mfma_f32_32x32x16_bf16 v[160:175], a[104:107], v[232:235], v[160:175]
ds_read_b128 a[164:167], v2 offset:8192
ds_read_b128 a[168:171], v3 offset:8192
v_mfma_f32_32x32x16_bf16 v[176:191], a[108:111], v[232:235], v[176:191]
ds_read_b128 a[172:175], v4 offset:8192
ds_read_b128 a[176:179], v5 offset:8192
v_max3_f32 v27, v27, v91, v92
s_waitcnt lgkmcnt(15)
v_mfma_f32_32x32x16_bf16 v[128:143], a[112:115], v[236:239], v[128:143]
ds_read_b128 a[180:183], v6 offset:8192
v_max3_f32 v27, v27, v93, v94
v_mfma_f32_32x32x16_bf16 v[144:159], a[116:119], v[236:239], v[144:159]
ds_read_b128 a[184:187], v7 offset:8192
ds_read_b128 a[188:191], v8 offset:8192
v_max3_f32 v26, v26, v79, v95
v_mfma_f32_32x32x16_bf16 v[160:175], a[120:123], v[236:239], v[160:175]
s_waitcnt lgkmcnt(15)
v_mfma_f32_32x32x16_bf16 v[176:191], a[124:127], v[236:239], v[176:191]
v_max_f32 v26, v26, v27
v_cmp_lt_f32 vcc, s51, v26
s_cbranch_vccz L_norare_3
s_call_b64 s[46:47], L_rare0
L_norare_3:
s_waitcnt lgkmcnt(0)
s_barrier
v_mfma_f32_32x32x16_bf16 v[96:111], a[128:131], a[64:67], v[48:63]
ds_read_b128 v[224:227], v19 offset:12288
ds_read_b64_tr_b16 v[192:193], v13 offset:16384
v_exp_f32 v64, v64
v_exp_f32 v65, v65
v_mfma_f32_32x32x16_bf16 v[96:111], a[132:135], a[68:71], v[96:111]
ds_read_b64_tr_b16 v[194:195], v13 offset:17408
ds_read_b64_tr_b16 v[196:197], v14 offset:16384
ds_read_b64_tr_b16 v[198:199], v14 offset:17408
v_exp_f32 v66, v66
v_exp_f32 v67, v67
v_mfma_f32_32x32x16_bf16 v[96:111], a[136:139], a[72:75], v[96:111]
ds_read_b64_tr_b16 v[200:201], v15 offset:16384
ds_read_b64_tr_b16 v[202:203], v15 offset:17408
v_add_f32 v24, v24, v64
v_add_f32 v25, v25, v65
v_cvt_pk_bf16_f32 v32, v64, v65
v_mfma_f32_32x32x16_bf16 v[96:111], a[140:143], a[76:79], v[96:111]
ds_read_b64_tr_b16 v[204:205], v16 offset:16384
ds_read_b64_tr_b16 v[206:207], v16 offset:17408
v_exp_f32 v68, v68
v_exp_f32 v69, v69
v_mfma_f32_32x32x16_bf16 v[96:111], a[144:147], a[80:83], v[96:111]
ds_read_b128 v[228:231], v20 offset:12288
ds_read_b64_tr_b16 v[208:209], v13 offset:20480
v_add_f32 v24, v24, v66
v_add_f32 v25, v25, v67
v_cvt_pk_bf16_f32 v33, v66, v67
v_mfma_f32_32x32x16_bf16 v[96:111], a[148:151], a[84:87], v[96:111]
ds_read_b64_tr_b16 v[210:211], v13 offset:21504
ds_read_b64_tr_b16 v[212:213], v14 offset:20480
ds_read_b64_tr_b16 v[214:215], v14 offset:21504
v_exp_f32 v70, v70
v_exp_f32 v71, v71
v_mfma_f32_32x32x16_bf16 v[96:111], a[152:155], a[88:91], v[96:111]
ds_read_b64_tr_b16 v[216:217], v15 offset:20480
ds_read_b64_tr_b16 v[218:219], v15 offset:21504
v_add_f32 v24, v24, v68
v_add_f32 v25, v25, v69
v_cvt_pk_bf16_f32 v34, v68, v69
v_mfma_f32_32x32x16_bf16 v[96:111], a[156:159], a[92:95], v[96:111]
ds_read_b64_tr_b16 v[220:221], v16 offset:20480
ds_read_b64_tr_b16 v[222:223], v16 offset:21504
v_exp_f32 v72, v72
v_exp_f32 v73, v73
v_mfma_f32_32x32x16_bf16 v[112:127], a[160:163], a[64:67], v[48:63]
ds_read_b64_tr_b16 a[192:193], v9 offset:0
ds_read_b64_tr_b16 a[194:195], v9 offset:2048
v_add_f32 v24, v24, v70
v_add_f32 v25, v25, v71
v_cvt_pk_bf16_f32 v35, v70, v71
v_mfma_f32_32x32x16_bf16 v[112:127], a[164:167], a[68:71], v[112:127]
ds_read_b64_tr_b16 a[196:197], v10 offset:0
ds_read_b64_tr_b16 a[198:199], v10 offset:2048
ds_read_b64_tr_b16 a[200:201], v11 offset:0
v_exp_f32 v74, v74
v_exp_f32 v75, v75
v_mfma_f32_32x32x16_bf16 v[112:127], a[168:171], a[72:75], v[112:127]
ds_read_b64_tr_b16 a[202:203], v11 offset:2048
ds_read_b64_tr_b16 a[204:205], v12 offset:0
v_add_f32 v24, v24, v72
v_add_f32 v25, v25, v73
v_cvt_pk_bf16_f32 v36, v72, v73
v_mfma_f32_32x32x16_bf16 v[112:127], a[172:175], a[76:79], v[112:127]
ds_read_b64_tr_b16 a[206:207], v12 offset:2048
ds_read_b64_tr_b16 a[208:209], v9 offset:4096
v_exp_f32 v76, v76
v_exp_f32 v77, v77
v_mfma_f32_32x32x16_bf16 v[112:127], a[176:179], a[80:83], v[112:127]
ds_read_b64_tr_b16 a[210:211], v9 offset:6144
ds_read_b64_tr_b16 a[212:213], v10 offset:4096
ds_read_b64_tr_b16 a[214:215], v10 offset:6144
v_add_f32 v24, v24, v74
v_add_f32 v25, v25, v75
v_cvt_pk_bf16_f32 v37, v74, v75
v_mfma_f32_32x32x16_bf16 v[112:127], a[180:183], a[84:87], v[112:127]
ds_read_b64_tr_b16 a[216:217], v11 offset:4096
ds_read_b64_tr_b16 a[218:219], v11 offset:6144
v_exp_f32 v78, v78
v_exp_f32 v79, v79
v_mfma_f32_32x32x16_bf16 v[112:127], a[184:187], a[88:91], v[112:127]
ds_read_b64_tr_b16 a[220:221], v12 offset:4096
ds_read_b64_tr_b16 a[222:223], v12 offset:6144
v_add_f32 v24, v24, v76
v_add_f32 v25, v25, v77
v_cvt_pk_bf16_f32 v38, v76, v77
v_mfma_f32_32x32x16_bf16 v[112:127], a[188:191], a[92:95], v[112:127]
ds_read_b64_tr_b16 a[224:225], v9 offset:8192
ds_read_b64_tr_b16 a[226:227], v9 offset:10240
v_exp_f32 v80, v80
v_exp_f32 v81, v81
s_waitcnt lgkmcnt(15)
v_mfma_f32_32x32x16_bf16 v[128:143], v[192:195], v[224:227], v[128:143]
ds_read_b64_tr_b16 a[228:229], v10 offset:8192
ds_read_b64_tr_b16 a[230:231], v10 offset:10240
ds_read_b64_tr_b16 a[232:233], v11 offset:8192
v_add_f32 v24, v24, v78
v_add_f32 v25, v25, v79
v_cvt_pk_bf16_f32 v39, v78, v79
v_mfma_f32_32x32x16_bf16 v[144:159], v[196:199], v[224:227], v[144:159]
ds_read_b64_tr_b16 a[234:235], v11 offset:10240
ds_read_b64_tr_b16 a[236:237], v12 offset:8192
v_exp_f32 v82, v82
v_exp_f32 v83, v83
v_mfma_f32_32x32x16_bf16 v[160:175], v[200:203], v[224:227], v[160:175]
ds_read_b64_tr_b16 a[238:239], v12 offset:10240
ds_read_b64_tr_b16 a[240:241], v9 offset:12288
v_add_f32 v24, v24, v80
v_add_f32 v25, v25, v81
v_cvt_pk_bf16_f32 v40, v80, v81
v_mfma_f32_32x32x16_bf16 v[176:191], v[204:207], v[224:227], v[176:191]
ds_read_b64_tr_b16 a[242:243], v9 offset:14336
ds_read_b64_tr_b16 a[244:245], v10 offset:12288
v_exp_f32 v84, v84
v_exp_f32 v85, v85
v_mfma_f32_32x32x16_bf16 v[128:143], v[208:211], v[228:231], v[128:143]
ds_read_b64_tr_b16 a[246:247], v10 offset:14336
ds_read_b64_tr_b16 a[248:249], v11 offset:12288
ds_read_b64_tr_b16 a[250:251], v11 offset:14336
v_add_f32 v24, v24, v82
v_add_f32 v25, v25, v83
v_cvt_pk_bf16_f32 v41, v82, v83
v_mfma_f32_32x32x16_bf16 v[144:159], v[212:215], v[228:231], v[144:159]
ds_read_b64_tr_b16 a[252:253], v12 offset:12288
ds_read_b64_tr_b16 a[254:255], v12 offset:14336
v_exp_f32 v86, v86
v_exp_f32 v87, v87
v_mfma_f32_32x32x16_bf16 v[160:175], v[216:219], v[228:231], v[160:175]
v_add_f32 v24, v24, v84
v_add_f32 v25, v25, v85
v_cvt_pk_bf16_f32 v42, v84, v85
v_mfma_f32_32x32x16_bf16 v[176:191], v[220:223], v[228:231], v[176:191]
s_nop 0
v_add_f32 v24, v24, v86
v_add_f32 v25, v25, v87
v_cvt_pk_bf16_f32 v43, v86, v87
s_waitcnt lgkmcnt(0)
s_barrier
v_mfma_f32_32x32x16_bf16 a[0:15], a[192:195], v[32:35], a[0:15]
ds_read_b128 v[224:227], v17 offset:24576
ds_read_b64_tr_b16 v[192:193], v13 offset:24576
v_exp_f32 v88, v88
v_mfma_f32_32x32x16_bf16 a[16:31], a[196:199], v[32:35], a[16:31]
ds_read_b64_tr_b16 v[194:195], v13 offset:25600
v_exp_f32 v89, v89
v_exp_f32 v90, v90
v_mfma_f32_32x32x16_bf16 a[32:47], a[200:203], v[32:35], a[32:47]
ds_read_b64_tr_b16 v[196:197], v14 offset:24576
ds_read_b64_tr_b16 v[198:199], v14 offset:25600
v_exp_f32 v91, v91
v_add_f32 v24, v24, v88
v_mfma_f32_32x32x16_bf16 a[48:63], a[204:207], v[32:35], a[48:63]
ds_read_b64_tr_b16 v[200:201], v15 offset:24576
ds_read_b64_tr_b16 v[202:203], v15 offset:25600
v_add_f32 v25, v25, v89
v_cvt_pk_bf16_f32 v44, v88, v89
v_mfma_f32_32x32x16_bf16 a[0:15], a[208:211], v[36:39], a[0:15]
ds_read_b64_tr_b16 v[204:205], v16 offset:24576
ds_read_b64_tr_b16 v[206:207], v16 offset:25600
v_exp_f32 v92, v92
v_exp_f32 v93, v93
v_mfma_f32_32x32x16_bf16 a[16:31], a[212:215], v[36:39], a[16:31]
ds_read_b128 v[228:231], v18 offset:24576
v_add_f32 v24, v24, v90
v_add_f32 v25, v25, v91
v_mfma_f32_32x32x16_bf16 a[32:47], a[216:219], v[36:39], a[32:47]
ds_read_b64_tr_b16 v[208:209], v13 offset:28672
ds_read_b64_tr_b16 v[210:211], v13 offset:29696
v_cvt_pk_bf16_f32 v45, v90, v91
v_exp_f32 v94, v94
v_mfma_f32_32x32x16_bf16 a[48:63], a[220:223], v[36:39], a[48:63]
ds_read_b64_tr_b16 v[212:213], v14 offset:28672
ds_read_b64_tr_b16 v[214:215], v14 offset:29696
v_exp_f32 v95, v95
v_add_f32 v24, v24, v92
v_mfma_f32_32x32x16_bf16 a[0:15], a[224:227], v[40:43], a[0:15]
ds_read_b64_tr_b16 v[216:217], v15 offset:28672
ds_read_b64_tr_b16 v[218:219], v15 offset:29696
v_add_f32 v25, v25, v93
v_cvt_pk_bf16_f32 v46, v92, v93
s_nop 0
v_mfma_f32_32x32x16_bf16 a[16:31], a[228:231], v[40:43], a[16:31]
ds_read_b64_tr_b16 v[220:221], v16 offset:28672
v_add_f32 v24, v24, v94
v_add_f32 v25, v25, v95
v_cvt_pk_bf16_f32 v47, v94, v95
v_mfma_f32_32x32x16_bf16 a[32:47], a[232:235], v[40:43], a[32:47]
ds_read_b64_tr_b16 v[222:223], v16 offset:29696
ds_read_b128 v[232:235], v19 offset:24576
v_max3_f32 v26, v96, v97, v98
v_mfma_f32_32x32x16_bf16 a[48:63], a[236:239], v[40:43], a[48:63]
ds_read_b64_tr_b16 a[96:97], v13 offset:32768
ds_read_b64_tr_b16 a[98:99], v13 offset:33792
v_mfma_f32_32x32x16_bf16 a[0:15], a[240:243], v[44:47], a[0:15]
ds_read_b64_tr_b16 a[100:101], v14 offset:32768
ds_read_b64_tr_b16 a[102:103], v14 offset:33792
v_max3_f32 v26, v26, v99, v100
v_mfma_f32_32x32x16_bf16 a[16:31], a[244:247], v[44:47], a[16:31]
ds_read_b64_tr_b16 a[104:105], v15 offset:32768
v_max3_f32 v26, v26, v101, v102
v_mfma_f32_32x32x16_bf16 a[32:47], a[248:251], v[44:47], a[32:47]
ds_read_b64_tr_b16 a[106:107], v15 offset:33792
ds_read_b64_tr_b16 a[108:109], v16 offset:32768
v_max3_f32 v26, v26, v103, v104
v_mfma_f32_32x32x16_bf16 a[48:63], a[252:255], v[44:47], a[48:63]
ds_read_b64_tr_b16 a[110:111], v16 offset:33792
ds_read_b128 v[236:239], v20 offset:24576
s_waitcnt lgkmcnt(15)
v_mfma_f32_32x32x16_bf16 v[128:143], v[192:195], v[224:227], v[128:143]
ds_read_b64_tr_b16 a[112:113], v13 offset:36864
v_max3_f32 v26, v26, v105, v106
v_mfma_f32_32x32x16_bf16 v[144:159], v[196:199], v[224:227], v[144:159]
ds_read_b64_tr_b16 a[114:115], v13 offset:37888
ds_read_b64_tr_b16 a[116:117], v14 offset:36864
v_max3_f32 v26, v26, v107, v108
v_mfma_f32_32x32x16_bf16 v[160:175], v[200:203], v[224:227], v[160:175]
ds_read_b64_tr_b16 a[118:119], v14 offset:37888
ds_read_b64_tr_b16 a[120:121], v15 offset:36864
v_max3_f32 v26, v26, v109, v110
v_mfma_f32_32x32x16_bf16 v[176:191], v[204:207], v[224:227], v[176:191]
ds_read_b64_tr_b16 a[122:123], v15 offset:37888
ds_read_b64_tr_b16 a[124:125], v16 offset:36864
v_mfma_f32_32x32x16_bf16 v[128:143], v[208:211], v[228:231], v[128:143]
ds_read_b64_tr_b16 a[126:127], v16 offset:37888
v_max3_f32 v27, v112, v113, v114
s_waitcnt lgkmcnt(15)
v_mfma_f32_32x32x16_bf16 v[144:159], v[212:215], v[228:231], v[144:159]
ds_read_b128 a[128:131], v1 offset:16384
ds_read_b128 a[132:135], v2 offset:16384
v_max3_f32 v27, v27, v115, v116
v_mfma_f32_32x32x16_bf16 v[160:175], v[216:219], v[228:231], v[160:175]
ds_read_b128 a[136:139], v3 offset:16384
ds_read_b128 a[140:143], v4 offset:16384
v_mfma_f32_32x32x16_bf16 v[176:191], v[220:223], v[228:231], v[176:191]
ds_read_b128 a[144:147], v5 offset:16384
ds_read_b128 a[148:151], v6 offset:16384
v_max3_f32 v27, v27, v117, v118
v_mfma_f32_32x32x16_bf16 v[128:143], a[96:99], v[232:235], v[128:143]
ds_read_b128 a[152:155], v7 offset:16384
v_max3_f32 v27, v27, v119, v120
s_waitcnt lgkmcnt(15)
v_mfma_f32_32x32x16_bf16 v[144:159], a[100:103], v[232:235], v[144:159]
ds_read_b128 a[156:159], v8 offset:16384
ds_read_b128 a[160:163], v1 offset:24576
v_max3_f32 v27, v27, v121, v122
v_mfma_f32_32x32x16_bf16 v[160:175], a[104:107], v[232:235], v[160:175]
ds_read_b128 a[164:167], v2 offset:24576
ds_read_b128 a[168:171], v3 offset:24576
v_mfma_f32_32x32x16_bf16 v[176:191], a[108:111], v[232:235], v[176:191]
ds_read_b128 a[172:175], v4 offset:24576
ds_read_b128 a[176:179], v5 offset:24576
v_max3_f32 v27, v27, v123, v124
s_waitcnt lgkmcnt(15)
v_mfma_f32_32x32x16_bf16 v[128:143], a[112:115], v[236:239], v[128:143]
ds_read_b128 a[180:183], v6 offset:24576
v_max3_f32 v27, v27, v125, v126
v_mfma_f32_32x32x16_bf16 v[144:159], a[116:119], v[236:239], v[144:159]
ds_read_b128 a[184:187], v7 offset:24576
ds_read_b128 a[188:191], v8 offset:24576
v_max3_f32 v26, v26, v111, v127
v_mfma_f32_32x32x16_bf16 v[160:175], a[120:123], v[236:239], v[160:175]
s_waitcnt lgkmcnt(15)
v_mfma_f32_32x32x16_bf16 v[176:191], a[124:127], v[236:239], v[176:191]
v_max_f32 v26, v26, v27
v_cmp_lt_f32 vcc, s51, v26
s_cbranch_vccz L_norare_4
s_call_b64 s[46:47], L_rare1
L_norare_4:
s_waitcnt lgkmcnt(0)
s_barrier
v_mfma_f32_32x32x16_bf16 v[64:79], a[128:131], a[64:67], v[48:63]
ds_read_b128 v[224:227], v17 offset:0
ds_read_b64_tr_b16 v[192:193], v13 offset:0
v_exp_f32 v96, v96
v_exp_f32 v97, v97
v_mfma_f32_32x32x16_bf16 v[64:79], a[132:135], a[68:71], v[64:79]
ds_read_b64_tr_b16 v[194:195], v13 offset:1024
ds_read_b64_tr_b16 v[196:197], v14 offset:0
ds_read_b64_tr_b16 v[198:199], v14 offset:1024
v_exp_f32 v98, v98
v_exp_f32 v99, v99
v_mfma_f32_32x32x16_bf16 v[64:79], a[136:139], a[72:75], v[64:79]
ds_read_b64_tr_b16 v[200:201], v15 offset:0
ds_read_b64_tr_b16 v[202:203], v15 offset:1024
v_add_f32 v24, v24, v96
v_add_f32 v25, v25, v97
v_cvt_pk_bf16_f32 v32, v96, v97
v_mfma_f32_32x32x16_bf16 v[64:79], a[140:143], a[76:79], v[64:79]
ds_read_b64_tr_b16 v[204:205], v16 offset:0
ds_read_b64_tr_b16 v[206:207], v16 offset:1024
v_exp_f32 v100, v100
v_exp_f32 v101, v101
v_mfma_f32_32x32x16_bf16 v[64:79], a[144:147], a[80:83], v[64:79]
ds_read_b128 v[228:231], v18 offset:0
ds_read_b64_tr_b16 v[208:209], v13 offset:4096
v_add_f32 v24, v24, v98
v_add_f32 v25, v25, v99
v_cvt_pk_bf16_f32 v33, v98, v99
v_mfma_f32_32x32x16_bf16 v[64:79], a[148:151], a[84:87], v[64:79]
ds_read_b64_tr_b16 v[210:211], v13 offset:5120
ds_read_b64_tr_b16 v[212:213], v14 offset:4096
ds_read_b64_tr_b16 v[214:215], v14 offset:5120
v_exp_f32 v102, v102
v_exp_f32 v103, v103
v_mfma_f32_32x32x16_bf16 v[64:79], a[152:155], a[88:91], v[64:79]
ds_read_b64_tr_b16 v[216:217], v15 offset:4096
ds_read_b64_tr_b16 v[218:219], v15 offset:5120
v_add_f32 v24, v24, v100
v_add_f32 v25, v25, v101
v_cvt_pk_bf16_f32 v34, v100, v101
v_mfma_f32_32x32x16_bf16 v[64:79], a[156:159], a[92:95], v[64:79]
ds_read_b64_tr_b16 v[220:221], v16 offset:4096
ds_read_b64_tr_b16 v[222:223], v16 offset:5120
v_exp_f32 v104, v104
v_exp_f32 v105, v105
v_mfma_f32_32x32x16_bf16 v[80:95], a[160:163], a[64:67], v[48:63]
ds_read_b64_tr_b16 a[192:193], v9 offset:16384
ds_read_b64_tr_b16 a[194:195], v9 offset:18432
v_add_f32 v24, v24, v102
v_add_f32 v25, v25, v103
v_cvt_pk_bf16_f32 v35, v102, v103
v_mfma_f32_32x32x16_bf16 v[80:95], a[164:167], a[68:71], v[80:95]
ds_read_b64_tr_b16 a[196:197], v10 offset:16384
ds_read_b64_tr_b16 a[198:199], v10 offset:18432
ds_read_b64_tr_b16 a[200:201], v11 offset:16384
v_exp_f32 v106, v106
v_exp_f32 v107, v107
v_mfma_f32_32x32x16_bf16 v[80:95], a[168:171], a[72:75], v[80:95]
ds_read_b64_tr_b16 a[202:203], v11 offset:18432
ds_read_b64_tr_b16 a[204:205], v12 offset:16384
v_add_f32 v24, v24, v104
v_add_f32 v25, v25, v105
v_cvt_pk_bf16_f32 v36, v104, v105
v_mfma_f32_32x32x16_bf16 v[80:95], a[172:175], a[76:79], v[80:95]
ds_read_b64_tr_b16 a[206:207], v12 offset:18432
ds_read_b64_tr_b16 a[208:209], v9 offset:20480
v_exp_f32 v108, v108
v_exp_f32 v109, v109
v_mfma_f32_32x32x16_bf16 v[80:95], a[176:179], a[80:83], v[80:95]
ds_read_b64_tr_b16 a[210:211], v9 offset:22528
ds_read_b64_tr_b16 a[212:213], v10 offset:20480
ds_read_b64_tr_b16 a[214:215], v10 offset:22528
v_add_f32 v24, v24, v106
v_add_f32 v25, v25, v107
v_cvt_pk_bf16_f32 v37, v106, v107
v_mfma_f32_32x32x16_bf16 v[80:95], a[180:183], a[84:87], v[80:95]
ds_read_b64_tr_b16 a[216:217], v11 offset:20480
ds_read_b64_tr_b16 a[218:219], v11 offset:22528
v_exp_f32 v110, v110
v_exp_f32 v111, v111
v_mfma_f32_32x32x16_bf16 v[80:95], a[184:187], a[88:91], v[80:95]
ds_read_b64_tr_b16 a[220:221], v12 offset:20480
ds_read_b64_tr_b16 a[222:223], v12 offset:22528
v_add_f32 v24, v24, v108
v_add_f32 v25, v25, v109
v_cvt_pk_bf16_f32 v38, v108, v109
v_mfma_f32_32x32x16_bf16 v[80:95], a[188:191], a[92:95], v[80:95]
ds_read_b64_tr_b16 a[224:225], v9 offset:24576
ds_read_b64_tr_b16 a[226:227], v9 offset:26624
v_exp_f32 v112, v112
v_exp_f32 v113, v113
s_waitcnt lgkmcnt(15)
v_mfma_f32_32x32x16_bf16 v[128:143], v[192:195], v[224:227], v[128:143]
ds_read_b64_tr_b16 a[228:229], v10 offset:24576
ds_read_b64_tr_b16 a[230:231], v10 offset:26624
ds_read_b64_tr_b16 a[232:233], v11 offset:24576
v_add_f32 v24, v24, v110
v_add_f32 v25, v25, v111
v_cvt_pk_bf16_f32 v39, v110, v111
v_mfma_f32_32x32x16_bf16 v[144:159], v[196:199], v[224:227], v[144:159]
ds_read_b64_tr_b16 a[234:235], v11 offset:26624
ds_read_b64_tr_b16 a[236:237], v12 offset:24576
v_exp_f32 v114, v114
v_exp_f32 v115, v115
v_mfma_f32_32x32x16_bf16 v[160:175], v[200:203], v[224:227], v[160:175]
ds_read_b64_tr_b16 a[238:239], v12 offset:26624
ds_read_b64_tr_b16 a[240:241], v9 offset:28672
v_add_f32 v24, v24, v112
v_add_f32 v25, v25, v113
v_cvt_pk_bf16_f32 v40, v112, v113
v_mfma_f32_32x32x16_bf16 v[176:191], v[204:207], v[224:227], v[176:191]
ds_read_b64_tr_b16 a[242:243], v9 offset:30720
ds_read_b64_tr_b16 a[244:245], v10 offset:28672
v_exp_f32 v116, v116
v_exp_f32 v117, v117
v_mfma_f32_32x32x16_bf16 v[128:143], v[208:211], v[228:231], v[128:143]
ds_read_b64_tr_b16 a[246:247], v10 offset:30720
ds_read_b64_tr_b16 a[248:249], v11 offset:28672
ds_read_b64_tr_b16 a[250:251], v11 offset:30720
v_add_f32 v24, v24, v114
v_add_f32 v25, v25, v115
v_cvt_pk_bf16_f32 v41, v114, v115
v_mfma_f32_32x32x16_bf16 v[144:159], v[212:215], v[228:231], v[144:159]
ds_read_b64_tr_b16 a[252:253], v12 offset:28672
ds_read_b64_tr_b16 a[254:255], v12 offset:30720
v_exp_f32 v118, v118
v_exp_f32 v119, v119
v_mfma_f32_32x32x16_bf16 v[160:175], v[216:219], v[228:231], v[160:175]
v_add_f32 v24, v24, v116
v_add_f32 v25, v25, v117
v_cvt_pk_bf16_f32 v42, v116, v117
v_mfma_f32_32x32x16_bf16 v[176:191], v[220:223], v[228:231], v[176:191]
s_nop 0
v_add_f32 v24, v24, v118
v_add_f32 v25, v25, v119
v_cvt_pk_bf16_f32 v43, v118, v119
s_waitcnt lgkmcnt(0)
s_barrier
v_mfma_f32_32x32x16_bf16 a[0:15], a[192:195], v[32:35], a[0:15]
ds_read_b128 v[224:227], v19 offset:0
ds_read_b64_tr_b16 v[192:193], v13 offset:8192
v_exp_f32 v120, v120
v_mfma_f32_32x32x16_bf16 a[16:31], a[196:199], v[32:35], a[16:31]
ds_read_b64_tr_b16 v[194:195], v13 offset:9216
v_exp_f32 v121, v121
v_exp_f32 v122, v122
v_mfma_f32_32x32x16_bf16 a[32:47], a[200:203], v[32:35], a[32:47]
ds_read_b64_tr_b16 v[196:197], v14 offset:8192
ds_read_b64_tr_b16 v[198:199], v14 offset:9216
v_exp_f32 v123, v123
v_add_f32 v24, v24, v120
v_mfma_f32_32x32x16_bf16 a[48:63], a[204:207], v[32:35], a[48:63]
ds_read_b64_tr_b16 v[200:201], v15 offset:8192
ds_read_b64_tr_b16 v[202:203], v15 offset:9216
v_add_f32 v25, v25, v121
v_cvt_pk_bf16_f32 v44, v120, v121
v_mfma_f32_32x32x16_bf16 a[0:15], a[208:211], v[36:39], a[0:15]
ds_read_b64_tr_b16 v[204:205], v16 offset:8192
ds_read_b64_tr_b16 v[206:207], v16 offset:9216
v_exp_f32 v124, v124
v_exp_f32 v125, v125
v_mfma_f32_32x32x16_bf16 a[16:31], a[212:215], v[36:39], a[16:31]
ds_read_b128 v[228:231], v20 offset:0
v_add_f32 v24, v24, v122
v_add_f32 v25, v25, v123
v_mfma_f32_32x32x16_bf16 a[32:47], a[216:219], v[36:39], a[32:47]
ds_read_b64_tr_b16 v[208:209], v13 offset:12288
ds_read_b64_tr_b16 v[210:211], v13 offset:13312
v_cvt_pk_bf16_f32 v45, v122, v123
v_exp_f32 v126, v126
v_mfma_f32_32x32x16_bf16 a[48:63], a[220:223], v[36:39], a[48:63]
ds_read_b64_tr_b16 v[212:213], v14 offset:12288
ds_read_b64_tr_b16 v[214:215], v14 offset:13312
v_exp_f32 v127, v127
v_add_f32 v24, v24, v124
v_mfma_f32_32x32x16_bf16 a[0:15], a[224:227], v[40:43], a[0:15]
ds_read_b64_tr_b16 v[216:217], v15 offset:12288
ds_read_b64_tr_b16 v[218:219], v15 offset:13312
v_add_f32 v25, v25, v125
v_cvt_pk_bf16_f32 v46, v124, v125
s_nop 0
v_mfma_f32_32x32x16_bf16 a[16:31], a[228:231], v[40:43], a[16:31]
ds_read_b64_tr_b16 v[220:221], v16 offset:12288
v_add_f32 v24, v24, v126
v_add_f32 v25, v25, v127
v_cvt_pk_bf16_f32 v47, v126, v127
v_mfma_f32_32x32x16_bf16 a[32:47], a[232:235], v[40:43], a[32:47]
ds_read_b64_tr_b16 v[222:223], v16 offset:13312
ds_read_b128 v[232:235], v17 offset:12288
v_max3_f32 v26, v64, v65, v66
v_mfma_f32_32x32x16_bf16 a[48:63], a[236:239], v[40:43], a[48:63]
ds_read_b64_tr_b16 a[96:97], v13 offset:16384
ds_read_b64_tr_b16 a[98:99], v13 offset:17408
v_mfma_f32_32x32x16_bf16 a[0:15], a[240:243], v[44:47], a[0:15]
ds_read_b64_tr_b16 a[100:101], v14 offset:16384
ds_read_b64_tr_b16 a[102:103], v14 offset:17408
v_max3_f32 v26, v26, v67, v68
v_mfma_f32_32x32x16_bf16 a[16:31], a[244:247], v[44:47], a[16:31]
ds_read_b64_tr_b16 a[104:105], v15 offset:16384
v_max3_f32 v26, v26, v69, v70
v_mfma_f32_32x32x16_bf16 a[32:47], a[248:251], v[44:47], a[32:47]
ds_read_b64_tr_b16 a[106:107], v15 offset:17408
ds_read_b64_tr_b16 a[108:109], v16 offset:16384
v_max3_f32 v26, v26, v71, v72
v_mfma_f32_32x32x16_bf16 a[48:63], a[252:255], v[44:47], a[48:63]
ds_read_b64_tr_b16 a[110:111], v16 offset:17408
ds_read_b128 v[236:239], v18 offset:12288
s_waitcnt lgkmcnt(15)
v_mfma_f32_32x32x16_bf16 v[128:143], v[192:195], v[224:227], v[128:143]
ds_read_b64_tr_b16 a[112:113], v13 offset:20480
v_max3_f32 v26, v26, v73, v74
v_mfma_f32_32x32x16_bf16 v[144:159], v[196:199], v[224:227], v[144:159]
ds_read_b64_tr_b16 a[114:115], v13 offset:21504
ds_read_b64_tr_b16 a[116:117], v14 offset:20480
v_max3_f32 v26, v26, v75, v76
v_mfma_f32_32x32x16_bf16 v[160:175], v[200:203], v[224:227], v[160:175]
ds_read_b64_tr_b16 a[118:119], v14 offset:21504
ds_read_b64_tr_b16 a[120:121], v15 offset:20480
v_max3_f32 v26, v26, v77, v78
v_mfma_f32_32x32x16_bf16 v[176:191], v[204:207], v[224:227], v[176:191]
ds_read_b64_tr_b16 a[122:123], v15 offset:21504
ds_read_b64_tr_b16 a[124:125], v16 offset:20480
v_mfma_f32_32x32x16_bf16 v[128:143], v[208:211], v[228:231], v[128:143]
ds_read_b64_tr_b16 a[126:127], v16 offset:21504
v_max3_f32 v27, v80, v81, v82
s_waitcnt lgkmcnt(15)
v_mfma_f32_32x32x16_bf16 v[144:159], v[212:215], v[228:231], v[144:159]
ds_read_b128 a[128:131], v1 offset:32768
ds_read_b128 a[132:135], v2 offset:32768
v_max3_f32 v27, v27, v83, v84
v_mfma_f32_32x32x16_bf16 v[160:175], v[216:219], v[228:231], v[160:175]
ds_read_b128 a[136:139], v3 offset:32768
ds_read_b128 a[140:143], v4 offset:32768
v_mfma_f32_32x32x16_bf16 v[176:191], v[220:223], v[228:231], v[176:191]
ds_read_b128 a[144:147], v5 offset:32768
ds_read_b128 a[148:151], v6 offset:32768
v_max3_f32 v27, v27, v85, v86
v_mfma_f32_32x32x16_bf16 v[128:143], a[96:99], v[232:235], v[128:143]
ds_read_b128 a[152:155], v7 offset:32768
v_max3_f32 v27, v27, v87, v88
s_waitcnt lgkmcnt(15)
v_mfma_f32_32x32x16_bf16 v[144:159], a[100:103], v[232:235], v[144:159]
ds_read_b128 a[156:159], v8 offset:32768
ds_read_b128 a[160:163], v1 offset:40960
v_max3_f32 v27, v27, v89, v90
v_mfma_f32_32x32x16_bf16 v[160:175], a[104:107], v[232:235], v[160:175]
ds_read_b128 a[164:167], v2 offset:40960
ds_read_b128 a[168:171], v3 offset:40960
v_mfma_f32_32x32x16_bf16 v[176:191], a[108:111], v[232:235], v[176:191]
ds_read_b128 a[172:175], v4 offset:40960
ds_read_b128 a[176:179], v5 offset:40960
v_max3_f32 v27, v27, v91, v92
s_waitcnt lgkmcnt(15)
v_mfma_f32_32x32x16_bf16 v[128:143], a[112:115], v[236:239], v[128:143]
ds_read_b128 a[180:183], v6 offset:40960
v_max3_f32 v27, v27, v93, v94
v_mfma_f32_32x32x16_bf16 v[144:159], a[116:119], v[236:239], v[144:159]
ds_read_b128 a[184:187], v7 offset:40960
ds_read_b128 a[188:191], v8 offset:40960
v_max3_f32 v26, v26, v79, v95
v_mfma_f32_32x32x16_bf16 v[160:175], a[120:123], v[236:239], v[160:175]
s_waitcnt lgkmcnt(15)
v_mfma_f32_32x32x16_bf16 v[176:191], a[124:127], v[236:239], v[176:191]
v_max_f32 v26, v26, v27
v_cmp_lt_f32 vcc, s51, v26
s_cbranch_vccz L_norare_5
s_call_b64 s[46:47], L_rare0
L_norare_5:
s_waitcnt lgkmcnt(0)
s_barrier
v_mfma_f32_32x32x16_bf16 v[96:111], a[128:131], a[64:67], v[48:63]
ds_read_b128 v[224:227], v19 offset:12288
ds_read_b64_tr_b16 v[192:193], v13 offset:24576
v_exp_f32 v64, v64
v_exp_f32 v65, v65
v_mfma_f32_32x32x16_bf16 v[96:111], a[132:135], a[68:71], v[96:111]
ds_read_b64_tr_b16 v[194:195], v13 offset:25600
ds_read_b64_tr_b16 v[196:197], v14 offset:24576
ds_read_b64_tr_b16 v[198:199], v14 offset:25600
v_exp_f32 v66, v66
v_exp_f32 v67, v67
v_mfma_f32_32x32x16_bf16 v[96:111], a[136:139], a[72:75], v[96:111]
ds_read_b64_tr_b16 v[200:201], v15 offset:24576
ds_read_b64_tr_b16 v[202:203], v15 offset:25600
v_add_f32 v24, v24, v64
v_add_f32 v25, v25, v65
v_cvt_pk_bf16_f32 v32, v64, v65
v_mfma_f32_32x32x16_bf16 v[96:111], a[140:143], a[76:79], v[96:111]
ds_read_b64_tr_b16 v[204:205], v16 offset:24576
ds_read_b64_tr_b16 v[206:207], v16 offset:25600
v_exp_f32 v68, v68
v_exp_f32 v69, v69
v_mfma_f32_32x32x16_bf16 v[96:111], a[144:147], a[80:83], v[96:111]
ds_read_b128 v[228:231], v20 offset:12288
ds_read_b64_tr_b16 v[208:209], v13 offset:28672
v_add_f32 v24, v24, v66
v_add_f32 v25, v25, v67
v_cvt_pk_bf16_f32 v33, v66, v67
v_mfma_f32_32x32x16_bf16 v[96:111], a[148:151], a[84:87], v[96:111]
ds_read_b64_tr_b16 v[210:211], v13 offset:29696
ds_read_b64_tr_b16 v[212:213], v14 offset:28672
ds_read_b64_tr_b16 v[214:215], v14 offset:29696
v_exp_f32 v70, v70
v_exp_f32 v71, v71
v_mfma_f32_32x32x16_bf16 v[96:111], a[152:155], a[88:91], v[96:111]
ds_read_b64_tr_b16 v[216:217], v15 offset:28672
ds_read_b64_tr_b16 v[218:219], v15 offset:29696
v_add_f32 v24, v24, v68
v_add_f32 v25, v25, v69
v_cvt_pk_bf16_f32 v34, v68, v69
v_mfma_f32_32x32x16_bf16 v[96:111], a[156:159], a[92:95], v[96:111]
ds_read_b64_tr_b16 v[220:221], v16 offset:28672
ds_read_b64_tr_b16 v[222:223], v16 offset:29696
v_exp_f32 v72, v72
v_exp_f32 v73, v73
v_mfma_f32_32x32x16_bf16 v[112:127], a[160:163], a[64:67], v[48:63]
ds_read_b64_tr_b16 a[192:193], v9 offset:0
ds_read_b64_tr_b16 a[194:195], v9 offset:2048
v_add_f32 v24, v24, v70
v_add_f32 v25, v25, v71
v_cvt_pk_bf16_f32 v35, v70, v71
v_mfma_f32_32x32x16_bf16 v[112:127], a[164:167], a[68:71], v[112:127]
ds_read_b64_tr_b16 a[196:197], v10 offset:0
ds_read_b64_tr_b16 a[198:199], v10 offset:2048
ds_read_b64_tr_b16 a[200:201], v11 offset:0
v_exp_f32 v74, v74
v_exp_f32 v75, v75
v_mfma_f32_32x32x16_bf16 v[112:127], a[168:171], a[72:75], v[112:127]
ds_read_b64_tr_b16 a[202:203], v11 offset:2048
ds_read_b64_tr_b16 a[204:205], v12 offset:0
v_add_f32 v24, v24, v72
v_add_f32 v25, v25, v73
v_cvt_pk_bf16_f32 v36, v72, v73
v_mfma_f32_32x32x16_bf16 v[112:127], a[172:175], a[76:79], v[112:127]
ds_read_b64_tr_b16 a[206:207], v12 offset:2048
ds_read_b64_tr_b16 a[208:209], v9 offset:4096
v_exp_f32 v76, v76
v_exp_f32 v77, v77
v_mfma_f32_32x32x16_bf16 v[112:127], a[176:179], a[80:83], v[112:127]
ds_read_b64_tr_b16 a[210:211], v9 offset:6144
ds_read_b64_tr_b16 a[212:213], v10 offset:4096
ds_read_b64_tr_b16 a[214:215], v10 offset:6144
v_add_f32 v24, v24, v74
v_add_f32 v25, v25, v75
v_cvt_pk_bf16_f32 v37, v74, v75
v_mfma_f32_32x32x16_bf16 v[112:127], a[180:183], a[84:87], v[112:127]
ds_read_b64_tr_b16 a[216:217], v11 offset:4096
ds_read_b64_tr_b16 a[218:219], v11 offset:6144
v_exp_f32 v78, v78
v_exp_f32 v79, v79
v_mfma_f32_32x32x16_bf16 v[112:127], a[184:187], a[88:91], v[112:127]
ds_read_b64_tr_b16 a[220:221], v12 offset:4096
ds_read_b64_tr_b16 a[222:223], v12 offset:6144
v_add_f32 v24, v24, v76
v_add_f32 v25, v25, v77
v_cvt_pk_bf16_f32 v38, v76, v77
v_mfma_f32_32x32x16_bf16 v[112:127], a[188:191], a[92:95], v[112:127]
ds_read_b64_tr_b16 a[224:225], v9 offset:8192
ds_read_b64_tr_b16 a[226:227], v9 offset:10240
v_exp_f32 v80, v80
v_exp_f32 v81, v81
s_waitcnt lgkmcnt(15)
v_mfma_f32_32x32x16_bf16 v[128:143], v[192:195], v[224:227], v[128:143]
ds_read_b64_tr_b16 a[228:229], v10 offset:8192
ds_read_b64_tr_b16 a[230:231], v10 offset:10240
ds_read_b64_tr_b16 a[232:233], v11 offset:8192
v_add_f32 v24, v24, v78
v_add_f32 v25, v25, v79
v_cvt_pk_bf16_f32 v39, v78, v79
v_mfma_f32_32x32x16_bf16 v[144:159], v[196:199], v[224:227], v[144:159]
ds_read_b64_tr_b16 a[234:235], v11 offset:10240
ds_read_b64_tr_b16 a[236:237], v12 offset:8192
v_exp_f32 v82, v82
v_exp_f32 v83, v83
v_mfma_f32_32x32x16_bf16 v[160:175], v[200:203], v[224:227], v[160:175]
ds_read_b64_tr_b16 a[238:239], v12 offset:10240
ds_read_b64_tr_b16 a[240:241], v9 offset:12288
v_add_f32 v24, v24, v80
v_add_f32 v25, v25, v81
v_cvt_pk_bf16_f32 v40, v80, v81
v_mfma_f32_32x32x16_bf16 v[176:191], v[204:207], v[224:227], v[176:191]
ds_read_b64_tr_b16 a[242:243], v9 offset:14336
ds_read_b64_tr_b16 a[244:245], v10 offset:12288
v_exp_f32 v84, v84
v_exp_f32 v85, v85
v_mfma_f32_32x32x16_bf16 v[128:143], v[208:211], v[228:231], v[128:143]
ds_read_b64_tr_b16 a[246:247], v10 offset:14336
ds_read_b64_tr_b16 a[248:249], v11 offset:12288
ds_read_b64_tr_b16 a[250:251], v11 offset:14336
v_add_f32 v24, v24, v82
v_add_f32 v25, v25, v83
v_cvt_pk_bf16_f32 v41, v82, v83
v_mfma_f32_32x32x16_bf16 v[144:159], v[212:215], v[228:231], v[144:159]
ds_read_b64_tr_b16 a[252:253], v12 offset:12288
ds_read_b64_tr_b16 a[254:255], v12 offset:14336
v_exp_f32 v86, v86
v_exp_f32 v87, v87
v_mfma_f32_32x32x16_bf16 v[160:175], v[216:219], v[228:231], v[160:175]
v_add_f32 v24, v24, v84
v_add_f32 v25, v25, v85
v_cvt_pk_bf16_f32 v42, v84, v85
v_mfma_f32_32x32x16_bf16 v[176:191], v[220:223], v[228:231], v[176:191]
s_nop 0
v_add_f32 v24, v24, v86
v_add_f32 v25, v25, v87
v_cvt_pk_bf16_f32 v43, v86, v87
s_waitcnt lgkmcnt(0)
s_barrier
v_mfma_f32_32x32x16_bf16 a[0:15], a[192:195], v[32:35], a[0:15]
ds_read_b128 v[224:227], v17 offset:24576
ds_read_b64_tr_b16 v[192:193], v13 offset:32768
v_exp_f32 v88, v88
v_mfma_f32_32x32x16_bf16 a[16:31], a[196:199], v[32:35], a[16:31]
ds_read_b64_tr_b16 v[194:195], v13 offset:33792
v_exp_f32 v89, v89
v_exp_f32 v90, v90
v_mfma_f32_32x32x16_bf16 a[32:47], a[200:203], v[32:35], a[32:47]
ds_read_b64_tr_b16 v[196:197], v14 offset:32768
ds_read_b64_tr_b16 v[198:199], v14 offset:33792
v_exp_f32 v91, v91
v_add_f32 v24, v24, v88
v_mfma_f32_32x32x16_bf16 a[48:63], a[204:207], v[32:35], a[48:63]
ds_read_b64_tr_b16 v[200:201], v15 offset:32768
ds_read_b64_tr_b16 v[202:203], v15 offset:33792
v_add_f32 v25, v25, v89
v_cvt_pk_bf16_f32 v44, v88, v89
v_mfma_f32_32x32x16_bf16 a[0:15], a[208:211], v[36:39], a[0:15]
ds_read_b64_tr_b16 v[204:205], v16 offset:32768
ds_read_b64_tr_b16 v[206:207], v16 offset:33792
v_exp_f32 v92, v92
v_exp_f32 v93, v93
v_mfma_f32_32x32x16_bf16 a[16:31], a[212:215], v[36:39], a[16:31]
ds_read_b128 v[228:231], v18 offset:24576
v_add_f32 v24, v24, v90
v_add_f32 v25, v25, v91
v_mfma_f32_32x32x16_bf16 a[32:47], a[216:219], v[36:39], a[32:47]
ds_read_b64_tr_b16 v[208:209], v13 offset:36864
ds_read_b64_tr_b16 v[210:211], v13 offset:37888
v_cvt_pk_bf16_f32 v45, v90, v91
v_exp_f32 v94, v94
v_mfma_f32_32x32x16_bf16 a[48:63], a[220:223], v[36:39], a[48:63]
ds_read_b64_tr_b16 v[212:213], v14 offset:36864
ds_read_b64_tr_b16 v[214:215], v14 offset:37888
v_exp_f32 v95, v95
v_add_f32 v24, v24, v92
v_mfma_f32_32x32x16_bf16 a[0:15], a[224:227], v[40:43], a[0:15]
ds_read_b64_tr_b16 v[216:217], v15 offset:36864
ds_read_b64_tr_b16 v[218:219], v15 offset:37888
v_add_f32 v25, v25, v93
v_cvt_pk_bf16_f32 v46, v92, v93
s_nop 0
v_mfma_f32_32x32x16_bf16 a[16:31], a[228:231], v[40:43], a[16:31]
ds_read_b64_tr_b16 v[220:221], v16 offset:36864
v_add_f32 v24, v24, v94
v_add_f32 v25, v25, v95
v_cvt_pk_bf16_f32 v47, v94, v95
v_mfma_f32_32x32x16_bf16 a[32:47], a[232:235], v[40:43], a[32:47]
ds_read_b64_tr_b16 v[222:223], v16 offset:37888
ds_read_b128 v[232:235], v19 offset:24576
v_max3_f32 v26, v96, v97, v98
v_mfma_f32_32x32x16_bf16 a[48:63], a[236:239], v[40:43], a[48:63]
ds_read_b64_tr_b16 a[96:97], v13 offset:0
ds_read_b64_tr_b16 a[98:99], v13 offset:1024
v_mfma_f32_32x32x16_bf16 a[0:15], a[240:243], v[44:47], a[0:15]
ds_read_b64_tr_b16 a[100:101], v14 offset:0
ds_read_b64_tr_b16 a[102:103], v14 offset:1024
v_max3_f32 v26, v26, v99, v100
v_mfma_f32_32x32x16_bf16 a[16:31], a[244:247], v[44:47], a[16:31]
ds_read_b64_tr_b16 a[104:105], v15 offset:0
v_max3_f32 v26, v26, v101, v102
v_mfma_f32_32x32x16_bf16 a[32:47], a[248:251], v[44:47], a[32:47]
ds_read_b64_tr_b16 a[106:107], v15 offset:1024
ds_read_b64_tr_b16 a[108:109], v16 offset:0
v_max3_f32 v26, v26, v103, v104
v_mfma_f32_32x32x16_bf16 a[48:63], a[252:255], v[44:47], a[48:63]
ds_read_b64_tr_b16 a[110:111], v16 offset:1024
ds_read_b128 v[236:239], v20 offset:24576
s_waitcnt lgkmcnt(15)
v_mfma_f32_32x32x16_bf16 v[128:143], v[192:195], v[224:227], v[128:143]
ds_read_b64_tr_b16 a[112:113], v13 offset:4096
v_max3_f32 v26, v26, v105, v106
v_mfma_f32_32x32x16_bf16 v[144:159], v[196:199], v[224:227], v[144:159]
ds_read_b64_tr_b16 a[114:115], v13 offset:5120
ds_read_b64_tr_b16 a[116:117], v14 offset:4096
v_max3_f32 v26, v26, v107, v108
v_mfma_f32_32x32x16_bf16 v[160:175], v[200:203], v[224:227], v[160:175]
ds_read_b64_tr_b16 a[118:119], v14 offset:5120
ds_read_b64_tr_b16 a[120:121], v15 offset:4096
v_max3_f32 v26, v26, v109, v110
v_mfma_f32_32x32x16_bf16 v[176:191], v[204:207], v[224:227], v[176:191]
ds_read_b64_tr_b16 a[122:123], v15 offset:5120
ds_read_b64_tr_b16 a[124:125], v16 offset:4096
v_mfma_f32_32x32x16_bf16 v[128:143], v[208:211], v[228:231], v[128:143]
ds_read_b64_tr_b16 a[126:127], v16 offset:5120
v_max3_f32 v27, v112, v113, v114
s_waitcnt lgkmcnt(15)
v_mfma_f32_32x32x16_bf16 v[144:159], v[212:215], v[228:231], v[144:159]
ds_read_b128 a[128:131], v1 offset:0
ds_read_b128 a[132:135], v2 offset:0
v_max3_f32 v27, v27, v115, v116
v_mfma_f32_32x32x16_bf16 v[160:175], v[216:219], v[228:231], v[160:175]
ds_read_b128 a[136:139], v3 offset:0
ds_read_b128 a[140:143], v4 offset:0
v_mfma_f32_32x32x16_bf16 v[176:191], v[220:223], v[228:231], v[176:191]
ds_read_b128 a[144:147], v5 offset:0
ds_read_b128 a[148:151], v6 offset:0
v_max3_f32 v27, v27, v117, v118
v_mfma_f32_32x32x16_bf16 v[128:143], a[96:99], v[232:235], v[128:143]
ds_read_b128 a[152:155], v7 offset:0
v_max3_f32 v27, v27, v119, v120
s_waitcnt lgkmcnt(15)
v_mfma_f32_32x32x16_bf16 v[144:159], a[100:103], v[232:235], v[144:159]
ds_read_b128 a[156:159], v8 offset:0
ds_read_b128 a[160:163], v1 offset:8192
v_max3_f32 v27, v27, v121, v122
v_mfma_f32_32x32x16_bf16 v[160:175], a[104:107], v[232:235], v[160:175]
ds_read_b128 a[164:167], v2 offset:8192
ds_read_b128 a[168:171], v3 offset:8192
v_mfma_f32_32x32x16_bf16 v[176:191], a[108:111], v[232:235], v[176:191]
ds_read_b128 a[172:175], v4 offset:8192
ds_read_b128 a[176:179], v5 offset:8192
v_max3_f32 v27, v27, v123, v124
s_waitcnt lgkmcnt(15)
v_mfma_f32_32x32x16_bf16 v[128:143], a[112:115], v[236:239], v[128:143]
ds_read_b128 a[180:183], v6 offset:8192
v_max3_f32 v27, v27, v125, v126
v_mfma_f32_32x32x16_bf16 v[144:159], a[116:119], v[236:239], v[144:159]
ds_read_b128 a[184:187], v7 offset:8192
ds_read_b128 a[188:191], v8 offset:8192
v_max3_f32 v26, v26, v111, v127
v_mfma_f32_32x32x16_bf16 v[160:175], a[120:123], v[236:239], v[160:175]
s_waitcnt lgkmcnt(15)
v_mfma_f32_32x32x16_bf16 v[176:191], a[124:127], v[236:239], v[176:191]
v_max_f32 v26, v26, v27
v_cmp_lt_f32 vcc, s51, v26
s_cbranch_vccz L_norare_6
s_call_b64 s[46:47], L_rare1
L_norare_6:
s_waitcnt lgkmcnt(0)
s_barrier
v_mfma_f32_32x32x16_bf16 v[64:79], a[128:131], a[64:67], v[48:63]
ds_read_b128 v[224:227], v17 offset:0
ds_read_b64_tr_b16 v[192:193], v13 offset:8192
v_exp_f32 v96, v96
v_exp_f32 v97, v97
v_mfma_f32_32x32x16_bf16 v[64:79], a[132:135], a[68:71], v[64:79]
ds_read_b64_tr_b16 v[194:195], v13 offset:9216
ds_read_b64_tr_b16 v[196:197], v14 offset:8192
ds_read_b64_tr_b16 v[198:199], v14 offset:9216
v_exp_f32 v98, v98
v_exp_f32 v99, v99
v_mfma_f32_32x32x16_bf16 v[64:79], a[136:139], a[72:75], v[64:79]
ds_read_b64_tr_b16 v[200:201], v15 offset:8192
ds_read_b64_tr_b16 v[202:203], v15 offset:9216
v_add_f32 v24, v24, v96
v_add_f32 v25, v25, v97
v_cvt_pk_bf16_f32 v32, v96, v97
v_mfma_f32_32x32x16_bf16 v[64:79], a[140:143], a[76:79], v[64:79]
ds_read_b64_tr_b16 v[204:205], v16 offset:8192
ds_read_b64_tr_b16 v[206:207], v16 offset:9216
v_exp_f32 v100, v100
v_exp_f32 v101, v101
v_mfma_f32_32x32x16_bf16 v[64:79], a[144:147], a[80:83], v[64:79]
ds_read_b128 v[228:231], v18 offset:0
ds_read_b64_tr_b16 v[208:209], v13 offset:12288
v_add_f32 v24, v24, v98
v_add_f32 v25, v25, v99
v_cvt_pk_bf16_f32 v33, v98, v99
v_mfma_f32_32x32x16_bf16 v[64:79], a[148:151], a[84:87], v[64:79]
ds_read_b64_tr_b16 v[210:211], v13 offset:13312
ds_read_b64_tr_b16 v[212:213], v14 offset:12288
ds_read_b64_tr_b16 v[214:215], v14 offset:13312
v_exp_f32 v102, v102
v_exp_f32 v103, v103
v_mfma_f32_32x32x16_bf16 v[64:79], a[152:155], a[88:91], v[64:79]
ds_read_b64_tr_b16 v[216:217], v15 offset:12288
ds_read_b64_tr_b16 v[218:219], v15 offset:13312
v_add_f32 v24, v24, v100
v_add_f32 v25, v25, v101
v_cvt_pk_bf16_f32 v34, v100, v101
v_mfma_f32_32x32x16_bf16 v[64:79], a[156:159], a[92:95], v[64:79]
ds_read_b64_tr_b16 v[220:221], v16 offset:12288
ds_read_b64_tr_b16 v[222:223], v16 offset:13312
v_exp_f32 v104, v104
v_exp_f32 v105, v105
v_mfma_f32_32x32x16_bf16 v[80:95], a[160:163], a[64:67], v[48:63]
ds_read_b64_tr_b16 a[192:193], v9 offset:16384
ds_read_b64_tr_b16 a[194:195], v9 offset:18432
v_add_f32 v24, v24, v102
v_add_f32 v25, v25, v103
v_cvt_pk_bf16_f32 v35, v102, v103
v_mfma_f32_32x32x16_bf16 v[80:95], a[164:167], a[68:71], v[80:95]
ds_read_b64_tr_b16 a[196:197], v10 offset:16384
ds_read_b64_tr_b16 a[198:199], v10 offset:18432
ds_read_b64_tr_b16 a[200:201], v11 offset:16384
v_exp_f32 v106, v106
v_exp_f32 v107, v107
v_mfma_f32_32x32x16_bf16 v[80:95], a[168:171], a[72:75], v[80:95]
ds_read_b64_tr_b16 a[202:203], v11 offset:18432
ds_read_b64_tr_b16 a[204:205], v12 offset:16384
v_add_f32 v24, v24, v104
v_add_f32 v25, v25, v105
v_cvt_pk_bf16_f32 v36, v104, v105
v_mfma_f32_32x32x16_bf16 v[80:95], a[172:175], a[76:79], v[80:95]
ds_read_b64_tr_b16 a[206:207], v12 offset:18432
ds_read_b64_tr_b16 a[208:209], v9 offset:20480
v_exp_f32 v108, v108
v_exp_f32 v109, v109
v_mfma_f32_32x32x16_bf16 v[80:95], a[176:179], a[80:83], v[80:95]
ds_read_b64_tr_b16 a[210:211], v9 offset:22528
ds_read_b64_tr_b16 a[212:213], v10 offset:20480
ds_read_b64_tr_b16 a[214:215], v10 offset:22528
v_add_f32 v24, v24, v106
v_add_f32 v25, v25, v107
v_cvt_pk_bf16_f32 v37, v106, v107
v_mfma_f32_32x32x16_bf16 v[80:95], a[180:183], a[84:87], v[80:95]
ds_read_b64_tr_b16 a[216:217], v11 offset:20480
ds_read_b64_tr_b16 a[218:219], v11 offset:22528
v_exp_f32 v110, v110
v_exp_f32 v111, v111
v_mfma_f32_32x32x16_bf16 v[80:95], a[184:187], a[88:91], v[80:95]
ds_read_b64_tr_b16 a[220:221], v12 offset:20480
ds_read_b64_tr_b16 a[222:223], v12 offset:22528
v_add_f32 v24, v24, v108
v_add_f32 v25, v25, v109
v_cvt_pk_bf16_f32 v38, v108, v109
v_mfma_f32_32x32x16_bf16 v[80:95], a[188:191], a[92:95], v[80:95]
ds_read_b64_tr_b16 a[224:225], v9 offset:24576
ds_read_b64_tr_b16 a[226:227], v9 offset:26624
v_exp_f32 v112, v112
v_exp_f32 v113, v113
s_waitcnt lgkmcnt(15)
v_mfma_f32_32x32x16_bf16 v[128:143], v[192:195], v[224:227], v[128:143]
ds_read_b64_tr_b16 a[228:229], v10 offset:24576
ds_read_b64_tr_b16 a[230:231], v10 offset:26624
ds_read_b64_tr_b16 a[232:233], v11 offset:24576
v_add_f32 v24, v24, v110
v_add_f32 v25, v25, v111
v_cvt_pk_bf16_f32 v39, v110, v111
v_mfma_f32_32x32x16_bf16 v[144:159], v[196:199], v[224:227], v[144:159]
ds_read_b64_tr_b16 a[234:235], v11 offset:26624
ds_read_b64_tr_b16 a[236:237], v12 offset:24576
v_exp_f32 v114, v114
v_exp_f32 v115, v115
v_mfma_f32_32x32x16_bf16 v[160:175], v[200:203], v[224:227], v[160:175]
ds_read_b64_tr_b16 a[238:239], v12 offset:26624
ds_read_b64_tr_b16 a[240:241], v9 offset:28672
v_add_f32 v24, v24, v112
v_add_f32 v25, v25, v113
v_cvt_pk_bf16_f32 v40, v112, v113
v_mfma_f32_32x32x16_bf16 v[176:191], v[204:207], v[224:227], v[176:191]
ds_read_b64_tr_b16 a[242:243], v9 offset:30720
ds_read_b64_tr_b16 a[244:245], v10 offset:28672
v_exp_f32 v116, v116
v_exp_f32 v117, v117
v_mfma_f32_32x32x16_bf16 v[128:143], v[208:211], v[228:231], v[128:143]
ds_read_b64_tr_b16 a[246:247], v10 offset:30720
ds_read_b64_tr_b16 a[248:249], v11 offset:28672
ds_read_b64_tr_b16 a[250:251], v11 offset:30720
v_add_f32 v24, v24, v114
v_add_f32 v25, v25, v115
v_cvt_pk_bf16_f32 v41, v114, v115
v_mfma_f32_32x32x16_bf16 v[144:159], v[212:215], v[228:231], v[144:159]
ds_read_b64_tr_b16 a[252:253], v12 offset:28672
ds_read_b64_tr_b16 a[254:255], v12 offset:30720
v_exp_f32 v118, v118
v_exp_f32 v119, v119
v_mfma_f32_32x32x16_bf16 v[160:175], v[216:219], v[228:231], v[160:175]
v_add_f32 v24, v24, v116
v_add_f32 v25, v25, v117
v_cvt_pk_bf16_f32 v42, v116, v117
v_mfma_f32_32x32x16_bf16 v[176:191], v[220:223], v[228:231], v[176:191]
s_nop 0
v_add_f32 v24, v24, v118
v_add_f32 v25, v25, v119
v_cvt_pk_bf16_f32 v43, v118, v119
s_waitcnt lgkmcnt(0)
s_barrier
v_mfma_f32_32x32x16_bf16 a[0:15], a[192:195], v[32:35], a[0:15]
ds_read_b128 v[224:227], v19 offset:0
ds_read_b64_tr_b16 v[192:193], v13 offset:16384
v_exp_f32 v120, v120
v_mfma_f32_32x32x16_bf16 a[16:31], a[196:199], v[32:35], a[16:31]
ds_read_b64_tr_b16 v[194:195], v13 offset:17408
v_exp_f32 v121, v121
v_exp_f32 v122, v122
v_mfma_f32_32x32x16_bf16 a[32:47], a[200:203], v[32:35], a[32:47]
ds_read_b64_tr_b16 v[196:197], v14 offset:16384
ds_read_b64_tr_b16 v[198:199], v14 offset:17408
v_exp_f32 v123, v123
v_add_f32 v24, v24, v120
v_mfma_f32_32x32x16_bf16 a[48:63], a[204:207], v[32:35], a[48:63]
ds_read_b64_tr_b16 v[200:201], v15 offset:16384
ds_read_b64_tr_b16 v[202:203], v15 offset:17408
v_add_f32 v25, v25, v121
v_cvt_pk_bf16_f32 v44, v120, v121
v_mfma_f32_32x32x16_bf16 a[0:15], a[208:211], v[36:39], a[0:15]
ds_read_b64_tr_b16 v[204:205], v16 offset:16384
ds_read_b64_tr_b16 v[206:207], v16 offset:17408
v_exp_f32 v124, v124
v_exp_f32 v125, v125
v_mfma_f32_32x32x16_bf16 a[16:31], a[212:215], v[36:39], a[16:31]
ds_read_b128 v[228:231], v20 offset:0
v_add_f32 v24, v24, v122
v_add_f32 v25, v25, v123
v_mfma_f32_32x32x16_bf16 a[32:47], a[216:219], v[36:39], a[32:47]
ds_read_b64_tr_b16 v[208:209], v13 offset:20480
ds_read_b64_tr_b16 v[210:211], v13 offset:21504
v_cvt_pk_bf16_f32 v45, v122, v123
v_exp_f32 v126, v126
v_mfma_f32_32x32x16_bf16 a[48:63], a[220:223], v[36:39], a[48:63]
ds_read_b64_tr_b16 v[212:213], v14 offset:20480
ds_read_b64_tr_b16 v[214:215], v14 offset:21504
v_exp_f32 v127, v127
v_add_f32 v24, v24, v124
v_mfma_f32_32x32x16_bf16 a[0:15], a[224:227], v[40:43], a[0:15]
ds_read_b64_tr_b16 v[216:217], v15 offset:20480
ds_read_b64_tr_b16 v[218:219], v15 offset:21504
v_add_f32 v25, v25, v125
v_cvt_pk_bf16_f32 v46, v124, v125
s_nop 0
v_mfma_f32_32x32x16_bf16 a[16:31], a[228:231], v[40:43], a[16:31]
ds_read_b64_tr_b16 v[220:221], v16 offset:20480
v_add_f32 v24, v24, v126
v_add_f32 v25, v25, v127
v_cvt_pk_bf16_f32 v47, v126, v127
v_mfma_f32_32x32x16_bf16 a[32:47], a[232:235], v[40:43], a[32:47]
ds_read_b64_tr_b16 v[222:223], v16 offset:21504
ds_read_b128 v[232:235], v17 offset:12288
v_max3_f32 v26, v64, v65, v66
v_mfma_f32_32x32x16_bf16 a[48:63], a[236:239], v[40:43], a[48:63]
ds_read_b64_tr_b16 a[96:97], v13 offset:24576
ds_read_b64_tr_b16 a[98:99], v13 offset:25600
v_mfma_f32_32x32x16_bf16 a[0:15], a[240:243], v[44:47], a[0:15]
ds_read_b64_tr_b16 a[100:101], v14 offset:24576
ds_read_b64_tr_b16 a[102:103], v14 offset:25600
v_max3_f32 v26, v26, v67, v68
v_mfma_f32_32x32x16_bf16 a[16:31], a[244:247], v[44:47], a[16:31]
ds_read_b64_tr_b16 a[104:105], v15 offset:24576
v_max3_f32 v26, v26, v69, v70
v_mfma_f32_32x32x16_bf16 a[32:47], a[248:251], v[44:47], a[32:47]
ds_read_b64_tr_b16 a[106:107], v15 offset:25600
ds_read_b64_tr_b16 a[108:109], v16 offset:24576
v_max3_f32 v26, v26, v71, v72
v_mfma_f32_32x32x16_bf16 a[48:63], a[252:255], v[44:47], a[48:63]
ds_read_b64_tr_b16 a[110:111], v16 offset:25600
ds_read_b128 v[236:239], v18 offset:12288
s_waitcnt lgkmcnt(15)
v_mfma_f32_32x32x16_bf16 v[128:143], v[192:195], v[224:227], v[128:143]
ds_read_b64_tr_b16 a[112:113], v13 offset:28672
v_max3_f32 v26, v26, v73, v74
v_mfma_f32_32x32x16_bf16 v[144:159], v[196:199], v[224:227], v[144:159]
ds_read_b64_tr_b16 a[114:115], v13 offset:29696
ds_read_b64_tr_b16 a[116:117], v14 offset:28672
v_max3_f32 v26, v26, v75, v76
v_mfma_f32_32x32x16_bf16 v[160:175], v[200:203], v[224:227], v[160:175]
ds_read_b64_tr_b16 a[118:119], v14 offset:29696
ds_read_b64_tr_b16 a[120:121], v15 offset:28672
v_max3_f32 v26, v26, v77, v78
v_mfma_f32_32x32x16_bf16 v[176:191], v[204:207], v[224:227], v[176:191]
ds_read_b64_tr_b16 a[122:123], v15 offset:29696
ds_read_b64_tr_b16 a[124:125], v16 offset:28672
v_mfma_f32_32x32x16_bf16 v[128:143], v[208:211], v[228:231], v[128:143]
ds_read_b64_tr_b16 a[126:127], v16 offset:29696
v_max3_f32 v27, v80, v81, v82
s_waitcnt lgkmcnt(15)
v_mfma_f32_32x32x16_bf16 v[144:159], v[212:215], v[228:231], v[144:159]
ds_read_b128 a[128:131], v1 offset:16384
ds_read_b128 a[132:135], v2 offset:16384
v_max3_f32 v27, v27, v83, v84
v_mfma_f32_32x32x16_bf16 v[160:175], v[216:219], v[228:231], v[160:175]
ds_read_b128 a[136:139], v3 offset:16384
ds_read_b128 a[140:143], v4 offset:16384
v_mfma_f32_32x32x16_bf16 v[176:191], v[220:223], v[228:231], v[176:191]
ds_read_b128 a[144:147], v5 offset:16384
ds_read_b128 a[148:151], v6 offset:16384
v_max3_f32 v27, v27, v85, v86
v_mfma_f32_32x32x16_bf16 v[128:143], a[96:99], v[232:235], v[128:143]
ds_read_b128 a[152:155], v7 offset:16384
v_max3_f32 v27, v27, v87, v88
s_waitcnt lgkmcnt(15)
v_mfma_f32_32x32x16_bf16 v[144:159], a[100:103], v[232:235], v[144:159]
ds_read_b128 a[156:159], v8 offset:16384
ds_read_b128 a[160:163], v1 offset:24576
v_max3_f32 v27, v27, v89, v90
v_mfma_f32_32x32x16_bf16 v[160:175], a[104:107], v[232:235], v[160:175]
ds_read_b128 a[164:167], v2 offset:24576
ds_read_b128 a[168:171], v3 offset:24576
v_mfma_f32_32x32x16_bf16 v[176:191], a[108:111], v[232:235], v[176:191]
ds_read_b128 a[172:175], v4 offset:24576
ds_read_b128 a[176:179], v5 offset:24576
v_max3_f32 v27, v27, v91, v92
s_waitcnt lgkmcnt(15)
v_mfma_f32_32x32x16_bf16 v[128:143], a[112:115], v[236:239], v[128:143]
ds_read_b128 a[180:183], v6 offset:24576
v_max3_f32 v27, v27, v93, v94
v_mfma_f32_32x32x16_bf16 v[144:159], a[116:119], v[236:239], v[144:159]
ds_read_b128 a[184:187], v7 offset:24576
ds_read_b128 a[188:191], v8 offset:24576
v_max3_f32 v26, v26, v79, v95
v_mfma_f32_32x32x16_bf16 v[160:175], a[120:123], v[236:239], v[160:175]
s_waitcnt lgkmcnt(15)
v_mfma_f32_32x32x16_bf16 v[176:191], a[124:127], v[236:239], v[176:191]
v_max_f32 v26, v26, v27
v_cmp_lt_f32 vcc, s51, v26
s_cbranch_vccz L_norare_7
s_call_b64 s[46:47], L_rare0
L_norare_7:
s_waitcnt lgkmcnt(0)
s_barrier
v_mfma_f32_32x32x16_bf16 v[96:111], a[128:131], a[64:67], v[48:63]
ds_read_b128 v[224:227], v19 offset:12288
ds_read_b64_tr_b16 v[192:193], v13 offset:32768
v_exp_f32 v64, v64
v_exp_f32 v65, v65
v_mfma_f32_32x32x16_bf16 v[96:111], a[132:135], a[68:71], v[96:111]
ds_read_b64_tr_b16 v[194:195], v13 offset:33792
ds_read_b64_tr_b16 v[196:197], v14 offset:32768
ds_read_b64_tr_b16 v[198:199], v14 offset:33792
v_exp_f32 v66, v66
v_exp_f32 v67, v67
v_mfma_f32_32x32x16_bf16 v[96:111], a[136:139], a[72:75], v[96:111]
ds_read_b64_tr_b16 v[200:201], v15 offset:32768
ds_read_b64_tr_b16 v[202:203], v15 offset:33792
v_add_f32 v24, v24, v64
v_add_f32 v25, v25, v65
v_cvt_pk_bf16_f32 v32, v64, v65
v_mfma_f32_32x32x16_bf16 v[96:111], a[140:143], a[76:79], v[96:111]
ds_read_b64_tr_b16 v[204:205], v16 offset:32768
ds_read_b64_tr_b16 v[206:207], v16 offset:33792
v_exp_f32 v68, v68
v_exp_f32 v69, v69
v_mfma_f32_32x32x16_bf16 v[96:111], a[144:147], a[80:83], v[96:111]
ds_read_b128 v[228:231], v20 offset:12288
ds_read_b64_tr_b16 v[208:209], v13 offset:36864
v_add_f32 v24, v24, v66
v_add_f32 v25, v25, v67
v_cvt_pk_bf16_f32 v33, v66, v67
v_mfma_f32_32x32x16_bf16 v[96:111], a[148:151], a[84:87], v[96:111]
ds_read_b64_tr_b16 v[210:211], v13 offset:37888
ds_read_b64_tr_b16 v[212:213], v14 offset:36864
ds_read_b64_tr_b16 v[214:215], v14 offset:37888
v_exp_f32 v70, v70
v_exp_f32 v71, v71
v_mfma_f32_32x32x16_bf16 v[96:111], a[152:155], a[88:91], v[96:111]
ds_read_b64_tr_b16 v[216:217], v15 offset:36864
ds_read_b64_tr_b16 v[218:219], v15 offset:37888
v_add_f32 v24, v24, v68
v_add_f32 v25, v25, v69
v_cvt_pk_bf16_f32 v34, v68, v69
v_mfma_f32_32x32x16_bf16 v[96:111], a[156:159], a[92:95], v[96:111]
ds_read_b64_tr_b16 v[220:221], v16 offset:36864
ds_read_b64_tr_b16 v[222:223], v16 offset:37888
v_exp_f32 v72, v72
v_exp_f32 v73, v73
v_mfma_f32_32x32x16_bf16 v[112:127], a[160:163], a[64:67], v[48:63]
ds_read_b64_tr_b16 a[192:193], v9 offset:0
ds_read_b64_tr_b16 a[194:195], v9 offset:2048
v_add_f32 v24, v24, v70
v_add_f32 v25, v25, v71
v_cvt_pk_bf16_f32 v35, v70, v71
v_mfma_f32_32x32x16_bf16 v[112:127], a[164:167], a[68:71], v[112:127]
ds_read_b64_tr_b16 a[196:197], v10 offset:0
ds_read_b64_tr_b16 a[198:199], v10 offset:2048
ds_read_b64_tr_b16 a[200:201], v11 offset:0
v_exp_f32 v74, v74
v_exp_f32 v75, v75
v_mfma_f32_32x32x16_bf16 v[112:127], a[168:171], a[72:75], v[112:127]
ds_read_b64_tr_b16 a[202:203], v11 offset:2048
ds_read_b64_tr_b16 a[204:205], v12 offset:0
v_add_f32 v24, v24, v72
v_add_f32 v25, v25, v73
v_cvt_pk_bf16_f32 v36, v72, v73
v_mfma_f32_32x32x16_bf16 v[112:127], a[172:175], a[76:79], v[112:127]
ds_read_b64_tr_b16 a[206:207], v12 offset:2048
ds_read_b64_tr_b16 a[208:209], v9 offset:4096
v_exp_f32 v76, v76
v_exp_f32 v77, v77
v_mfma_f32_32x32x16_bf16 v[112:127], a[176:179], a[80:83], v[112:127]
ds_read_b64_tr_b16 a[210:211], v9 offset:6144
ds_read_b64_tr_b16 a[212:213], v10 offset:4096
ds_read_b64_tr_b16 a[214:215], v10 offset:6144
v_add_f32 v24, v24, v74
v_add_f32 v25, v25, v75
v_cvt_pk_bf16_f32 v37, v74, v75
v_mfma_f32_32x32x16_bf16 v[112:127], a[180:183], a[84:87], v[112:127]
ds_read_b64_tr_b16 a[216:217], v11 offset:4096
ds_read_b64_tr_b16 a[218:219], v11 offset:6144
v_exp_f32 v78, v78
v_exp_f32 v79, v79
v_mfma_f32_32x32x16_bf16 v[112:127], a[184:187], a[88:91], v[112:127]
ds_read_b64_tr_b16 a[220:221], v12 offset:4096
ds_read_b64_tr_b16 a[222:223], v12 offset:6144
v_add_f32 v24, v24, v76
v_add_f32 v25, v25, v77
v_cvt_pk_bf16_f32 v38, v76, v77
v_mfma_f32_32x32x16_bf16 v[112:127], a[188:191], a[92:95], v[112:127]
ds_read_b64_tr_b16 a[224:225], v9 offset:8192
ds_read_b64_tr_b16 a[226:227], v9 offset:10240
v_exp_f32 v80, v80
v_exp_f32 v81, v81
s_waitcnt lgkmcnt(15)
v_mfma_f32_32x32x16_bf16 v[128:143], v[192:195], v[224:227], v[128:143]
ds_read_b64_tr_b16 a[228:229], v10 offset:8192
ds_read_b64_tr_b16 a[230:231], v10 offset:10240
ds_read_b64_tr_b16 a[232:233], v11 offset:8192
v_add_f32 v24, v24, v78
v_add_f32 v25, v25, v79
v_cvt_pk_bf16_f32 v39, v78, v79
v_mfma_f32_32x32x16_bf16 v[144:159], v[196:199], v[224:227], v[144:159]
ds_read_b64_tr_b16 a[234:235], v11 offset:10240
ds_read_b64_tr_b16 a[236:237], v12 offset:8192
v_exp_f32 v82, v82
v_exp_f32 v83, v83
v_mfma_f32_32x32x16_bf16 v[160:175], v[200:203], v[224:227], v[160:175]
ds_read_b64_tr_b16 a[238:239], v12 offset:10240
ds_read_b64_tr_b16 a[240:241], v9 offset:12288
v_add_f32 v24, v24, v80
v_add_f32 v25, v25, v81
v_cvt_pk_bf16_f32 v40, v80, v81
v_mfma_f32_32x32x16_bf16 v[176:191], v[204:207], v[224:227], v[176:191]
ds_read_b64_tr_b16 a[242:243], v9 offset:14336
ds_read_b64_tr_b16 a[244:245], v10 offset:12288
v_exp_f32 v84, v84
v_exp_f32 v85, v85
v_mfma_f32_32x32x16_bf16 v[128:143], v[208:211], v[228:231], v[128:143]
ds_read_b64_tr_b16 a[246:247], v10 offset:14336
ds_read_b64_tr_b16 a[248:249], v11 offset:12288
ds_read_b64_tr_b16 a[250:251], v11 offset:14336
v_add_f32 v24, v24, v82
v_add_f32 v25, v25, v83
v_cvt_pk_bf16_f32 v41, v82, v83
v_mfma_f32_32x32x16_bf16 v[144:159], v[212:215], v[228:231], v[144:159]
ds_read_b64_tr_b16 a[252:253], v12 offset:12288
ds_read_b64_tr_b16 a[254:255], v12 offset:14336
v_exp_f32 v86, v86
v_exp_f32 v87, v87
v_mfma_f32_32x32x16_bf16 v[160:175], v[216:219], v[228:231], v[160:175]
v_add_f32 v24, v24, v84
v_add_f32 v25, v25, v85
v_cvt_pk_bf16_f32 v42, v84, v85
v_mfma_f32_32x32x16_bf16 v[176:191], v[220:223], v[228:231], v[176:191]
s_nop 0
v_add_f32 v24, v24, v86
v_add_f32 v25, v25, v87
v_cvt_pk_bf16_f32 v43, v86, v87
s_waitcnt lgkmcnt(0)
s_barrier
v_mfma_f32_32x32x16_bf16 a[0:15], a[192:195], v[32:35], a[0:15]
ds_read_b128 a[128:131], v1 offset:32768
v_exp_f32 v88, v88
v_mfma_f32_32x32x16_bf16 a[16:31], a[196:199], v[32:35], a[16:31]
ds_read_b128 a[132:135], v2 offset:32768
v_exp_f32 v89, v89
v_exp_f32 v90, v90
v_mul_f32 v128, s52, v128
v_mul_f32 v129, s52, v129
v_mul_f32 v130, s52, v130
v_mul_f32 v131, s52, v131
v_mul_f32 v132, s52, v132
v_mul_f32 v133, s52, v133
v_mul_f32 v134, s52, v134
v_mul_f32 v135, s52, v135
v_mul_f32 v136, s52, v136
v_mfma_f32_32x32x16_bf16 a[32:47], a[200:203], v[32:35], a[32:47]
ds_read_b128 a[136:139], v3 offset:32768
v_exp_f32 v91, v91
v_add_f32 v24, v24, v88
v_mul_f32 v137, s52, v137
v_mul_f32 v138, s52, v138
v_mul_f32 v139, s52, v139
v_mul_f32 v140, s52, v140
v_mul_f32 v141, s52, v141
v_mul_f32 v142, s52, v142
v_mul_f32 v143, s52, v143
v_cvt_pk_bf16_f32 v128, v128, v129
v_mfma_f32_32x32x16_bf16 a[48:63], a[204:207], v[32:35], a[48:63]
ds_read_b128 a[140:143], v4 offset:32768
ds_read_b128 a[144:147], v5 offset:32768
v_add_f32 v25, v25, v89
v_cvt_pk_bf16_f32 v44, v88, v89
v_cvt_pk_bf16_f32 v129, v130, v131
v_cvt_pk_bf16_f32 v130, v132, v133
v_cvt_pk_bf16_f32 v131, v134, v135
v_cvt_pk_bf16_f32 v132, v136, v137
v_cvt_pk_bf16_f32 v133, v138, v139
v_cvt_pk_bf16_f32 v134, v140, v141
v_cvt_pk_bf16_f32 v135, v142, v143
v_accvgpr_write_b32 a96, v128
v_accvgpr_write_b32 a97, v129
v_mfma_f32_32x32x16_bf16 a[0:15], a[208:211], v[36:39], a[0:15]
ds_read_b128 a[148:151], v6 offset:32768
v_exp_f32 v92, v92
v_exp_f32 v93, v93
v_accvgpr_write_b32 a98, v130
v_accvgpr_write_b32 a99, v131
v_accvgpr_write_b32 a100, v132
v_accvgpr_write_b32 a101, v133
v_accvgpr_write_b32 a102, v134
v_accvgpr_write_b32 a103, v135
v_mul_f32 v144, s52, v144
v_mul_f32 v145, s52, v145
v_mfma_f32_32x32x16_bf16 a[16:31], a[212:215], v[36:39], a[16:31]
ds_read_b128 a[152:155], v7 offset:32768
v_add_f32 v24, v24, v90
v_add_f32 v25, v25, v91
v_mul_f32 v146, s52, v146
v_mul_f32 v147, s52, v147
v_mul_f32 v148, s52, v148
v_mul_f32 v149, s52, v149
v_mul_f32 v150, s52, v150
v_mul_f32 v151, s52, v151
v_mul_f32 v152, s52, v152
v_mul_f32 v153, s52, v153
v_mul_f32 v154, s52, v154
v_mfma_f32_32x32x16_bf16 a[32:47], a[216:219], v[36:39], a[32:47]
ds_read_b128 a[156:159], v8 offset:32768
v_cvt_pk_bf16_f32 v45, v90, v91
v_exp_f32 v94, v94
v_mul_f32 v155, s52, v155
v_mul_f32 v156, s52, v156
v_mul_f32 v157, s52, v157
v_mul_f32 v158, s52, v158
v_mul_f32 v159, s52, v159
v_cvt_pk_bf16_f32 v144, v144, v145
v_cvt_pk_bf16_f32 v145, v146, v147
v_cvt_pk_bf16_f32 v146, v148, v149
v_mfma_f32_32x32x16_bf16 a[48:63], a[220:223], v[36:39], a[48:63]
ds_read_b128 a[160:163], v1 offset:40960
v_exp_f32 v95, v95
v_add_f32 v24, v24, v92
v_cvt_pk_bf16_f32 v147, v150, v151
v_cvt_pk_bf16_f32 v148, v152, v153
v_cvt_pk_bf16_f32 v149, v154, v155
v_cvt_pk_bf16_f32 v150, v156, v157
v_cvt_pk_bf16_f32 v151, v158, v159
v_accvgpr_write_b32 a104, v144
v_accvgpr_write_b32 a105, v145
v_accvgpr_write_b32 a106, v146
v_accvgpr_write_b32 a107, v147
v_mfma_f32_32x32x16_bf16 a[0:15], a[224:227], v[40:43], a[0:15]
ds_read_b128 a[164:167], v2 offset:40960
v_add_f32 v25, v25, v93
v_cvt_pk_bf16_f32 v46, v92, v93
s_nop 0
v_accvgpr_write_b32 a108, v148
v_accvgpr_write_b32 a109, v149
v_accvgpr_write_b32 a110, v150
v_accvgpr_write_b32 a111, v151
v_mul_f32 v160, s52, v160
v_mul_f32 v161, s52, v161
v_mul_f32 v162, s52, v162
v_mul_f32 v163, s52, v163
v_mfma_f32_32x32x16_bf16 a[16:31], a[228:231], v[40:43], a[16:31]
ds_read_b128 a[168:171], v3 offset:40960
v_add_f32 v24, v24, v94
v_add_f32 v25, v25, v95
v_cvt_pk_bf16_f32 v47, v94, v95
v_mul_f32 v164, s52, v164
v_mul_f32 v165, s52, v165
v_mul_f32 v166, s52, v166
v_mul_f32 v167, s52, v167
v_mul_f32 v168, s52, v168
v_mul_f32 v169, s52, v169
v_mul_f32 v170, s52, v170
v_mul_f32 v171, s52, v171
v_mul_f32 v172, s52, v172
v_mfma_f32_32x32x16_bf16 a[32:47], a[232:235], v[40:43], a[32:47]
ds_read_b128 a[172:175], v4 offset:40960
ds_read_b128 a[176:179], v5 offset:40960
v_mul_f32 v173, s52, v173
v_mul_f32 v174, s52, v174
v_mul_f32 v175, s52, v175
v_cvt_pk_bf16_f32 v160, v160, v161
v_cvt_pk_bf16_f32 v161, v162, v163
v_cvt_pk_bf16_f32 v162, v164, v165
v_cvt_pk_bf16_f32 v163, v166, v167
v_cvt_pk_bf16_f32 v164, v168, v169
v_max3_f32 v26, v96, v97, v98
v_max3_f32 v26, v26, v99, v100
v_max3_f32 v26, v26, v101, v102
v_mfma_f32_32x32x16_bf16 a[48:63], a[236:239], v[40:43], a[48:63]
ds_read_b128 a[180:183], v6 offset:40960
v_cvt_pk_bf16_f32 v165, v170, v171
v_cvt_pk_bf16_f32 v166, v172, v173
v_cvt_pk_bf16_f32 v167, v174, v175
v_accvgpr_write_b32 a112, v160
v_accvgpr_write_b32 a113, v161
v_accvgpr_write_b32 a114, v162
v_accvgpr_write_b32 a115, v163
v_accvgpr_write_b32 a116, v164
v_accvgpr_write_b32 a117, v165
v_max3_f32 v26, v26, v103, v104
v_max3_f32 v26, v26, v105, v106
v_mfma_f32_32x32x16_bf16 a[0:15], a[240:243], v[44:47], a[0:15]
ds_read_b128 a[184:187], v7 offset:40960
v_accvgpr_write_b32 a118, v166
v_accvgpr_write_b32 a119, v167
v_mul_f32 v176, s52, v176
v_mul_f32 v177, s52, v177
v_mul_f32 v178, s52, v178
v_mul_f32 v179, s52, v179
v_mul_f32 v180, s52, v180
v_mul_f32 v181, s52, v181
v_max3_f32 v26, v26, v107, v108
v_max3_f32 v26, v26, v109, v110
v_max3_f32 v27, v112, v113, v114
v_mfma_f32_32x32x16_bf16 a[16:31], a[244:247], v[44:47], a[16:31]
ds_read_b128 a[188:191], v8 offset:40960
v_mul_f32 v182, s52, v182
v_mul_f32 v183, s52, v183
v_mul_f32 v184, s52, v184
v_mul_f32 v185, s52, v185
v_mul_f32 v186, s52, v186
v_mul_f32 v187, s52, v187
v_mul_f32 v188, s52, v188
v_mul_f32 v189, s52, v189
v_mul_f32 v190, s52, v190
v_max3_f32 v27, v27, v115, v116
v_max3_f32 v27, v27, v117, v118
v_max3_f32 v27, v27, v119, v120
v_mfma_f32_32x32x16_bf16 a[32:47], a[248:251], v[44:47], a[32:47]
v_mul_f32 v191, s52, v191
v_cvt_pk_bf16_f32 v176, v176, v177
v_cvt_pk_bf16_f32 v177, v178, v179
v_cvt_pk_bf16_f32 v178, v180, v181
v_cvt_pk_bf16_f32 v179, v182, v183
v_cvt_pk_bf16_f32 v180, v184, v185
v_cvt_pk_bf16_f32 v181, v186, v187
v_cvt_pk_bf16_f32 v182, v188, v189
v_max3_f32 v27, v27, v121, v122
v_max3_f32 v27, v27, v123, v124
v_mfma_f32_32x32x16_bf16 a[48:63], a[252:255], v[44:47], a[48:63]
v_cvt_pk_bf16_f32 v183, v190, v191
v_accvgpr_write_b32 a120, v176
v_accvgpr_write_b32 a121, v177
v_accvgpr_write_b32 a122, v178
v_accvgpr_write_b32 a123, v179
v_accvgpr_write_b32 a124, v180
v_accvgpr_write_b32 a125, v181
v_accvgpr_write_b32 a126, v182
v_accvgpr_write_b32 a127, v183
v_max3_f32 v27, v27, v125, v126
v_max3_f32 v26, v26, v111, v127
v_max_f32 v26, v26, v27
v_cmp_lt_f32 vcc, s51, v26
s_cbranch_vccz L_norare_8
s_call_b64 s[46:47], L_rare1
L_norare_8:
v_mov_b32 v16, 77824
ds_read_b64 v[18:19], v16
s_waitcnt lgkmcnt(0)
s_barrier
v_mfma_f32_32x32x16_bf16 v[64:79], a[128:131], a[96:99], 0
ds_read_b64_tr_b16 a[192:193], v9 offset:16384
ds_read_b64_tr_b16 a[194:195], v9 offset:18432
v_exp_f32 v96, v96
v_exp_f32 v97, v97
v_mfma_f32_32x32x16_bf16 v[64:79], a[132:135], a[100:103], v[64:79]
ds_read_b64_tr_b16 a[196:197], v10 offset:16384
ds_read_b64_tr_b16 a[198:199], v10 offset:18432
v_exp_f32 v98, v98
v_exp_f32 v99, v99
v_add_f32 v24, v24, v96
v_mfma_f32_32x32x16_bf16 v[64:79], a[136:139], a[104:107], v[64:79]
ds_read_b64_tr_b16 a[200:201], v11 offset:16384
ds_read_b64_tr_b16 a[202:203], v11 offset:18432
v_add_f32 v25, v25, v97
v_cvt_pk_bf16_f32 v32, v96, v97
v_exp_f32 v100, v100
v_mfma_f32_32x32x16_bf16 v[64:79], a[140:143], a[108:111], v[64:79]
ds_read_b64_tr_b16 a[204:205], v12 offset:16384
ds_read_b64_tr_b16 a[206:207], v12 offset:18432
v_exp_f32 v101, v101
v_add_f32 v24, v24, v98
v_add_f32 v25, v25, v99
v_cvt_pk_bf16_f32 v33, v98, v99
v_mfma_f32_32x32x16_bf16 v[64:79], a[144:147], a[112:115], v[64:79]
ds_read_b64_tr_b16 a[208:209], v9 offset:20480
ds_read_b64_tr_b16 a[210:211], v9 offset:22528
v_exp_f32 v102, v102
v_exp_f32 v103, v103
v_mfma_f32_32x32x16_bf16 v[64:79], a[148:151], a[116:119], v[64:79]
ds_read_b64_tr_b16 a[212:213], v10 offset:20480
ds_read_b64_tr_b16 a[214:215], v10 offset:22528
v_add_f32 v24, v24, v100
v_add_f32 v25, v25, v101
v_cvt_pk_bf16_f32 v34, v100, v101
v_exp_f32 v104, v104
v_mfma_f32_32x32x16_bf16 v[64:79], a[152:155], a[120:123], v[64:79]
ds_read_b64_tr_b16 a[216:217], v11 offset:20480
ds_read_b64_tr_b16 a[218:219], v11 offset:22528
v_exp_f32 v105, v105
v_add_f32 v24, v24, v102
v_add_f32 v25, v25, v103
v_mfma_f32_32x32x16_bf16 v[64:79], a[156:159], a[124:127], v[64:79]
ds_read_b64_tr_b16 a[220:221], v12 offset:20480
ds_read_b64_tr_b16 a[222:223], v12 offset:22528
v_cvt_pk_bf16_f32 v35, v102, v103
v_exp_f32 v106, v106
v_exp_f32 v107, v107
v_mfma_f32_32x32x16_bf16 v[80:95], a[160:163], a[96:99], 0
ds_read_b64_tr_b16 a[224:225], v9 offset:24576
ds_read_b64_tr_b16 a[226:227], v9 offset:26624
v_add_f32 v24, v24, v104
v_add_f32 v25, v25, v105
v_cvt_pk_bf16_f32 v36, v104, v105
v_mfma_f32_32x32x16_bf16 v[80:95], a[164:167], a[100:103], v[80:95]
ds_read_b64_tr_b16 a[228:229], v10 offset:24576
ds_read_b64_tr_b16 a[230:231], v10 offset:26624
v_exp_f32 v108, v108
v_exp_f32 v109, v109
v_add_f32 v24, v24, v106
v_mfma_f32_32x32x16_bf16 v[80:95], a[168:171], a[104:107], v[80:95]
ds_read_b64_tr_b16 a[232:233], v11 offset:24576
ds_read_b64_tr_b16 a[234:235], v11 offset:26624
v_add_f32 v25, v25, v107
v_cvt_pk_bf16_f32 v37, v106, v107
v_exp_f32 v110, v110
v_mfma_f32_32x32x16_bf16 v[80:95], a[172:175], a[108:111], v[80:95]
ds_read_b64_tr_b16 a[236:237], v12 offset:24576
ds_read_b64_tr_b16 a[238:239], v12 offset:26624
v_exp_f32 v111, v111
v_add_f32 v24, v24, v108
v_add_f32 v25, v25, v109
v_cvt_pk_bf16_f32 v38, v108, v109
v_mfma_f32_32x32x16_bf16 v[80:95], a[176:179], a[112:115], v[80:95]
ds_read_b64_tr_b16 a[240:241], v9 offset:28672
ds_read_b64_tr_b16 a[242:243], v9 offset:30720
v_exp_f32 v112, v112
v_exp_f32 v113, v113
v_add_f32 v24, v24, v110
v_mfma_f32_32x32x16_bf16 v[80:95], a[180:183], a[116:119], v[80:95]
ds_read_b64_tr_b16 a[244:245], v10 offset:28672
ds_read_b64_tr_b16 a[246:247], v10 offset:30720
v_add_f32 v25, v25, v111
v_cvt_pk_bf16_f32 v39, v110, v111
v_exp_f32 v114, v114
v_mfma_f32_32x32x16_bf16 v[80:95], a[184:187], a[120:123], v[80:95]
ds_read_b64_tr_b16 a[248:249], v11 offset:28672
ds_read_b64_tr_b16 a[250:251], v11 offset:30720
v_exp_f32 v115, v115
v_add_f32 v24, v24, v112
v_add_f32 v25, v25, v113
v_cvt_pk_bf16_f32 v40, v112, v113
v_mfma_f32_32x32x16_bf16 v[80:95], a[188:191], a[124:127], v[80:95]
ds_read_b64_tr_b16 a[252:253], v12 offset:28672
ds_read_b64_tr_b16 a[254:255], v12 offset:30720
s_nop 0
v_add_f32 v24, v24, v114
v_add_f32 v25, v25, v115
v_cvt_pk_bf16_f32 v41, v114, v115
v_and_b32 v16, 4, v0
v_cmp_eq_u32 vcc, 0, v16
v_and_b32 v16, 3, v0
v_lshlrev_b32 v16, 3, v16
v_cndmask_b32 v18, v19, v18, vcc
v_lshrrev_b32 v28, v16, v18
v_bfe_u32 v17, v28, 0, 1
v_bfe_u32 v29, v28, 1, 1
v_lshl_or_b32 v17, v29, 16, v17
v_bfe_u32 v18, v28, 2, 1
v_bfe_u32 v29, v28, 3, 1
v_lshl_or_b32 v18, v29, 16, v18
v_bfe_u32 v19, v28, 4, 1
v_bfe_u32 v29, v28, 5, 1
v_lshl_or_b32 v19, v29, 16, v19
v_bfe_u32 v20, v28, 6, 1
v_bfe_u32 v29, v28, 7, 1
v_lshl_or_b32 v20, v29, 16, v20
v_mov_b32 v16, 0x8000
s_waitcnt lgkmcnt(0)
s_barrier
v_mfma_f32_32x32x16_bf16 a[0:15], a[192:195], v[32:35], a[0:15]
ds_read_b128 a[128:131], v1 offset:0
v_exp_f32 v116, v116
v_exp_f32 v117, v117
v_mfma_f32_32x32x16_bf16 a[16:31], a[196:199], v[32:35], a[16:31]
ds_read_b128 a[132:135], v2 offset:0
v_exp_f32 v118, v118
v_exp_f32 v119, v119
v_mfma_f32_32x32x16_bf16 a[32:47], a[200:203], v[32:35], a[32:47]
ds_read_b128 a[136:139], v3 offset:0
v_add_f32 v24, v24, v116
v_add_f32 v25, v25, v117
v_cvt_pk_bf16_f32 v42, v116, v117
v_mfma_f32_32x32x16_bf16 a[48:63], a[204:207], v[32:35], a[48:63]
ds_read_b128 a[140:143], v4 offset:0
ds_read_b128 a[144:147], v5 offset:0
v_exp_f32 v120, v120
v_exp_f32 v121, v121
v_add_f32 v24, v24, v118
v_max3_f32 v26, v64, v65, v66
v_max3_f32 v26, v26, v67, v68
v_mfma_f32_32x32x16_bf16 a[0:15], a[208:211], v[36:39], a[0:15]
ds_read_b128 a[148:151], v6 offset:0
v_add_f32 v25, v25, v119
v_cvt_pk_bf16_f32 v43, v118, v119
v_exp_f32 v122, v122
v_max3_f32 v26, v26, v69, v70
v_max3_f32 v26, v26, v71, v72
v_mfma_f32_32x32x16_bf16 a[16:31], a[212:215], v[36:39], a[16:31]
ds_read_b128 a[152:155], v7 offset:0
v_exp_f32 v123, v123
v_add_f32 v24, v24, v120
v_max3_f32 v26, v26, v73, v74
v_max3_f32 v26, v26, v75, v76
v_mfma_f32_32x32x16_bf16 a[32:47], a[216:219], v[36:39], a[32:47]
ds_read_b128 a[156:159], v8 offset:0
v_add_f32 v25, v25, v121
v_cvt_pk_bf16_f32 v44, v120, v121
v_exp_f32 v124, v124
v_max3_f32 v26, v26, v77, v78
v_max3_f32 v27, v80, v81, v82
v_mfma_f32_32x32x16_bf16 a[48:63], a[220:223], v[36:39], a[48:63]
ds_read_b128 a[160:163], v1 offset:8192
v_exp_f32 v125, v125
v_add_f32 v24, v24, v122
v_add_f32 v25, v25, v123
v_max3_f32 v27, v27, v83, v84
v_max3_f32 v27, v27, v85, v86
v_mfma_f32_32x32x16_bf16 a[0:15], a[224:227], v[40:43], a[0:15]
ds_read_b128 a[164:167], v2 offset:8192
v_cvt_pk_bf16_f32 v45, v122, v123
v_exp_f32 v126, v126
v_exp_f32 v127, v127
v_max3_f32 v27, v27, v87, v88
v_max3_f32 v27, v27, v89, v90
v_mfma_f32_32x32x16_bf16 a[16:31], a[228:231], v[40:43], a[16:31]
ds_read_b128 a[168:171], v3 offset:8192
v_add_f32 v24, v24, v124
v_add_f32 v25, v25, v125
v_cvt_pk_bf16_f32 v46, v124, v125
v_max3_f32 v27, v27, v91, v92
v_max3_f32 v27, v27, v93, v94
v_mfma_f32_32x32x16_bf16 a[32:47], a[232:235], v[40:43], a[32:47]
ds_read_b128 a[172:175], v4 offset:8192
ds_read_b128 a[176:179], v5 offset:8192
s_nop 0
v_add_f32 v24, v24, v126
v_add_f32 v25, v25, v127
v_cvt_pk_bf16_f32 v47, v126, v127
v_max3_f32 v26, v26, v79, v95
v_max_f32 v26, v26, v27
v_mfma_f32_32x32x16_bf16 a[48:63], a[236:239], v[40:43], a[48:63]
ds_read_b128 a[180:183], v6 offset:8192
v_mov_b32 v28, v26
s_nop 1
v_permlane32_swap_b32 v26, v28
s_nop 0
v_max_f32 v26, v26, v28
v_sub_f32 v48, 0, v26
v_sub_f32 v49, 0, v26
v_sub_f32 v50, 0, v26
v_sub_f32 v51, 0, v26
v_sub_f32 v52, 0, v26
v_sub_f32 v53, 0, v26
v_sub_f32 v54, 0, v26
v_mfma_f32_32x32x16_bf16 a[0:15], a[240:243], v[44:47], a[0:15]
ds_read_b128 a[184:187], v7 offset:8192
v_sub_f32 v55, 0, v26
v_sub_f32 v56, 0, v26
v_sub_f32 v57, 0, v26
v_sub_f32 v58, 0, v26
v_sub_f32 v59, 0, v26
v_sub_f32 v60, 0, v26
v_sub_f32 v61, 0, v26
v_sub_f32 v62, 0, v26
v_sub_f32 v63, 0, v26
v_sub_f32 v64, v64, v26
v_sub_f32 v65, v65, v26
v_sub_f32 v66, v66, v26
v_sub_f32 v67, v67, v26
v_mfma_f32_32x32x16_bf16 a[16:31], a[244:247], v[44:47], a[16:31]
ds_read_b128 a[188:191], v8 offset:8192
v_sub_f32 v68, v68, v26
v_sub_f32 v69, v69, v26
v_sub_f32 v70, v70, v26
v_sub_f32 v71, v71, v26
v_sub_f32 v72, v72, v26
v_sub_f32 v73, v73, v26
v_sub_f32 v74, v74, v26
v_sub_f32 v75, v75, v26
v_sub_f32 v76, v76, v26
v_sub_f32 v77, v77, v26
v_sub_f32 v78, v78, v26
v_sub_f32 v79, v79, v26
v_mfma_f32_32x32x16_bf16 a[32:47], a[248:251], v[44:47], a[32:47]
v_sub_f32 v80, v80, v26
v_sub_f32 v81, v81, v26
v_sub_f32 v82, v82, v26
v_sub_f32 v83, v83, v26
v_sub_f32 v84, v84, v26
v_sub_f32 v85, v85, v26
v_sub_f32 v86, v86, v26
v_sub_f32 v87, v87, v26
v_sub_f32 v88, v88, v26
v_sub_f32 v89, v89, v26
v_sub_f32 v90, v90, v26
v_sub_f32 v91, v91, v26
v_sub_f32 v92, v92, v26
v_mfma_f32_32x32x16_bf16 a[48:63], a[252:255], v[44:47], a[48:63]
v_sub_f32 v93, v93, v26
v_sub_f32 v94, v94, v26
v_sub_f32 v95, v95, v26
v_add_f32 v24, v24, v25
v_mov_b32 v28, v24
s_nop 1
v_permlane32_swap_b32 v24, v28
s_nop 0
v_add_f32 v24, v24, v28
v_rcp_f32 v30, v24
v_mov_b32 v25, 0
v_mov_b32 v24, 0
s_waitcnt lgkmcnt(0)
s_barrier
v_mfma_f32_32x32x16_bf16 v[96:111], a[128:131], a[96:99], v[48:63]
ds_read_b64_tr_b16 a[192:193], v9 offset:0
ds_read_b64_tr_b16 a[194:195], v9 offset:2048
v_accvgpr_read_b32 v240, a0
v_accvgpr_read_b32 v241, a1
v_accvgpr_read_b32 v242, a2
v_accvgpr_read_b32 v243, a3
v_accvgpr_read_b32 v244, a4
v_accvgpr_read_b32 v245, a5
v_accvgpr_read_b32 v246, a6
v_accvgpr_read_b32 v247, a7
v_accvgpr_read_b32 v248, a8
v_accvgpr_read_b32 v249, a9
v_exp_f32 v64, v64
v_exp_f32 v65, v65
v_mfma_f32_32x32x16_bf16 v[96:111], a[132:135], a[100:103], v[96:111]
ds_read_b64_tr_b16 a[196:197], v10 offset:0
ds_read_b64_tr_b16 a[198:199], v10 offset:2048
v_accvgpr_read_b32 v250, a10
v_accvgpr_read_b32 v251, a11
v_accvgpr_read_b32 v252, a12
v_accvgpr_read_b32 v253, a13
v_accvgpr_read_b32 v254, a14
v_accvgpr_read_b32 v255, a15
v_pk_mul_f32 v[240:241], v[240:241], v[30:31] op_sel_hi:[1,0]
v_pk_mul_f32 v[242:243], v[242:243], v[30:31] op_sel_hi:[1,0]
v_pk_mul_f32 v[244:245], v[244:245], v[30:31] op_sel_hi:[1,0]
v_pk_mul_f32 v[246:247], v[246:247], v[30:31] op_sel_hi:[1,0]
v_exp_f32 v66, v66
v_exp_f32 v67, v67
v_add_f32 v24, v24, v64
v_mfma_f32_32x32x16_bf16 v[96:111], a[136:139], a[104:107], v[96:111]
ds_read_b64_tr_b16 a[200:201], v11 offset:0
ds_read_b64_tr_b16 a[202:203], v11 offset:2048
v_pk_mul_f32 v[248:249], v[248:249], v[30:31] op_sel_hi:[1,0]
v_pk_mul_f32 v[250:251], v[250:251], v[30:31] op_sel_hi:[1,0]
v_pk_mul_f32 v[252:253], v[252:253], v[30:31] op_sel_hi:[1,0]
v_pk_mul_f32 v[254:255], v[254:255], v[30:31] op_sel_hi:[1,0]
v_cvt_pk_bf16_f32 v208, v240, v241
v_cvt_pk_bf16_f32 v209, v242, v243
v_cvt_pk_bf16_f32 v210, v244, v245
v_cvt_pk_bf16_f32 v211, v246, v247
v_cvt_pk_bf16_f32 v212, v248, v249
v_cvt_pk_bf16_f32 v213, v250, v251
v_cvt_pk_bf16_f32 v214, v252, v253
v_add_f32 v25, v25, v65
v_cvt_pk_bf16_f32 v32, v64, v65
v_exp_f32 v68, v68
v_mfma_f32_32x32x16_bf16 v[96:111], a[140:143], a[108:111], v[96:111]
ds_read_b64_tr_b16 a[204:205], v12 offset:0
ds_read_b64_tr_b16 a[206:207], v12 offset:2048
v_cvt_pk_bf16_f32 v215, v254, v255
v_accvgpr_write_b32 a64, v208
v_accvgpr_write_b32 a65, v209
v_accvgpr_write_b32 a66, v210
v_accvgpr_write_b32 a67, v211
v_accvgpr_write_b32 a68, v212
v_accvgpr_write_b32 a69, v213
v_accvgpr_write_b32 a70, v214
v_accvgpr_write_b32 a71, v215
v_accvgpr_read_b32 v240, a16
v_exp_f32 v69, v69
v_add_f32 v24, v24, v66
v_add_f32 v25, v25, v67
v_cvt_pk_bf16_f32 v33, v66, v67
v_mfma_f32_32x32x16_bf16 v[96:111], a[144:147], a[112:115], v[96:111]
ds_read_b64_tr_b16 a[208:209], v9 offset:4096
ds_read_b64_tr_b16 a[210:211], v9 offset:6144
v_accvgpr_read_b32 v241, a17
v_accvgpr_read_b32 v242, a18
v_accvgpr_read_b32 v243, a19
v_accvgpr_read_b32 v244, a20
v_accvgpr_read_b32 v245, a21
v_accvgpr_read_b32 v246, a22
v_accvgpr_read_b32 v247, a23
v_accvgpr_read_b32 v248, a24
v_accvgpr_read_b32 v249, a25
v_accvgpr_read_b32 v250, a26
v_exp_f32 v70, v70
v_exp_f32 v71, v71
v_mfma_f32_32x32x16_bf16 v[96:111], a[148:151], a[116:119], v[96:111]
ds_read_b64_tr_b16 a[212:213], v10 offset:4096
ds_read_b64_tr_b16 a[214:215], v10 offset:6144
v_accvgpr_read_b32 v251, a27
v_accvgpr_read_b32 v252, a28
v_accvgpr_read_b32 v253, a29
v_accvgpr_read_b32 v254, a30
v_accvgpr_read_b32 v255, a31
v_pk_mul_f32 v[240:241], v[240:241], v[30:31] op_sel_hi:[1,0]
v_pk_mul_f32 v[242:243], v[242:243], v[30:31] op_sel_hi:[1,0]
v_pk_mul_f32 v[244:245], v[244:245], v[30:31] op_sel_hi:[1,0]
v_pk_mul_f32 v[246:247], v[246:247], v[30:31] op_sel_hi:[1,0]
v_pk_mul_f32 v[248:249], v[248:249], v[30:31] op_sel_hi:[1,0]
v_add_f32 v24, v24, v68
v_add_f32 v25, v25, v69
v_cvt_pk_bf16_f32 v34, v68, v69
v_exp_f32 v72, v72
v_mfma_f32_32x32x16_bf16 v[96:111], a[152:155], a[120:123], v[96:111]
ds_read_b64_tr_b16 a[216:217], v11 offset:4096
ds_read_b64_tr_b16 a[218:219], v11 offset:6144
v_pk_mul_f32 v[250:251], v[250:251], v[30:31] op_sel_hi:[1,0]
v_pk_mul_f32 v[252:253], v[252:253], v[30:31] op_sel_hi:[1,0]
v_pk_mul_f32 v[254:255], v[254:255], v[30:31] op_sel_hi:[1,0]
v_cvt_pk_bf16_f32 v208, v240, v241
v_cvt_pk_bf16_f32 v209, v242, v243
v_cvt_pk_bf16_f32 v210, v244, v245
v_cvt_pk_bf16_f32 v211, v246, v247
v_cvt_pk_bf16_f32 v212, v248, v249
v_cvt_pk_bf16_f32 v213, v250, v251
v_cvt_pk_bf16_f32 v214, v252, v253
v_cvt_pk_bf16_f32 v215, v254, v255
v_exp_f32 v73, v73
v_add_f32 v24, v24, v70
v_add_f32 v25, v25, v71
v_mfma_f32_32x32x16_bf16 v[96:111], a[156:159], a[124:127], v[96:111]
ds_read_b64_tr_b16 a[220:221], v12 offset:4096
ds_read_b64_tr_b16 a[222:223], v12 offset:6144
v_accvgpr_write_b32 a72, v208
v_accvgpr_write_b32 a73, v209
v_accvgpr_write_b32 a74, v210
v_accvgpr_write_b32 a75, v211
v_accvgpr_write_b32 a76, v212
v_accvgpr_write_b32 a77, v213
v_accvgpr_write_b32 a78, v214
v_accvgpr_write_b32 a79, v215
v_accvgpr_read_b32 v240, a32
v_accvgpr_read_b32 v241, a33
v_cvt_pk_bf16_f32 v35, v70, v71
v_exp_f32 v74, v74
v_exp_f32 v75, v75
v_mfma_f32_32x32x16_bf16 v[112:127], a[160:163], a[96:99], v[48:63]
ds_read_b64_tr_b16 a[224:225], v9 offset:8192
ds_read_b64_tr_b16 a[226:227], v9 offset:10240
v_accvgpr_read_b32 v242, a34
v_accvgpr_read_b32 v243, a35
v_accvgpr_read_b32 v244, a36
v_accvgpr_read_b32 v245, a37
v_accvgpr_read_b32 v246, a38
v_accvgpr_read_b32 v247, a39
v_accvgpr_read_b32 v248, a40
v_accvgpr_read_b32 v249, a41
v_accvgpr_read_b32 v250, a42
v_accvgpr_read_b32 v251, a43
v_add_f32 v24, v24, v72
v_add_f32 v25, v25, v73
v_cvt_pk_bf16_f32 v36, v72, v73
v_mfma_f32_32x32x16_bf16 v[112:127], a[164:167], a[100:103], v[112:127]
ds_read_b64_tr_b16 a[228:229], v10 offset:8192
ds_read_b64_tr_b16 a[230:231], v10 offset:10240
v_accvgpr_read_b32 v252, a44
v_accvgpr_read_b32 v253, a45
v_accvgpr_read_b32 v254, a46
v_accvgpr_read_b32 v255, a47
v_pk_mul_f32 v[240:241], v[240:241], v[30:31] op_sel_hi:[1,0]
v_pk_mul_f32 v[242:243], v[242:243], v[30:31] op_sel_hi:[1,0]
v_pk_mul_f32 v[244:245], v[244:245], v[30:31] op_sel_hi:[1,0]
v_pk_mul_f32 v[246:247], v[246:247], v[30:31] op_sel_hi:[1,0]
v_pk_mul_f32 v[248:249], v[248:249], v[30:31] op_sel_hi:[1,0]
v_pk_mul_f32 v[250:251], v[250:251], v[30:31] op_sel_hi:[1,0]
v_exp_f32 v76, v76
v_exp_f32 v77, v77
v_add_f32 v24, v24, v74
v_mfma_f32_32x32x16_bf16 v[112:127], a[168:171], a[104:107], v[112:127]
ds_read_b64_tr_b16 a[232:233], v11 offset:8192
ds_read_b64_tr_b16 a[234:235], v11 offset:10240
v_pk_mul_f32 v[252:253], v[252:253], v[30:31] op_sel_hi:[1,0]
v_pk_mul_f32 v[254:255], v[254:255], v[30:31] op_sel_hi:[1,0]
v_cvt_pk_bf16_f32 v208, v240, v241
v_cvt_pk_bf16_f32 v209, v242, v243
v_cvt_pk_bf16_f32 v210, v244, v245
v_cvt_pk_bf16_f32 v211, v246, v247
v_cvt_pk_bf16_f32 v212, v248, v249
v_cvt_pk_bf16_f32 v213, v250, v251
v_cvt_pk_bf16_f32 v214, v252, v253
v_cvt_pk_bf16_f32 v215, v254, v255
v_accvgpr_write_b32 a80, v208
v_add_f32 v25, v25, v75
v_cvt_pk_bf16_f32 v37, v74, v75
v_exp_f32 v78, v78
v_mfma_f32_32x32x16_bf16 v[112:127], a[172:175], a[108:111], v[112:127]
ds_read_b64_tr_b16 a[236:237], v12 offset:8192
ds_read_b64_tr_b16 a[238:239], v12 offset:10240
v_accvgpr_write_b32 a81, v209
v_accvgpr_write_b32 a82, v210
v_accvgpr_write_b32 a83, v211
v_accvgpr_write_b32 a84, v212
v_accvgpr_write_b32 a85, v213
v_accvgpr_write_b32 a86, v214
v_accvgpr_write_b32 a87, v215
v_accvgpr_read_b32 v240, a48
v_accvgpr_read_b32 v241, a49
v_accvgpr_read_b32 v242, a50
v_exp_f32 v79, v79
v_add_f32 v24, v24, v76
v_add_f32 v25, v25, v77
v_cvt_pk_bf16_f32 v38, v76, v77
v_mfma_f32_32x32x16_bf16 v[112:127], a[176:179], a[112:115], v[112:127]
ds_read_b64_tr_b16 a[240:241], v9 offset:12288
ds_read_b64_tr_b16 a[242:243], v9 offset:14336
v_accvgpr_read_b32 v243, a51
v_accvgpr_read_b32 v244, a52
v_accvgpr_read_b32 v245, a53
v_accvgpr_read_b32 v246, a54
v_accvgpr_read_b32 v247, a55
v_accvgpr_read_b32 v248, a56
v_accvgpr_read_b32 v249, a57
v_accvgpr_read_b32 v250, a58
v_accvgpr_read_b32 v251, a59
v_accvgpr_read_b32 v252, a60
v_exp_f32 v80, v80
v_exp_f32 v81, v81
v_add_f32 v24, v24, v78
v_mfma_f32_32x32x16_bf16 v[112:127], a[180:183], a[116:119], v[112:127]
ds_read_b64_tr_b16 a[244:245], v10 offset:12288
ds_read_b64_tr_b16 a[246:247], v10 offset:14336
v_accvgpr_read_b32 v253, a61
v_accvgpr_read_b32 v254, a62
v_accvgpr_read_b32 v255, a63
v_pk_mul_f32 v[240:241], v[240:241], v[30:31] op_sel_hi:[1,0]
v_pk_mul_f32 v[242:243], v[242:243], v[30:31] op_sel_hi:[1,0]
v_pk_mul_f32 v[244:245], v[244:245], v[30:31] op_sel_hi:[1,0]
v_pk_mul_f32 v[246:247], v[246:247], v[30:31] op_sel_hi:[1,0]
v_pk_mul_f32 v[248:249], v[248:249], v[30:31] op_sel_hi:[1,0]
v_pk_mul_f32 v[250:251], v[250:251], v[30:31] op_sel_hi:[1,0]
v_pk_mul_f32 v[252:253], v[252:253], v[30:31] op_sel_hi:[1,0]
v_add_f32 v25, v25, v79
v_cvt_pk_bf16_f32 v39, v78, v79
v_exp_f32 v82, v82
v_mfma_f32_32x32x16_bf16 v[112:127], a[184:187], a[120:123], v[112:127]
ds_read_b64_tr_b16 a[248:249], v11 offset:12288
ds_read_b64_tr_b16 a[250:251], v11 offset:14336
v_pk_mul_f32 v[254:255], v[254:255], v[30:31] op_sel_hi:[1,0]
v_cvt_pk_bf16_f32 v208, v240, v241
v_cvt_pk_bf16_f32 v209, v242, v243
v_cvt_pk_bf16_f32 v210, v244, v245
v_cvt_pk_bf16_f32 v211, v246, v247
v_cvt_pk_bf16_f32 v212, v248, v249
v_cvt_pk_bf16_f32 v213, v250, v251
v_cvt_pk_bf16_f32 v214, v252, v253
v_cvt_pk_bf16_f32 v215, v254, v255
v_accvgpr_write_b32 a88, v208
v_accvgpr_write_b32 a89, v209
v_exp_f32 v83, v83
v_add_f32 v24, v24, v80
v_add_f32 v25, v25, v81
v_cvt_pk_bf16_f32 v40, v80, v81
v_mfma_f32_32x32x16_bf16 v[112:127], a[188:191], a[124:127], v[112:127]
ds_read_b64_tr_b16 a[252:253], v12 offset:12288
ds_read_b64_tr_b16 a[254:255], v12 offset:14336
v_accvgpr_write_b32 a90, v210
v_accvgpr_write_b32 a91, v211
v_accvgpr_write_b32 a92, v212
v_accvgpr_write_b32 a93, v213
v_accvgpr_write_b32 a94, v214
v_accvgpr_write_b32 a95, v215
v_add_u32 v13, 61440, v21
v_add_u32 v14, 122880, v21
v_and_b32 v15, 3, v0
v_lshlrev_b32 v15, 2, v15
s_nop 0
v_add_f32 v24, v24, v82
v_add_f32 v25, v25, v83
v_cvt_pk_bf16_f32 v41, v82, v83
s_waitcnt lgkmcnt(0)
s_barrier
v_mfma_f32_32x32x16_bf16 a[0:15], a[192:195], v[32:35], 0
ds_read_b64_tr_b16 v[208:209], v21 offset:0
v_exp_f32 v84, v84
v_exp_f32 v85, v85
v_mfma_f32_32x32x16_bf16 a[16:31], a[196:199], v[32:35], 0
ds_read_b64_tr_b16 v[210:211], v21 offset:1280
ds_read_b64_tr_b16 v[212:213], v21 offset:64
v_exp_f32 v86, v86
v_exp_f32 v87, v87
v_mfma_f32_32x32x16_bf16 a[32:47], a[200:203], v[32:35], 0
ds_read_b64_tr_b16 v[214:215], v21 offset:1344
v_add_f32 v24, v24, v84
v_add_f32 v25, v25, v85
v_cvt_pk_bf16_f32 v42, v84, v85
v_mfma_f32_32x32x16_bf16 a[48:63], a[204:207], v[32:35], 0
ds_read_b64_tr_b16 v[216:217], v21 offset:128
ds_read_b64_tr_b16 v[218:219], v21 offset:1408
v_exp_f32 v88, v88
v_exp_f32 v89, v89
v_add_f32 v24, v24, v86
v_mfma_f32_32x32x16_bf16 a[0:15], a[208:211], v[36:39], a[0:15]
ds_read_b64_tr_b16 v[220:221], v21 offset:192
v_add_f32 v25, v25, v87
v_cvt_pk_bf16_f32 v43, v86, v87
v_exp_f32 v90, v90
v_mfma_f32_32x32x16_bf16 a[16:31], a[212:215], v[36:39], a[16:31]
ds_read_b64_tr_b16 v[222:223], v21 offset:1472
ds_read_b64_tr_b16 v[224:225], v21 offset:256
v_exp_f32 v91, v91
v_add_f32 v24, v24, v88
v_mfma_f32_32x32x16_bf16 a[32:47], a[216:219], v[36:39], a[32:47]
ds_read_b64_tr_b16 v[226:227], v21 offset:1536
v_add_f32 v25, v25, v89
v_cvt_pk_bf16_f32 v44, v88, v89
v_exp_f32 v92, v92
v_mfma_f32_32x32x16_bf16 a[48:63], a[220:223], v[36:39], a[48:63]
ds_read_b64_tr_b16 v[228:229], v21 offset:5120
ds_read_b64_tr_b16 v[230:231], v21 offset:6400
v_exp_f32 v93, v93
v_add_f32 v24, v24, v90
v_add_f32 v25, v25, v91
v_mfma_f32_32x32x16_bf16 a[0:15], a[224:227], v[40:43], a[0:15]
ds_read_b64_tr_b16 v[232:233], v21 offset:5184
v_cvt_pk_bf16_f32 v45, v90, v91
v_exp_f32 v94, v94
v_exp_f32 v95, v95
v_mfma_f32_32x32x16_bf16 a[16:31], a[228:231], v[40:43], a[16:31]
ds_read_b64_tr_b16 v[234:235], v21 offset:6464
ds_read_b64_tr_b16 v[236:237], v21 offset:5248
v_add_f32 v24, v24, v92
v_add_f32 v25, v25, v93
v_cvt_pk_bf16_f32 v46, v92, v93
v_mfma_f32_32x32x16_bf16 a[32:47], a[232:235], v[40:43], a[32:47]
ds_read_b64_tr_b16 v[238:239], v21 offset:6528
s_nop 0
v_add_f32 v24, v24, v94
v_add_f32 v25, v25, v95
v_cvt_pk_bf16_f32 v47, v94, v95
v_max3_f32 v26, v96, v97, v98
v_mfma_f32_32x32x16_bf16 a[48:63], a[236:239], v[40:43], a[48:63]
ds_read_b64_tr_b16 v[240:241], v21 offset:5312
ds_read_b64_tr_b16 v[242:243], v21 offset:6592
v_max3_f32 v26, v26, v99, v100
v_mfma_f32_32x32x16_bf16 a[0:15], a[240:243], v[44:47], a[0:15]
ds_read_b64_tr_b16 v[244:245], v21 offset:5376
v_max3_f32 v26, v26, v101, v102
v_mfma_f32_32x32x16_bf16 a[16:31], a[244:247], v[44:47], a[16:31]
ds_read_b64_tr_b16 v[246:247], v21 offset:6656
ds_read_b128 a[128:131], v1 offset:16384
v_max3_f32 v26, v26, v103, v104
v_mfma_f32_32x32x16_bf16 a[32:47], a[248:251], v[44:47], a[32:47]
ds_read_b128 a[132:135], v2 offset:16384
v_max3_f32 v26, v26, v105, v106
v_mfma_f32_32x32x16_bf16 a[48:63], a[252:255], v[44:47], a[48:63]
ds_read_b128 a[136:139], v3 offset:16384
ds_read_b128 a[140:143], v4 offset:16384
v_max3_f32 v26, v26, v107, v108
s_waitcnt lgkmcnt(15)
v_mfma_f32_32x32x16_bf16 v[128:143], v[208:211], a[64:67], 0
ds_read_b128 a[144:147], v5 offset:16384
v_max3_f32 v26, v26, v109, v110
v_mfma_f32_32x32x16_bf16 v[144:159], v[212:215], a[64:67], 0
ds_read_b128 a[148:151], v6 offset:16384
ds_read_b128 a[152:155], v7 offset:16384
v_max3_f32 v27, v112, v113, v114
v_mfma_f32_32x32x16_bf16 v[160:175], v[216:219], a[64:67], 0
ds_read_b128 a[156:159], v8 offset:16384
v_max3_f32 v27, v27, v115, v116
v_mfma_f32_32x32x16_bf16 v[176:191], v[220:223], a[64:67], 0
ds_read_b128 a[160:163], v1 offset:24576
ds_read_b128 a[164:167], v2 offset:24576
v_max3_f32 v27, v27, v117, v118
s_waitcnt lgkmcnt(15)
v_mfma_f32_32x32x16_bf16 v[192:207], v[224:227], a[64:67], 0
ds_read_b128 a[168:171], v3 offset:24576
v_max3_f32 v27, v27, v119, v120
v_mfma_f32_32x32x16_bf16 v[128:143], v[228:231], a[68:71], v[128:143]
ds_read_b128 a[172:175], v4 offset:24576
ds_read_b128 a[176:179], v5 offset:24576
v_max3_f32 v27, v27, v121, v122
v_mfma_f32_32x32x16_bf16 v[144:159], v[232:235], a[68:71], v[144:159]
ds_read_b128 a[180:183], v6 offset:24576
v_max3_f32 v27, v27, v123, v124
s_waitcnt lgkmcnt(15)
v_mfma_f32_32x32x16_bf16 v[160:175], v[236:239], a[68:71], v[160:175]
ds_read_b128 a[184:187], v7 offset:24576
ds_read_b128 a[188:191], v8 offset:24576
v_max3_f32 v27, v27, v125, v126
v_mfma_f32_32x32x16_bf16 v[176:191], v[240:243], a[68:71], v[176:191]
v_max3_f32 v26, v26, v111, v127
s_waitcnt lgkmcnt(15)
v_mfma_f32_32x32x16_bf16 v[192:207], v[244:247], a[68:71], v[192:207]
v_max_f32 v26, v26, v27
v_cmp_lt_f32 vcc, s51, v26
s_cbranch_vccz L_norare_9
s_call_b64 s[46:47], L_rare1
L_norare_9:
s_add_u32 s41, s50, 0
buffer_store_dwordx4 a[64:67], v23, s[24:27], s41 offen offset:0 sc1
buffer_store_dwordx4 a[68:71], v23, s[24:27], s41 offen offset:1024 sc1
s_add_u32 s41, s50, 6144
buffer_store_dwordx4 a[72:75], v23, s[24:27], s41 offen offset:0 sc1
buffer_store_dwordx4 a[76:79], v23, s[24:27], s41 offen offset:1024 sc1
s_add_u32 s41, s50, 12288
buffer_store_dwordx4 a[80:83], v23, s[24:27], s41 offen offset:0 sc1
buffer_store_dwordx4 a[84:87], v23, s[24:27], s41 offen offset:1024 sc1
s_add_u32 s41, s50, 18432
buffer_store_dwordx4 a[88:91], v23, s[24:27], s41 offen offset:0 sc1
buffer_store_dwordx4 a[92:95], v23, s[24:27], s41 offen offset:1024 sc1
s_waitcnt lgkmcnt(0)
s_barrier
v_mfma_f32_32x32x16_bf16 v[64:79], a[128:131], a[96:99], v[48:63]
ds_read_b64_tr_b16 a[192:193], v9 offset:16384
ds_read_b64_tr_b16 a[194:195], v9 offset:18432
v_exp_f32 v96, v96
v_exp_f32 v97, v97
v_mfma_f32_32x32x16_bf16 v[64:79], a[132:135], a[100:103], v[64:79]
ds_read_b64_tr_b16 a[196:197], v10 offset:16384
ds_read_b64_tr_b16 a[198:199], v10 offset:18432
v_exp_f32 v98, v98
v_exp_f32 v99, v99
v_add_f32 v24, v24, v96
v_mfma_f32_32x32x16_bf16 v[64:79], a[136:139], a[104:107], v[64:79]
ds_read_b64_tr_b16 a[200:201], v11 offset:16384
ds_read_b64_tr_b16 a[202:203], v11 offset:18432
v_add_f32 v25, v25, v97
v_cvt_pk_bf16_f32 v32, v96, v97
v_exp_f32 v100, v100
v_mfma_f32_32x32x16_bf16 v[64:79], a[140:143], a[108:111], v[64:79]
ds_read_b64_tr_b16 a[204:205], v12 offset:16384
ds_read_b64_tr_b16 a[206:207], v12 offset:18432
v_exp_f32 v101, v101
v_add_f32 v24, v24, v98
v_add_f32 v25, v25, v99
v_cvt_pk_bf16_f32 v33, v98, v99
v_mfma_f32_32x32x16_bf16 v[64:79], a[144:147], a[112:115], v[64:79]
ds_read_b64_tr_b16 a[208:209], v9 offset:20480
ds_read_b64_tr_b16 a[210:211], v9 offset:22528
v_exp_f32 v102, v102
v_exp_f32 v103, v103
v_mfma_f32_32x32x16_bf16 v[64:79], a[148:151], a[116:119], v[64:79]
ds_read_b64_tr_b16 a[212:213], v10 offset:20480
ds_read_b64_tr_b16 a[214:215], v10 offset:22528
v_add_f32 v24, v24, v100
v_add_f32 v25, v25, v101
v_cvt_pk_bf16_f32 v34, v100, v101
v_exp_f32 v104, v104
v_mfma_f32_32x32x16_bf16 v[64:79], a[152:155], a[120:123], v[64:79]
ds_read_b64_tr_b16 a[216:217], v11 offset:20480
ds_read_b64_tr_b16 a[218:219], v11 offset:22528
v_exp_f32 v105, v105
v_add_f32 v24, v24, v102
v_add_f32 v25, v25, v103
v_mfma_f32_32x32x16_bf16 v[64:79], a[156:159], a[124:127], v[64:79]
ds_read_b64_tr_b16 a[220:221], v12 offset:20480
ds_read_b64_tr_b16 a[222:223], v12 offset:22528
v_cvt_pk_bf16_f32 v35, v102, v103
v_exp_f32 v106, v106
v_exp_f32 v107, v107
v_mfma_f32_32x32x16_bf16 v[80:95], a[160:163], a[96:99], v[48:63]
ds_read_b64_tr_b16 a[224:225], v9 offset:24576
ds_read_b64_tr_b16 a[226:227], v9 offset:26624
v_add_f32 v24, v24, v104
v_add_f32 v25, v25, v105
v_cvt_pk_bf16_f32 v36, v104, v105
v_mfma_f32_32x32x16_bf16 v[80:95], a[164:167], a[100:103], v[80:95]
ds_read_b64_tr_b16 a[228:229], v10 offset:24576
ds_read_b64_tr_b16 a[230:231], v10 offset:26624
v_exp_f32 v108, v108
v_exp_f32 v109, v109
v_add_f32 v24, v24, v106
v_mfma_f32_32x32x16_bf16 v[80:95], a[168:171], a[104:107], v[80:95]
ds_read_b64_tr_b16 a[232:233], v11 offset:24576
ds_read_b64_tr_b16 a[234:235], v11 offset:26624
v_add_f32 v25, v25, v107
v_cvt_pk_bf16_f32 v37, v106, v107
v_exp_f32 v110, v110
v_mfma_f32_32x32x16_bf16 v[80:95], a[172:175], a[108:111], v[80:95]
ds_read_b64_tr_b16 a[236:237], v12 offset:24576
ds_read_b64_tr_b16 a[238:239], v12 offset:26624
v_exp_f32 v111, v111
v_add_f32 v24, v24, v108
v_add_f32 v25, v25, v109
v_cvt_pk_bf16_f32 v38, v108, v109
v_mfma_f32_32x32x16_bf16 v[80:95], a[176:179], a[112:115], v[80:95]
ds_read_b64_tr_b16 a[240:241], v9 offset:28672
ds_read_b64_tr_b16 a[242:243], v9 offset:30720
v_exp_f32 v112, v112
v_exp_f32 v113, v113
v_add_f32 v24, v24, v110
v_mfma_f32_32x32x16_bf16 v[80:95], a[180:183], a[116:119], v[80:95]
ds_read_b64_tr_b16 a[244:245], v10 offset:28672
ds_read_b64_tr_b16 a[246:247], v10 offset:30720
v_add_f32 v25, v25, v111
v_cvt_pk_bf16_f32 v39, v110, v111
v_exp_f32 v114, v114
v_mfma_f32_32x32x16_bf16 v[80:95], a[184:187], a[120:123], v[80:95]
ds_read_b64_tr_b16 a[248:249], v11 offset:28672
ds_read_b64_tr_b16 a[250:251], v11 offset:30720
v_exp_f32 v115, v115
v_add_f32 v24, v24, v112
v_add_f32 v25, v25, v113
v_cvt_pk_bf16_f32 v40, v112, v113
v_mfma_f32_32x32x16_bf16 v[80:95], a[188:191], a[124:127], v[80:95]
ds_read_b64_tr_b16 a[252:253], v12 offset:28672
ds_read_b64_tr_b16 a[254:255], v12 offset:30720
s_nop 0
v_add_f32 v24, v24, v114
v_add_f32 v25, v25, v115
v_cvt_pk_bf16_f32 v41, v114, v115
s_waitcnt lgkmcnt(0)
s_barrier
v_mfma_f32_32x32x16_bf16 a[0:15], a[192:195], v[32:35], a[0:15]
ds_read_b64_tr_b16 v[208:209], v21 offset:10240
v_exp_f32 v116, v116
v_exp_f32 v117, v117
v_mfma_f32_32x32x16_bf16 a[16:31], a[196:199], v[32:35], a[16:31]
ds_read_b64_tr_b16 v[210:211], v21 offset:11520
ds_read_b64_tr_b16 v[212:213], v21 offset:10304
v_exp_f32 v118, v118
v_exp_f32 v119, v119
v_mfma_f32_32x32x16_bf16 a[32:47], a[200:203], v[32:35], a[32:47]
ds_read_b64_tr_b16 v[214:215], v21 offset:11584
v_add_f32 v24, v24, v116
v_add_f32 v25, v25, v117
v_cvt_pk_bf16_f32 v42, v116, v117
v_mfma_f32_32x32x16_bf16 a[48:63], a[204:207], v[32:35], a[48:63]
ds_read_b64_tr_b16 v[216:217], v21 offset:10368
ds_read_b64_tr_b16 v[218:219], v21 offset:11648
v_exp_f32 v120, v120
v_exp_f32 v121, v121
v_add_f32 v24, v24, v118
v_mfma_f32_32x32x16_bf16 a[0:15], a[208:211], v[36:39], a[0:15]
ds_read_b64_tr_b16 v[220:221], v21 offset:10432
v_add_f32 v25, v25, v119
v_cvt_pk_bf16_f32 v43, v118, v119
v_exp_f32 v122, v122
v_mfma_f32_32x32x16_bf16 a[16:31], a[212:215], v[36:39], a[16:31]
ds_read_b64_tr_b16 v[222:223], v21 offset:11712
ds_read_b64_tr_b16 v[224:225], v21 offset:10496
v_exp_f32 v123, v123
v_add_f32 v24, v24, v120
v_mfma_f32_32x32x16_bf16 a[32:47], a[216:219], v[36:39], a[32:47]
ds_read_b64_tr_b16 v[226:227], v21 offset:11776
v_add_f32 v25, v25, v121
v_cvt_pk_bf16_f32 v44, v120, v121
v_exp_f32 v124, v124
v_mfma_f32_32x32x16_bf16 a[48:63], a[220:223], v[36:39], a[48:63]
ds_read_b64_tr_b16 v[228:229], v21 offset:15360
ds_read_b64_tr_b16 v[230:231], v21 offset:16640
v_exp_f32 v125, v125
v_add_f32 v24, v24, v122
v_add_f32 v25, v25, v123
v_mfma_f32_32x32x16_bf16 a[0:15], a[224:227], v[40:43], a[0:15]
ds_read_b64_tr_b16 v[232:233], v21 offset:15424
v_cvt_pk_bf16_f32 v45, v122, v123
v_exp_f32 v126, v126
v_exp_f32 v127, v127
v_mfma_f32_32x32x16_bf16 a[16:31], a[228:231], v[40:43], a[16:31]
ds_read_b64_tr_b16 v[234:235], v21 offset:16704
ds_read_b64_tr_b16 v[236:237], v21 offset:15488
v_add_f32 v24, v24, v124
v_add_f32 v25, v25, v125
v_cvt_pk_bf16_f32 v46, v124, v125
v_mfma_f32_32x32x16_bf16 a[32:47], a[232:235], v[40:43], a[32:47]
ds_read_b64_tr_b16 v[238:239], v21 offset:16768
s_nop 0
v_add_f32 v24, v24, v126
v_add_f32 v25, v25, v127
v_cvt_pk_bf16_f32 v47, v126, v127
v_max3_f32 v26, v64, v65, v66
v_mfma_f32_32x32x16_bf16 a[48:63], a[236:239], v[40:43], a[48:63]
ds_read_b64_tr_b16 v[240:241], v21 offset:15552
ds_read_b64_tr_b16 v[242:243], v21 offset:16832
v_max3_f32 v26, v26, v67, v68
v_mfma_f32_32x32x16_bf16 a[0:15], a[240:243], v[44:47], a[0:15]
ds_read_b64_tr_b16 v[244:245], v21 offset:15616
v_max3_f32 v26, v26, v69, v70
v_mfma_f32_32x32x16_bf16 a[16:31], a[244:247], v[44:47], a[16:31]
ds_read_b64_tr_b16 v[246:247], v21 offset:16896
ds_read_b128 a[128:131], v1 offset:32768
v_max3_f32 v26, v26, v71, v72
v_mfma_f32_32x32x16_bf16 a[32:47], a[248:251], v[44:47], a[32:47]
ds_read_b128 a[132:135], v2 offset:32768
v_max3_f32 v26, v26, v73, v74
v_mfma_f32_32x32x16_bf16 a[48:63], a[252:255], v[44:47], a[48:63]
ds_read_b128 a[136:139], v3 offset:32768
ds_read_b128 a[140:143], v4 offset:32768
v_max3_f32 v26, v26, v75, v76
s_waitcnt lgkmcnt(15)
v_mfma_f32_32x32x16_bf16 v[128:143], v[208:211], a[72:75], v[128:143]
ds_read_b128 a[144:147], v5 offset:32768
v_max3_f32 v26, v26, v77, v78
v_mfma_f32_32x32x16_bf16 v[144:159], v[212:215], a[72:75], v[144:159]
ds_read_b128 a[148:151], v6 offset:32768
ds_read_b128 a[152:155], v7 offset:32768
v_max3_f32 v27, v80, v81, v82
v_mfma_f32_32x32x16_bf16 v[160:175], v[216:219], a[72:75], v[160:175]
ds_read_b128 a[156:159], v8 offset:32768
v_max3_f32 v27, v27, v83, v84
v_mfma_f32_32x32x16_bf16 v[176:191], v[220:223], a[72:75], v[176:191]
ds_read_b128 a[160:163], v1 offset:40960
ds_read_b128 a[164:167], v2 offset:40960
v_max3_f32 v27, v27, v85, v86
s_waitcnt lgkmcnt(15)
v_mfma_f32_32x32x16_bf16 v[192:207], v[224:227], a[72:75], v[192:207]
ds_read_b128 a[168:171], v3 offset:40960
v_max3_f32 v27, v27, v87, v88
v_mfma_f32_32x32x16_bf16 v[128:143], v[228:231], a[76:79], v[128:143]
ds_read_b128 a[172:175], v4 offset:40960
ds_read_b128 a[176:179], v5 offset:40960
v_max3_f32 v27, v27, v89, v90
v_mfma_f32_32x32x16_bf16 v[144:159], v[232:235], a[76:79], v[144:159]
ds_read_b128 a[180:183], v6 offset:40960
v_max3_f32 v27, v27, v91, v92
s_waitcnt lgkmcnt(15)
v_mfma_f32_32x32x16_bf16 v[160:175], v[236:239], a[76:79], v[160:175]
ds_read_b128 a[184:187], v7 offset:40960
ds_read_b128 a[188:191], v8 offset:40960
v_max3_f32 v27, v27, v93, v94
v_mfma_f32_32x32x16_bf16 v[176:191], v[240:243], a[76:79], v[176:191]
v_max3_f32 v26, v26, v79, v95
s_waitcnt lgkmcnt(15)
v_mfma_f32_32x32x16_bf16 v[192:207], v[244:247], a[76:79], v[192:207]
v_max_f32 v26, v26, v27
v_cmp_lt_f32 vcc, s51, v26
s_cbranch_vccz L_norare_10
s_call_b64 s[46:47], L_rare0
L_norare_10:
s_waitcnt lgkmcnt(0)
s_barrier
v_mfma_f32_32x32x16_bf16 v[96:111], a[128:131], a[96:99], v[48:63]
ds_read_b64_tr_b16 a[192:193], v9 offset:0
ds_read_b64_tr_b16 a[194:195], v9 offset:2048
v_exp_f32 v64, v64
v_exp_f32 v65, v65
v_mfma_f32_32x32x16_bf16 v[96:111], a[132:135], a[100:103], v[96:111]
ds_read_b64_tr_b16 a[196:197], v10 offset:0
ds_read_b64_tr_b16 a[198:199], v10 offset:2048
v_exp_f32 v66, v66
v_exp_f32 v67, v67
v_add_f32 v24, v24, v64
v_mfma_f32_32x32x16_bf16 v[96:111], a[136:139], a[104:107], v[96:111]
ds_read_b64_tr_b16 a[200:201], v11 offset:0
ds_read_b64_tr_b16 a[202:203], v11 offset:2048
v_add_f32 v25, v25, v65
v_cvt_pk_bf16_f32 v32, v64, v65
v_exp_f32 v68, v68
v_mfma_f32_32x32x16_bf16 v[96:111], a[140:143], a[108:111], v[96:111]
ds_read_b64_tr_b16 a[204:205], v12 offset:0
ds_read_b64_tr_b16 a[206:207], v12 offset:2048
v_exp_f32 v69, v69
v_add_f32 v24, v24, v66
v_add_f32 v25, v25, v67
v_cvt_pk_bf16_f32 v33, v66, v67
v_mfma_f32_32x32x16_bf16 v[96:111], a[144:147], a[112:115], v[96:111]
ds_read_b64_tr_b16 a[208:209], v9 offset:4096
ds_read_b64_tr_b16 a[210:211], v9 offset:6144
v_exp_f32 v70, v70
v_exp_f32 v71, v71
v_mfma_f32_32x32x16_bf16 v[96:111], a[148:151], a[116:119], v[96:111]
ds_read_b64_tr_b16 a[212:213], v10 offset:4096
ds_read_b64_tr_b16 a[214:215], v10 offset:6144
v_add_f32 v24, v24, v68
v_add_f32 v25, v25, v69
v_cvt_pk_bf16_f32 v34, v68, v69
v_exp_f32 v72, v72
v_mfma_f32_32x32x16_bf16 v[96:111], a[152:155], a[120:123], v[96:111]
ds_read_b64_tr_b16 a[216:217], v11 offset:4096
ds_read_b64_tr_b16 a[218:219], v11 offset:6144
v_exp_f32 v73, v73
v_add_f32 v24, v24, v70
v_add_f32 v25, v25, v71
v_mfma_f32_32x32x16_bf16 v[96:111], a[156:159], a[124:127], v[96:111]
ds_read_b64_tr_b16 a[220:221], v12 offset:4096
ds_read_b64_tr_b16 a[222:223], v12 offset:6144
v_cvt_pk_bf16_f32 v35, v70, v71
v_exp_f32 v74, v74
v_exp_f32 v75, v75
v_mfma_f32_32x32x16_bf16 v[112:127], a[160:163], a[96:99], v[48:63]
ds_read_b64_tr_b16 a[224:225], v9 offset:8192
ds_read_b64_tr_b16 a[226:227], v9 offset:10240
v_add_f32 v24, v24, v72
v_add_f32 v25, v25, v73
v_cvt_pk_bf16_f32 v36, v72, v73
v_mfma_f32_32x32x16_bf16 v[112:127], a[164:167], a[100:103], v[112:127]
ds_read_b64_tr_b16 a[228:229], v10 offset:8192
ds_read_b64_tr_b16 a[230:231], v10 offset:10240
v_exp_f32 v76, v76
v_exp_f32 v77, v77
v_add_f32 v24, v24, v74
v_mfma_f32_32x32x16_bf16 v[112:127], a[168:171], a[104:107], v[112:127]
ds_read_b64_tr_b16 a[232:233], v11 offset:8192
ds_read_b64_tr_b16 a[234:235], v11 offset:10240
v_add_f32 v25, v25, v75
v_cvt_pk_bf16_f32 v37, v74, v75
v_exp_f32 v78, v78
v_mfma_f32_32x32x16_bf16 v[112:127], a[172:175], a[108:111], v[112:127]
ds_read_b64_tr_b16 a[236:237], v12 offset:8192
ds_read_b64_tr_b16 a[238:239], v12 offset:10240
v_exp_f32 v79, v79
v_add_f32 v24, v24, v76
v_add_f32 v25, v25, v77
v_cvt_pk_bf16_f32 v38, v76, v77
v_mfma_f32_32x32x16_bf16 v[112:127], a[176:179], a[112:115], v[112:127]
ds_read_b64_tr_b16 a[240:241], v9 offset:12288
ds_read_b64_tr_b16 a[242:243], v9 offset:14336
v_exp_f32 v80, v80
v_exp_f32 v81, v81
v_add_f32 v24, v24, v78
v_mfma_f32_32x32x16_bf16 v[112:127], a[180:183], a[116:119], v[112:127]
ds_read_b64_tr_b16 a[244:245], v10 offset:12288
ds_read_b64_tr_b16 a[246:247], v10 offset:14336
v_add_f32 v25, v25, v79
v_cvt_pk_bf16_f32 v39, v78, v79
v_exp_f32 v82, v82
v_mfma_f32_32x32x16_bf16 v[112:127], a[184:187], a[120:123], v[112:127]
ds_read_b64_tr_b16 a[248:249], v11 offset:12288
ds_read_b64_tr_b16 a[250:251], v11 offset:14336
v_exp_f32 v83, v83
v_add_f32 v24, v24, v80
v_add_f32 v25, v25, v81
v_cvt_pk_bf16_f32 v40, v80, v81
v_mfma_f32_32x32x16_bf16 v[112:127], a[188:191], a[124:127], v[112:127]
ds_read_b64_tr_b16 a[252:253], v12 offset:12288
ds_read_b64_tr_b16 a[254:255], v12 offset:14336
s_nop 0
v_add_f32 v24, v24, v82
v_add_f32 v25, v25, v83
v_cvt_pk_bf16_f32 v41, v82, v83
v_mov_b32 v28, 1
s_waitcnt vmcnt(0)
buffer_store_dword v28, v22, s[24:27], s49 offen sc1
s_waitcnt lgkmcnt(0)
s_barrier
v_mfma_f32_32x32x16_bf16 a[0:15], a[192:195], v[32:35], a[0:15]
ds_read_b64_tr_b16 v[208:209], v21 offset:20480
v_exp_f32 v84, v84
v_exp_f32 v85, v85
v_mfma_f32_32x32x16_bf16 a[16:31], a[196:199], v[32:35], a[16:31]
ds_read_b64_tr_b16 v[210:211], v21 offset:21760
ds_read_b64_tr_b16 v[212:213], v21 offset:20544
v_exp_f32 v86, v86
v_exp_f32 v87, v87
v_mfma_f32_32x32x16_bf16 a[32:47], a[200:203], v[32:35], a[32:47]
ds_read_b64_tr_b16 v[214:215], v21 offset:21824
v_add_f32 v24, v24, v84
v_add_f32 v25, v25, v85
v_cvt_pk_bf16_f32 v42, v84, v85
v_mfma_f32_32x32x16_bf16 a[48:63], a[204:207], v[32:35], a[48:63]
ds_read_b64_tr_b16 v[216:217], v21 offset:20608
ds_read_b64_tr_b16 v[218:219], v21 offset:21888
v_exp_f32 v88, v88
v_exp_f32 v89, v89
v_add_f32 v24, v24, v86
v_mfma_f32_32x32x16_bf16 a[0:15], a[208:211], v[36:39], a[0:15]
ds_read_b64_tr_b16 v[220:221], v21 offset:20672
v_add_f32 v25, v25, v87
v_cvt_pk_bf16_f32 v43, v86, v87
v_exp_f32 v90, v90
v_mfma_f32_32x32x16_bf16 a[16:31], a[212:215], v[36:39], a[16:31]
ds_read_b64_tr_b16 v[222:223], v21 offset:21952
ds_read_b64_tr_b16 v[224:225], v21 offset:20736
v_exp_f32 v91, v91
v_add_f32 v24, v24, v88
v_mfma_f32_32x32x16_bf16 a[32:47], a[216:219], v[36:39], a[32:47]
ds_read_b64_tr_b16 v[226:227], v21 offset:22016
v_add_f32 v25, v25, v89
v_cvt_pk_bf16_f32 v44, v88, v89
v_exp_f32 v92, v92
v_mfma_f32_32x32x16_bf16 a[48:63], a[220:223], v[36:39], a[48:63]
ds_read_b64_tr_b16 v[228:229], v21 offset:25600
ds_read_b64_tr_b16 v[230:231], v21 offset:26880
v_exp_f32 v93, v93
v_add_f32 v24, v24, v90
v_add_f32 v25, v25, v91
v_mfma_f32_32x32x16_bf16 a[0:15], a[224:227], v[40:43], a[0:15]
ds_read_b64_tr_b16 v[232:233], v21 offset:25664
v_cvt_pk_bf16_f32 v45, v90, v91
v_exp_f32 v94, v94
v_exp_f32 v95, v95
v_mfma_f32_32x32x16_bf16 a[16:31], a[228:231], v[40:43], a[16:31]
ds_read_b64_tr_b16 v[234:235], v21 offset:26944
ds_read_b64_tr_b16 v[236:237], v21 offset:25728
v_add_f32 v24, v24, v92
v_add_f32 v25, v25, v93
v_cvt_pk_bf16_f32 v46, v92, v93
v_mfma_f32_32x32x16_bf16 a[32:47], a[232:235], v[40:43], a[32:47]
ds_read_b64_tr_b16 v[238:239], v21 offset:27008
s_nop 0
v_add_f32 v24, v24, v94
v_add_f32 v25, v25, v95
v_cvt_pk_bf16_f32 v47, v94, v95
v_max3_f32 v26, v96, v97, v98
v_mfma_f32_32x32x16_bf16 a[48:63], a[236:239], v[40:43], a[48:63]
ds_read_b64_tr_b16 v[240:241], v21 offset:25792
ds_read_b64_tr_b16 v[242:243], v21 offset:27072
v_max3_f32 v26, v26, v99, v100
v_mfma_f32_32x32x16_bf16 a[0:15], a[240:243], v[44:47], a[0:15]
ds_read_b64_tr_b16 v[244:245], v21 offset:25856
v_max3_f32 v26, v26, v101, v102
v_mfma_f32_32x32x16_bf16 a[16:31], a[244:247], v[44:47], a[16:31]
ds_read_b64_tr_b16 v[246:247], v21 offset:27136
ds_read_b128 a[128:131], v1 offset:0
v_max3_f32 v26, v26, v103, v104
v_mfma_f32_32x32x16_bf16 a[32:47], a[248:251], v[44:47], a[32:47]
ds_read_b128 a[132:135], v2 offset:0
v_max3_f32 v26, v26, v105, v106
v_mfma_f32_32x32x16_bf16 a[48:63], a[252:255], v[44:47], a[48:63]
ds_read_b128 a[136:139], v3 offset:0
ds_read_b128 a[140:143], v4 offset:0
v_max3_f32 v26, v26, v107, v108
s_waitcnt lgkmcnt(15)
v_mfma_f32_32x32x16_bf16 v[128:143], v[208:211], a[80:83], v[128:143]
ds_read_b128 a[144:147], v5 offset:0
v_max3_f32 v26, v26, v109, v110
v_mfma_f32_32x32x16_bf16 v[144:159], v[212:215], a[80:83], v[144:159]
ds_read_b128 a[148:151], v6 offset:0
ds_read_b128 a[152:155], v7 offset:0
v_max3_f32 v27, v112, v113, v114
v_mfma_f32_32x32x16_bf16 v[160:175], v[216:219], a[80:83], v[160:175]
ds_read_b128 a[156:159], v8 offset:0
v_max3_f32 v27, v27, v115, v116
v_mfma_f32_32x32x16_bf16 v[176:191], v[220:223], a[80:83], v[176:191]
ds_read_b128 a[160:163], v1 offset:8192
ds_read_b128 a[164:167], v2 offset:8192
v_max3_f32 v27, v27, v117, v118
s_waitcnt lgkmcnt(15)
v_mfma_f32_32x32x16_bf16 v[192:207], v[224:227], a[80:83], v[192:207]
ds_read_b128 a[168:171], v3 offset:8192
v_max3_f32 v27, v27, v119, v120
v_mfma_f32_32x32x16_bf16 v[128:143], v[228:231], a[84:87], v[128:143]
ds_read_b128 a[172:175], v4 offset:8192
ds_read_b128 a[176:179], v5 offset:8192
v_max3_f32 v27, v27, v121, v122
v_mfma_f32_32x32x16_bf16 v[144:159], v[232:235], a[84:87], v[144:159]
ds_read_b128 a[180:183], v6 offset:8192
v_max3_f32 v27, v27, v123, v124
s_waitcnt lgkmcnt(15)
v_mfma_f32_32x32x16_bf16 v[160:175], v[236:239], a[84:87], v[160:175]
ds_read_b128 a[184:187], v7 offset:8192
ds_read_b128 a[188:191], v8 offset:8192
v_max3_f32 v27, v27, v125, v126
v_mfma_f32_32x32x16_bf16 v[176:191], v[240:243], a[84:87], v[176:191]
v_max3_f32 v26, v26, v111, v127
s_waitcnt lgkmcnt(15)
v_mfma_f32_32x32x16_bf16 v[192:207], v[244:247], a[84:87], v[192:207]
v_max_f32 v26, v26, v27
v_cmp_lt_f32 vcc, s51, v26
s_cbranch_vccz L_norare_11
s_call_b64 s[46:47], L_rare1
L_norare_11:
s_waitcnt lgkmcnt(0)
s_barrier
v_mfma_f32_32x32x16_bf16 v[64:79], a[128:131], a[96:99], v[48:63]
ds_read_b64_tr_b16 a[192:193], v9 offset:16384
ds_read_b64_tr_b16 a[194:195], v9 offset:18432
v_exp_f32 v96, v96
v_exp_f32 v97, v97
v_mfma_f32_32x32x16_bf16 v[64:79], a[132:135], a[100:103], v[64:79]
ds_read_b64_tr_b16 a[196:197], v10 offset:16384
ds_read_b64_tr_b16 a[198:199], v10 offset:18432
v_exp_f32 v98, v98
v_exp_f32 v99, v99
v_add_f32 v24, v24, v96
v_mfma_f32_32x32x16_bf16 v[64:79], a[136:139], a[104:107], v[64:79]
ds_read_b64_tr_b16 a[200:201], v11 offset:16384
ds_read_b64_tr_b16 a[202:203], v11 offset:18432
v_add_f32 v25, v25, v97
v_cvt_pk_bf16_f32 v32, v96, v97
v_exp_f32 v100, v100
v_mfma_f32_32x32x16_bf16 v[64:79], a[140:143], a[108:111], v[64:79]
ds_read_b64_tr_b16 a[204:205], v12 offset:16384
ds_read_b64_tr_b16 a[206:207], v12 offset:18432
v_exp_f32 v101, v101
v_add_f32 v24, v24, v98
v_add_f32 v25, v25, v99
v_cvt_pk_bf16_f32 v33, v98, v99
v_mfma_f32_32x32x16_bf16 v[64:79], a[144:147], a[112:115], v[64:79]
ds_read_b64_tr_b16 a[208:209], v9 offset:20480
ds_read_b64_tr_b16 a[210:211], v9 offset:22528
v_exp_f32 v102, v102
v_exp_f32 v103, v103
v_mfma_f32_32x32x16_bf16 v[64:79], a[148:151], a[116:119], v[64:79]
ds_read_b64_tr_b16 a[212:213], v10 offset:20480
ds_read_b64_tr_b16 a[214:215], v10 offset:22528
v_add_f32 v24, v24, v100
v_add_f32 v25, v25, v101
v_cvt_pk_bf16_f32 v34, v100, v101
v_exp_f32 v104, v104
v_mfma_f32_32x32x16_bf16 v[64:79], a[152:155], a[120:123], v[64:79]
ds_read_b64_tr_b16 a[216:217], v11 offset:20480
ds_read_b64_tr_b16 a[218:219], v11 offset:22528
v_exp_f32 v105, v105
v_add_f32 v24, v24, v102
v_add_f32 v25, v25, v103
v_mfma_f32_32x32x16_bf16 v[64:79], a[156:159], a[124:127], v[64:79]
ds_read_b64_tr_b16 a[220:221], v12 offset:20480
ds_read_b64_tr_b16 a[222:223], v12 offset:22528
v_cvt_pk_bf16_f32 v35, v102, v103
v_exp_f32 v106, v106
v_exp_f32 v107, v107
v_mfma_f32_32x32x16_bf16 v[80:95], a[160:163], a[96:99], v[48:63]
ds_read_b64_tr_b16 a[224:225], v9 offset:24576
ds_read_b64_tr_b16 a[226:227], v9 offset:26624
v_add_f32 v24, v24, v104
v_add_f32 v25, v25, v105
v_cvt_pk_bf16_f32 v36, v104, v105
v_mfma_f32_32x32x16_bf16 v[80:95], a[164:167], a[100:103], v[80:95]
ds_read_b64_tr_b16 a[228:229], v10 offset:24576
ds_read_b64_tr_b16 a[230:231], v10 offset:26624
v_exp_f32 v108, v108
v_exp_f32 v109, v109
v_add_f32 v24, v24, v106
v_mfma_f32_32x32x16_bf16 v[80:95], a[168:171], a[104:107], v[80:95]
ds_read_b64_tr_b16 a[232:233], v11 offset:24576
ds_read_b64_tr_b16 a[234:235], v11 offset:26624
v_add_f32 v25, v25, v107
v_cvt_pk_bf16_f32 v37, v106, v107
v_exp_f32 v110, v110
v_mfma_f32_32x32x16_bf16 v[80:95], a[172:175], a[108:111], v[80:95]
ds_read_b64_tr_b16 a[236:237], v12 offset:24576
ds_read_b64_tr_b16 a[238:239], v12 offset:26624
v_exp_f32 v111, v111
v_add_f32 v24, v24, v108
v_add_f32 v25, v25, v109
v_cvt_pk_bf16_f32 v38, v108, v109
v_mfma_f32_32x32x16_bf16 v[80:95], a[176:179], a[112:115], v[80:95]
ds_read_b64_tr_b16 a[240:241], v9 offset:28672
ds_read_b64_tr_b16 a[242:243], v9 offset:30720
v_exp_f32 v112, v112
v_exp_f32 v113, v113
v_add_f32 v24, v24, v110
v_mfma_f32_32x32x16_bf16 v[80:95], a[180:183], a[116:119], v[80:95]
ds_read_b64_tr_b16 a[244:245], v10 offset:28672
ds_read_b64_tr_b16 a[246:247], v10 offset:30720
v_add_f32 v25, v25, v111
v_cvt_pk_bf16_f32 v39, v110, v111
v_exp_f32 v114, v114
v_mfma_f32_32x32x16_bf16 v[80:95], a[184:187], a[120:123], v[80:95]
ds_read_b64_tr_b16 a[248:249], v11 offset:28672
ds_read_b64_tr_b16 a[250:251], v11 offset:30720
v_exp_f32 v115, v115
v_add_f32 v24, v24, v112
v_add_f32 v25, v25, v113
v_cvt_pk_bf16_f32 v40, v112, v113
v_mfma_f32_32x32x16_bf16 v[80:95], a[188:191], a[124:127], v[80:95]
ds_read_b64_tr_b16 a[252:253], v12 offset:28672
ds_read_b64_tr_b16 a[254:255], v12 offset:30720
s_nop 0
v_add_f32 v24, v24, v114
v_add_f32 v25, v25, v115
v_cvt_pk_bf16_f32 v41, v114, v115
s_waitcnt lgkmcnt(0)
s_barrier
v_mfma_f32_32x32x16_bf16 a[0:15], a[192:195], v[32:35], a[0:15]
ds_read_b64_tr_b16 v[208:209], v21 offset:40960
v_exp_f32 v116, v116
v_exp_f32 v117, v117
v_mfma_f32_32x32x16_bf16 a[16:31], a[196:199], v[32:35], a[16:31]
ds_read_b64_tr_b16 v[210:211], v21 offset:42240
ds_read_b64_tr_b16 v[212:213], v21 offset:41024
v_exp_f32 v118, v118
v_exp_f32 v119, v119
v_mfma_f32_32x32x16_bf16 a[32:47], a[200:203], v[32:35], a[32:47]
ds_read_b64_tr_b16 v[214:215], v21 offset:42304
v_add_f32 v24, v24, v116
v_add_f32 v25, v25, v117
v_cvt_pk_bf16_f32 v42, v116, v117
v_mfma_f32_32x32x16_bf16 a[48:63], a[204:207], v[32:35], a[48:63]
ds_read_b64_tr_b16 v[216:217], v21 offset:41088
ds_read_b64_tr_b16 v[218:219], v21 offset:42368
v_exp_f32 v120, v120
v_exp_f32 v121, v121
v_add_f32 v24, v24, v118
v_mfma_f32_32x32x16_bf16 a[0:15], a[208:211], v[36:39], a[0:15]
ds_read_b64_tr_b16 v[220:221], v21 offset:41152
v_add_f32 v25, v25, v119
v_cvt_pk_bf16_f32 v43, v118, v119
v_exp_f32 v122, v122
v_mfma_f32_32x32x16_bf16 a[16:31], a[212:215], v[36:39], a[16:31]
ds_read_b64_tr_b16 v[222:223], v21 offset:42432
ds_read_b64_tr_b16 v[224:225], v21 offset:41216
v_exp_f32 v123, v123
v_add_f32 v24, v24, v120
v_mfma_f32_32x32x16_bf16 a[32:47], a[216:219], v[36:39], a[32:47]
ds_read_b64_tr_b16 v[226:227], v21 offset:42496
v_add_f32 v25, v25, v121
v_cvt_pk_bf16_f32 v44, v120, v121
v_exp_f32 v124, v124
v_mfma_f32_32x32x16_bf16 a[48:63], a[220:223], v[36:39], a[48:63]
ds_read_b64_tr_b16 v[228:229], v21 offset:46080
ds_read_b64_tr_b16 v[230:231], v21 offset:47360
v_exp_f32 v125, v125
v_add_f32 v24, v24, v122
v_add_f32 v25, v25, v123
v_mfma_f32_32x32x16_bf16 a[0:15], a[224:227], v[40:43], a[0:15]
ds_read_b64_tr_b16 v[232:233], v21 offset:46144
v_cvt_pk_bf16_f32 v45, v122, v123
v_exp_f32 v126, v126
v_exp_f32 v127, v127
v_mfma_f32_32x32x16_bf16 a[16:31], a[228:231], v[40:43], a[16:31]
ds_read_b64_tr_b16 v[234:235], v21 offset:47424
ds_read_b64_tr_b16 v[236:237], v21 offset:46208
v_add_f32 v24, v24, v124
v_add_f32 v25, v25, v125
v_cvt_pk_bf16_f32 v46, v124, v125
v_mfma_f32_32x32x16_bf16 a[32:47], a[232:235], v[40:43], a[32:47]
ds_read_b64_tr_b16 v[238:239], v21 offset:47488
s_nop 0
v_add_f32 v24, v24, v126
v_add_f32 v25, v25, v127
v_cvt_pk_bf16_f32 v47, v126, v127
v_max3_f32 v26, v64, v65, v66
v_mfma_f32_32x32x16_bf16 a[48:63], a[236:239], v[40:43], a[48:63]
ds_read_b64_tr_b16 v[240:241], v21 offset:46272
ds_read_b64_tr_b16 v[242:243], v21 offset:47552
v_max3_f32 v26, v26, v67, v68
v_mfma_f32_32x32x16_bf16 a[0:15], a[240:243], v[44:47], a[0:15]
ds_read_b64_tr_b16 v[244:245], v21 offset:46336
v_max3_f32 v26, v26, v69, v70
v_mfma_f32_32x32x16_bf16 a[16:31], a[244:247], v[44:47], a[16:31]
ds_read_b64_tr_b16 v[246:247], v21 offset:47616
ds_read_b128 a[128:131], v1 offset:16384
v_max3_f32 v26, v26, v71, v72
v_mfma_f32_32x32x16_bf16 a[32:47], a[248:251], v[44:47], a[32:47]
ds_read_b128 a[132:135], v2 offset:16384
v_max3_f32 v26, v26, v73, v74
v_mfma_f32_32x32x16_bf16 a[48:63], a[252:255], v[44:47], a[48:63]
ds_read_b128 a[136:139], v3 offset:16384
ds_read_b128 a[140:143], v4 offset:16384
v_max3_f32 v26, v26, v75, v76
s_waitcnt lgkmcnt(15)
v_mfma_f32_32x32x16_bf16 v[128:143], v[208:211], a[88:91], v[128:143]
ds_read_b128 a[144:147], v5 offset:16384
v_max3_f32 v26, v26, v77, v78
v_mfma_f32_32x32x16_bf16 v[144:159], v[212:215], a[88:91], v[144:159]
ds_read_b128 a[148:151], v6 offset:16384
ds_read_b128 a[152:155], v7 offset:16384
v_max3_f32 v27, v80, v81, v82
v_mfma_f32_32x32x16_bf16 v[160:175], v[216:219], a[88:91], v[160:175]
ds_read_b128 a[156:159], v8 offset:16384
v_max3_f32 v27, v27, v83, v84
v_mfma_f32_32x32x16_bf16 v[176:191], v[220:223], a[88:91], v[176:191]
ds_read_b128 a[160:163], v1 offset:24576
ds_read_b128 a[164:167], v2 offset:24576
v_max3_f32 v27, v27, v85, v86
s_waitcnt lgkmcnt(15)
v_mfma_f32_32x32x16_bf16 v[192:207], v[224:227], a[88:91], v[192:207]
ds_read_b128 a[168:171], v3 offset:24576
v_max3_f32 v27, v27, v87, v88
v_mfma_f32_32x32x16_bf16 v[128:143], v[228:231], a[92:95], v[128:143]
ds_read_b128 a[172:175], v4 offset:24576
ds_read_b128 a[176:179], v5 offset:24576
v_max3_f32 v27, v27, v89, v90
v_mfma_f32_32x32x16_bf16 v[144:159], v[232:235], a[92:95], v[144:159]
ds_read_b128 a[180:183], v6 offset:24576
v_max3_f32 v27, v27, v91, v92
s_waitcnt lgkmcnt(15)
v_mfma_f32_32x32x16_bf16 v[160:175], v[236:239], a[92:95], v[160:175]
ds_read_b128 a[184:187], v7 offset:24576
ds_read_b128 a[188:191], v8 offset:24576
v_max3_f32 v27, v27, v93, v94
v_mfma_f32_32x32x16_bf16 v[176:191], v[240:243], a[92:95], v[176:191]
v_max3_f32 v26, v26, v79, v95
s_waitcnt lgkmcnt(15)
v_mfma_f32_32x32x16_bf16 v[192:207], v[244:247], a[92:95], v[192:207]
v_max_f32 v26, v26, v27
v_cmp_lt_f32 vcc, s51, v26
s_cbranch_vccz L_norare_12
s_call_b64 s[46:47], L_rare0
L_norare_12:
s_waitcnt lgkmcnt(0)
s_barrier
v_mfma_f32_32x32x16_bf16 v[96:111], a[128:131], a[96:99], v[48:63]
ds_read_b64_tr_b16 a[192:193], v9 offset:0
ds_read_b64_tr_b16 a[194:195], v9 offset:2048
v_exp_f32 v64, v64
v_exp_f32 v65, v65
v_mfma_f32_32x32x16_bf16 v[96:111], a[132:135], a[100:103], v[96:111]
ds_read_b64_tr_b16 a[196:197], v10 offset:0
ds_read_b64_tr_b16 a[198:199], v10 offset:2048
v_exp_f32 v66, v66
v_exp_f32 v67, v67
v_add_f32 v24, v24, v64
v_mfma_f32_32x32x16_bf16 v[96:111], a[136:139], a[104:107], v[96:111]
ds_read_b64_tr_b16 a[200:201], v11 offset:0
ds_read_b64_tr_b16 a[202:203], v11 offset:2048
v_add_f32 v25, v25, v65
v_cvt_pk_bf16_f32 v32, v64, v65
v_exp_f32 v68, v68
v_mfma_f32_32x32x16_bf16 v[96:111], a[140:143], a[108:111], v[96:111]
ds_read_b64_tr_b16 a[204:205], v12 offset:0
ds_read_b64_tr_b16 a[206:207], v12 offset:2048
v_exp_f32 v69, v69
v_add_f32 v24, v24, v66
v_add_f32 v25, v25, v67
v_cvt_pk_bf16_f32 v33, v66, v67
v_mfma_f32_32x32x16_bf16 v[96:111], a[144:147], a[112:115], v[96:111]
ds_read_b64_tr_b16 a[208:209], v9 offset:4096
ds_read_b64_tr_b16 a[210:211], v9 offset:6144
v_exp_f32 v70, v70
v_exp_f32 v71, v71
v_mfma_f32_32x32x16_bf16 v[96:111], a[148:151], a[116:119], v[96:111]
ds_read_b64_tr_b16 a[212:213], v10 offset:4096
ds_read_b64_tr_b16 a[214:215], v10 offset:6144
v_add_f32 v24, v24, v68
v_add_f32 v25, v25, v69
v_cvt_pk_bf16_f32 v34, v68, v69
v_exp_f32 v72, v72
v_mfma_f32_32x32x16_bf16 v[96:111], a[152:155], a[120:123], v[96:111]
ds_read_b64_tr_b16 a[216:217], v11 offset:4096
ds_read_b64_tr_b16 a[218:219], v11 offset:6144
v_exp_f32 v73, v73
v_add_f32 v24, v24, v70
v_add_f32 v25, v25, v71
v_mfma_f32_32x32x16_bf16 v[96:111], a[156:159], a[124:127], v[96:111]
ds_read_b64_tr_b16 a[220:221], v12 offset:4096
ds_read_b64_tr_b16 a[222:223], v12 offset:6144
v_cvt_pk_bf16_f32 v35, v70, v71
v_exp_f32 v74, v74
v_exp_f32 v75, v75
v_mfma_f32_32x32x16_bf16 v[112:127], a[160:163], a[96:99], v[48:63]
ds_read_b64_tr_b16 a[224:225], v9 offset:8192
ds_read_b64_tr_b16 a[226:227], v9 offset:10240
v_add_f32 v24, v24, v72
v_add_f32 v25, v25, v73
v_cvt_pk_bf16_f32 v36, v72, v73
v_mfma_f32_32x32x16_bf16 v[112:127], a[164:167], a[100:103], v[112:127]
ds_read_b64_tr_b16 a[228:229], v10 offset:8192
ds_read_b64_tr_b16 a[230:231], v10 offset:10240
v_exp_f32 v76, v76
v_exp_f32 v77, v77
v_add_f32 v24, v24, v74
v_mfma_f32_32x32x16_bf16 v[112:127], a[168:171], a[104:107], v[112:127]
ds_read_b64_tr_b16 a[232:233], v11 offset:8192
ds_read_b64_tr_b16 a[234:235], v11 offset:10240
v_add_f32 v25, v25, v75
v_cvt_pk_bf16_f32 v37, v74, v75
v_exp_f32 v78, v78
v_mfma_f32_32x32x16_bf16 v[112:127], a[172:175], a[108:111], v[112:127]
ds_read_b64_tr_b16 a[236:237], v12 offset:8192
ds_read_b64_tr_b16 a[238:239], v12 offset:10240
v_exp_f32 v79, v79
v_add_f32 v24, v24, v76
v_add_f32 v25, v25, v77
v_cvt_pk_bf16_f32 v38, v76, v77
v_mfma_f32_32x32x16_bf16 v[112:127], a[176:179], a[112:115], v[112:127]
ds_read_b64_tr_b16 a[240:241], v9 offset:12288
ds_read_b64_tr_b16 a[242:243], v9 offset:14336
v_exp_f32 v80, v80
v_exp_f32 v81, v81
v_add_f32 v24, v24, v78
v_mfma_f32_32x32x16_bf16 v[112:127], a[180:183], a[116:119], v[112:127]
ds_read_b64_tr_b16 a[244:245], v10 offset:12288
ds_read_b64_tr_b16 a[246:247], v10 offset:14336
v_add_f32 v25, v25, v79
v_cvt_pk_bf16_f32 v39, v78, v79
v_exp_f32 v82, v82
v_mfma_f32_32x32x16_bf16 v[112:127], a[184:187], a[120:123], v[112:127]
ds_read_b64_tr_b16 a[248:249], v11 offset:12288
ds_read_b64_tr_b16 a[250:251], v11 offset:14336
v_exp_f32 v83, v83
v_add_f32 v24, v24, v80
v_add_f32 v25, v25, v81
v_cvt_pk_bf16_f32 v40, v80, v81
v_mfma_f32_32x32x16_bf16 v[112:127], a[188:191], a[124:127], v[112:127]
ds_read_b64_tr_b16 a[252:253], v12 offset:12288
ds_read_b64_tr_b16 a[254:255], v12 offset:14336
s_nop 0
v_add_f32 v24, v24, v82
v_add_f32 v25, v25, v83
v_cvt_pk_bf16_f32 v41, v82, v83
s_waitcnt lgkmcnt(0)
s_barrier
v_mfma_f32_32x32x16_bf16 a[0:15], a[192:195], v[32:35], a[0:15]
ds_read_b128 a[128:131], v1 offset:32768
v_exp_f32 v84, v84
v_exp_f32 v85, v85
v_mfma_f32_32x32x16_bf16 a[16:31], a[196:199], v[32:35], a[16:31]
ds_read_b128 a[132:135], v2 offset:32768
v_exp_f32 v86, v86
v_exp_f32 v87, v87
v_mfma_f32_32x32x16_bf16 a[32:47], a[200:203], v[32:35], a[32:47]
ds_read_b128 a[136:139], v3 offset:32768
v_add_f32 v24, v24, v84
v_add_f32 v25, v25, v85
v_cvt_pk_bf16_f32 v42, v84, v85
v_mfma_f32_32x32x16_bf16 a[48:63], a[204:207], v[32:35], a[48:63]
ds_read_b128 a[140:143], v4 offset:32768
ds_read_b128 a[144:147], v5 offset:32768
v_exp_f32 v88, v88
v_exp_f32 v89, v89
v_add_f32 v24, v24, v86
v_mfma_f32_32x32x16_bf16 a[0:15], a[208:211], v[36:39], a[0:15]
ds_read_b128 a[148:151], v6 offset:32768
v_add_f32 v25, v25, v87
v_cvt_pk_bf16_f32 v43, v86, v87
v_exp_f32 v90, v90
v_mfma_f32_32x32x16_bf16 a[16:31], a[212:215], v[36:39], a[16:31]
ds_read_b128 a[152:155], v7 offset:32768
v_exp_f32 v91, v91
v_add_f32 v24, v24, v88
v_mfma_f32_32x32x16_bf16 a[32:47], a[216:219], v[36:39], a[32:47]
ds_read_b128 a[156:159], v8 offset:32768
v_add_f32 v25, v25, v89
v_cvt_pk_bf16_f32 v44, v88, v89
v_exp_f32 v92, v92
v_mfma_f32_32x32x16_bf16 a[48:63], a[220:223], v[36:39], a[48:63]
ds_read_b128 a[160:163], v1 offset:40960
v_exp_f32 v93, v93
v_add_f32 v24, v24, v90
v_add_f32 v25, v25, v91
v_mfma_f32_32x32x16_bf16 a[0:15], a[224:227], v[40:43], a[0:15]
ds_read_b128 a[164:167], v2 offset:40960
v_cvt_pk_bf16_f32 v45, v90, v91
v_exp_f32 v94, v94
v_exp_f32 v95, v95
v_mfma_f32_32x32x16_bf16 a[16:31], a[228:231], v[40:43], a[16:31]
ds_read_b128 a[168:171], v3 offset:40960
v_add_f32 v24, v24, v92
v_add_f32 v25, v25, v93
v_cvt_pk_bf16_f32 v46, v92, v93
v_mfma_f32_32x32x16_bf16 a[32:47], a[232:235], v[40:43], a[32:47]
ds_read_b128 a[172:175], v4 offset:40960
ds_read_b128 a[176:179], v5 offset:40960
s_nop 0
v_add_f32 v24, v24, v94
v_add_f32 v25, v25, v95
v_cvt_pk_bf16_f32 v47, v94, v95
v_max3_f32 v26, v96, v97, v98
v_max3_f32 v26, v26, v99, v100
v_max3_f32 v26, v26, v101, v102
v_mfma_f32_32x32x16_bf16 a[48:63], a[236:239], v[40:43], a[48:63]
ds_read_b128 a[180:183], v6 offset:40960
v_max3_f32 v26, v26, v103, v104
v_max3_f32 v26, v26, v105, v106
v_mfma_f32_32x32x16_bf16 a[0:15], a[240:243], v[44:47], a[0:15]
ds_read_b128 a[184:187], v7 offset:40960
v_max3_f32 v26, v26, v107, v108
v_max3_f32 v26, v26, v109, v110
v_max3_f32 v27, v112, v113, v114
v_mfma_f32_32x32x16_bf16 a[16:31], a[244:247], v[44:47], a[16:31]
ds_read_b128 a[188:191], v8 offset:40960
v_max3_f32 v27, v27, v115, v116
v_max3_f32 v27, v27, v117, v118
v_max3_f32 v27, v27, v119, v120
v_mfma_f32_32x32x16_bf16 a[32:47], a[248:251], v[44:47], a[32:47]
v_max3_f32 v27, v27, v121, v122
v_max3_f32 v27, v27, v123, v124
v_mfma_f32_32x32x16_bf16 a[48:63], a[252:255], v[44:47], a[48:63]
v_max3_f32 v27, v27, v125, v126
v_max3_f32 v26, v26, v111, v127
v_max_f32 v26, v26, v27
v_cmp_lt_f32 vcc, s51, v26
s_cbranch_vccz L_norare_13
s_call_b64 s[46:47], L_rare1
L_norare_13:
s_waitcnt lgkmcnt(0)
s_barrier
v_mfma_f32_32x32x16_bf16 v[64:79], a[128:131], a[96:99], v[48:63]
ds_read_b64_tr_b16 a[192:193], v9 offset:16384
ds_read_b64_tr_b16 a[194:195], v9 offset:18432
v_exp_f32 v96, v96
v_exp_f32 v97, v97
v_mfma_f32_32x32x16_bf16 v[64:79], a[132:135], a[100:103], v[64:79]
ds_read_b64_tr_b16 a[196:197], v10 offset:16384
ds_read_b64_tr_b16 a[198:199], v10 offset:18432
v_exp_f32 v98, v98
v_exp_f32 v99, v99
v_add_f32 v24, v24, v96
v_mfma_f32_32x32x16_bf16 v[64:79], a[136:139], a[104:107], v[64:79]
ds_read_b64_tr_b16 a[200:201], v11 offset:16384
ds_read_b64_tr_b16 a[202:203], v11 offset:18432
v_add_f32 v25, v25, v97
v_cvt_pk_bf16_f32 v32, v96, v97
v_exp_f32 v100, v100
v_mfma_f32_32x32x16_bf16 v[64:79], a[140:143], a[108:111], v[64:79]
ds_read_b64_tr_b16 a[204:205], v12 offset:16384
ds_read_b64_tr_b16 a[206:207], v12 offset:18432
v_exp_f32 v101, v101
v_add_f32 v24, v24, v98
v_add_f32 v25, v25, v99
v_cvt_pk_bf16_f32 v33, v98, v99
v_mfma_f32_32x32x16_bf16 v[64:79], a[144:147], a[112:115], v[64:79]
ds_read_b64_tr_b16 a[208:209], v9 offset:20480
ds_read_b64_tr_b16 a[210:211], v9 offset:22528
v_exp_f32 v102, v102
v_exp_f32 v103, v103
v_mfma_f32_32x32x16_bf16 v[64:79], a[148:151], a[116:119], v[64:79]
ds_read_b64_tr_b16 a[212:213], v10 offset:20480
ds_read_b64_tr_b16 a[214:215], v10 offset:22528
v_add_f32 v24, v24, v100
v_add_f32 v25, v25, v101
v_cvt_pk_bf16_f32 v34, v100, v101
v_exp_f32 v104, v104
v_mfma_f32_32x32x16_bf16 v[64:79], a[152:155], a[120:123], v[64:79]
ds_read_b64_tr_b16 a[216:217], v11 offset:20480
ds_read_b64_tr_b16 a[218:219], v11 offset:22528
v_exp_f32 v105, v105
v_add_f32 v24, v24, v102
v_add_f32 v25, v25, v103
v_mfma_f32_32x32x16_bf16 v[64:79], a[156:159], a[124:127], v[64:79]
ds_read_b64_tr_b16 a[220:221], v12 offset:20480
ds_read_b64_tr_b16 a[222:223], v12 offset:22528
v_cvt_pk_bf16_f32 v35, v102, v103
v_exp_f32 v106, v106
v_exp_f32 v107, v107
v_mfma_f32_32x32x16_bf16 v[80:95], a[160:163], a[96:99], v[48:63]
ds_read_b64_tr_b16 a[224:225], v9 offset:24576
ds_read_b64_tr_b16 a[226:227], v9 offset:26624
v_add_f32 v24, v24, v104
v_add_f32 v25, v25, v105
v_cvt_pk_bf16_f32 v36, v104, v105
v_mfma_f32_32x32x16_bf16 v[80:95], a[164:167], a[100:103], v[80:95]
ds_read_b64_tr_b16 a[228:229], v10 offset:24576
ds_read_b64_tr_b16 a[230:231], v10 offset:26624
v_exp_f32 v108, v108
v_exp_f32 v109, v109
v_add_f32 v24, v24, v106
v_mfma_f32_32x32x16_bf16 v[80:95], a[168:171], a[104:107], v[80:95]
ds_read_b64_tr_b16 a[232:233], v11 offset:24576
ds_read_b64_tr_b16 a[234:235], v11 offset:26624
v_add_f32 v25, v25, v107
v_cvt_pk_bf16_f32 v37, v106, v107
v_exp_f32 v110, v110
v_mfma_f32_32x32x16_bf16 v[80:95], a[172:175], a[108:111], v[80:95]
ds_read_b64_tr_b16 a[236:237], v12 offset:24576
ds_read_b64_tr_b16 a[238:239], v12 offset:26624
v_exp_f32 v111, v111
v_add_f32 v24, v24, v108
v_add_f32 v25, v25, v109
v_cvt_pk_bf16_f32 v38, v108, v109
v_mfma_f32_32x32x16_bf16 v[80:95], a[176:179], a[112:115], v[80:95]
ds_read_b64_tr_b16 a[240:241], v9 offset:28672
ds_read_b64_tr_b16 a[242:243], v9 offset:30720
v_exp_f32 v112, v112
v_exp_f32 v113, v113
v_add_f32 v24, v24, v110
v_mfma_f32_32x32x16_bf16 v[80:95], a[180:183], a[116:119], v[80:95]
ds_read_b64_tr_b16 a[244:245], v10 offset:28672
ds_read_b64_tr_b16 a[246:247], v10 offset:30720
v_add_f32 v25, v25, v111
v_cvt_pk_bf16_f32 v39, v110, v111
v_exp_f32 v114, v114
v_mfma_f32_32x32x16_bf16 v[80:95], a[184:187], a[120:123], v[80:95]
ds_read_b64_tr_b16 a[248:249], v11 offset:28672
ds_read_b64_tr_b16 a[250:251], v11 offset:30720
v_exp_f32 v115, v115
v_add_f32 v24, v24, v112
v_add_f32 v25, v25, v113
v_cvt_pk_bf16_f32 v40, v112, v113
v_mfma_f32_32x32x16_bf16 v[80:95], a[188:191], a[124:127], v[80:95]
ds_read_b64_tr_b16 a[252:253], v12 offset:28672
ds_read_b64_tr_b16 a[254:255], v12 offset:30720
s_nop 0
v_add_f32 v24, v24, v114
v_add_f32 v25, v25, v115
v_cvt_pk_bf16_f32 v41, v114, v115
s_waitcnt lgkmcnt(0)
s_barrier
v_mfma_f32_32x32x16_bf16 a[0:15], a[192:195], v[32:35], a[0:15]
ds_read_b128 a[128:131], v1 offset:0
v_exp_f32 v116, v116
v_exp_f32 v117, v117
v_mfma_f32_32x32x16_bf16 a[16:31], a[196:199], v[32:35], a[16:31]
ds_read_b128 a[132:135], v2 offset:0
v_exp_f32 v118, v118
v_exp_f32 v119, v119
v_mfma_f32_32x32x16_bf16 a[32:47], a[200:203], v[32:35], a[32:47]
ds_read_b128 a[136:139], v3 offset:0
v_add_f32 v24, v24, v116
v_add_f32 v25, v25, v117
v_cvt_pk_bf16_f32 v42, v116, v117
v_mfma_f32_32x32x16_bf16 a[48:63], a[204:207], v[32:35], a[48:63]
ds_read_b128 a[140:143], v4 offset:0
ds_read_b128 a[144:147], v5 offset:0
v_exp_f32 v120, v120
v_exp_f32 v121, v121
v_add_f32 v24, v24, v118
v_mfma_f32_32x32x16_bf16 a[0:15], a[208:211], v[36:39], a[0:15]
ds_read_b128 a[148:151], v6 offset:0
v_add_f32 v25, v25, v119
v_cvt_pk_bf16_f32 v43, v118, v119
v_exp_f32 v122, v122
v_mfma_f32_32x32x16_bf16 a[16:31], a[212:215], v[36:39], a[16:31]
ds_read_b128 a[152:155], v7 offset:0
v_exp_f32 v123, v123
v_add_f32 v24, v24, v120
v_mfma_f32_32x32x16_bf16 a[32:47], a[216:219], v[36:39], a[32:47]
ds_read_b128 a[156:159], v8 offset:0
v_add_f32 v25, v25, v121
v_cvt_pk_bf16_f32 v44, v120, v121
v_exp_f32 v124, v124
v_mfma_f32_32x32x16_bf16 a[48:63], a[220:223], v[36:39], a[48:63]
ds_read_b128 a[160:163], v1 offset:8192
v_exp_f32 v125, v125
v_add_f32 v24, v24, v122
v_add_f32 v25, v25, v123
v_mfma_f32_32x32x16_bf16 a[0:15], a[224:227], v[40:43], a[0:15]
ds_read_b128 a[164:167], v2 offset:8192
v_cvt_pk_bf16_f32 v45, v122, v123
v_exp_f32 v126, v126
v_exp_f32 v127, v127
v_mfma_f32_32x32x16_bf16 a[16:31], a[228:231], v[40:43], a[16:31]
ds_read_b128 a[168:171], v3 offset:8192
v_add_f32 v24, v24, v124
v_add_f32 v25, v25, v125
v_cvt_pk_bf16_f32 v46, v124, v125
v_mfma_f32_32x32x16_bf16 a[32:47], a[232:235], v[40:43], a[32:47]
ds_read_b128 a[172:175], v4 offset:8192
ds_read_b128 a[176:179], v5 offset:8192
s_nop 0
v_add_f32 v24, v24, v126
v_add_f32 v25, v25, v127
v_cvt_pk_bf16_f32 v47, v126, v127
v_max3_f32 v26, v64, v65, v66
v_max3_f32 v26, v26, v67, v68
v_max3_f32 v26, v26, v69, v70
v_mfma_f32_32x32x16_bf16 a[48:63], a[236:239], v[40:43], a[48:63]
ds_read_b128 a[180:183], v6 offset:8192
v_max3_f32 v26, v26, v71, v72
v_max3_f32 v26, v26, v73, v74
v_mfma_f32_32x32x16_bf16 a[0:15], a[240:243], v[44:47], a[0:15]
ds_read_b128 a[184:187], v7 offset:8192
v_max3_f32 v26, v26, v75, v76
v_max3_f32 v26, v26, v77, v78
v_max3_f32 v27, v80, v81, v82
v_mfma_f32_32x32x16_bf16 a[16:31], a[244:247], v[44:47], a[16:31]
ds_read_b128 a[188:191], v8 offset:8192
v_max3_f32 v27, v27, v83, v84
v_max3_f32 v27, v27, v85, v86
v_max3_f32 v27, v27, v87, v88
v_mfma_f32_32x32x16_bf16 a[32:47], a[248:251], v[44:47], a[32:47]
v_max3_f32 v27, v27, v89, v90
v_max3_f32 v27, v27, v91, v92
v_mfma_f32_32x32x16_bf16 a[48:63], a[252:255], v[44:47], a[48:63]
v_max3_f32 v27, v27, v93, v94
v_max3_f32 v26, v26, v79, v95
v_max_f32 v26, v26, v27
v_cmp_lt_f32 vcc, s51, v26
s_cbranch_vccz L_norare_14
s_call_b64 s[46:47], L_rare0
L_norare_14:
s_waitcnt lgkmcnt(0)
s_barrier
v_mfma_f32_32x32x16_bf16 v[96:111], a[128:131], a[96:99], v[48:63]
ds_read_b64_tr_b16 a[192:193], v9 offset:0
ds_read_b64_tr_b16 a[194:195], v9 offset:2048
v_exp_f32 v64, v64
v_exp_f32 v65, v65
v_mfma_f32_32x32x16_bf16 v[96:111], a[132:135], a[100:103], v[96:111]
ds_read_b64_tr_b16 a[196:197], v10 offset:0
ds_read_b64_tr_b16 a[198:199], v10 offset:2048
v_exp_f32 v66, v66
v_exp_f32 v67, v67
v_add_f32 v24, v24, v64
v_mfma_f32_32x32x16_bf16 v[96:111], a[136:139], a[104:107], v[96:111]
ds_read_b64_tr_b16 a[200:201], v11 offset:0
ds_read_b64_tr_b16 a[202:203], v11 offset:2048
v_add_f32 v25, v25, v65
v_cvt_pk_bf16_f32 v32, v64, v65
v_exp_f32 v68, v68
v_mfma_f32_32x32x16_bf16 v[96:111], a[140:143], a[108:111], v[96:111]
ds_read_b64_tr_b16 a[204:205], v12 offset:0
ds_read_b64_tr_b16 a[206:207], v12 offset:2048
v_exp_f32 v69, v69
v_add_f32 v24, v24, v66
v_add_f32 v25, v25, v67
v_cvt_pk_bf16_f32 v33, v66, v67
v_mfma_f32_32x32x16_bf16 v[96:111], a[144:147], a[112:115], v[96:111]
ds_read_b64_tr_b16 a[208:209], v9 offset:4096
ds_read_b64_tr_b16 a[210:211], v9 offset:6144
v_exp_f32 v70, v70
v_exp_f32 v71, v71
v_mfma_f32_32x32x16_bf16 v[96:111], a[148:151], a[116:119], v[96:111]
ds_read_b64_tr_b16 a[212:213], v10 offset:4096
ds_read_b64_tr_b16 a[214:215], v10 offset:6144
v_add_f32 v24, v24, v68
v_add_f32 v25, v25, v69
v_cvt_pk_bf16_f32 v34, v68, v69
v_exp_f32 v72, v72
v_mfma_f32_32x32x16_bf16 v[96:111], a[152:155], a[120:123], v[96:111]
ds_read_b64_tr_b16 a[216:217], v11 offset:4096
ds_read_b64_tr_b16 a[218:219], v11 offset:6144
v_exp_f32 v73, v73
v_add_f32 v24, v24, v70
v_add_f32 v25, v25, v71
v_mfma_f32_32x32x16_bf16 v[96:111], a[156:159], a[124:127], v[96:111]
ds_read_b64_tr_b16 a[220:221], v12 offset:4096
ds_read_b64_tr_b16 a[222:223], v12 offset:6144
v_cvt_pk_bf16_f32 v35, v70, v71
v_exp_f32 v74, v74
v_exp_f32 v75, v75
v_mfma_f32_32x32x16_bf16 v[112:127], a[160:163], a[96:99], v[48:63]
ds_read_b64_tr_b16 a[224:225], v9 offset:8192
ds_read_b64_tr_b16 a[226:227], v9 offset:10240
v_add_f32 v24, v24, v72
v_add_f32 v25, v25, v73
v_cvt_pk_bf16_f32 v36, v72, v73
v_mfma_f32_32x32x16_bf16 v[112:127], a[164:167], a[100:103], v[112:127]
ds_read_b64_tr_b16 a[228:229], v10 offset:8192
ds_read_b64_tr_b16 a[230:231], v10 offset:10240
v_exp_f32 v76, v76
v_exp_f32 v77, v77
v_add_f32 v24, v24, v74
v_mfma_f32_32x32x16_bf16 v[112:127], a[168:171], a[104:107], v[112:127]
ds_read_b64_tr_b16 a[232:233], v11 offset:8192
ds_read_b64_tr_b16 a[234:235], v11 offset:10240
v_add_f32 v25, v25, v75
v_cvt_pk_bf16_f32 v37, v74, v75
v_exp_f32 v78, v78
v_mfma_f32_32x32x16_bf16 v[112:127], a[172:175], a[108:111], v[112:127]
ds_read_b64_tr_b16 a[236:237], v12 offset:8192
ds_read_b64_tr_b16 a[238:239], v12 offset:10240
v_exp_f32 v79, v79
v_add_f32 v24, v24, v76
v_add_f32 v25, v25, v77
v_cvt_pk_bf16_f32 v38, v76, v77
v_mfma_f32_32x32x16_bf16 v[112:127], a[176:179], a[112:115], v[112:127]
ds_read_b64_tr_b16 a[240:241], v9 offset:12288
ds_read_b64_tr_b16 a[242:243], v9 offset:14336
v_exp_f32 v80, v80
v_exp_f32 v81, v81
v_add_f32 v24, v24, v78
v_mfma_f32_32x32x16_bf16 v[112:127], a[180:183], a[116:119], v[112:127]
ds_read_b64_tr_b16 a[244:245], v10 offset:12288
ds_read_b64_tr_b16 a[246:247], v10 offset:14336
v_add_f32 v25, v25, v79
v_cvt_pk_bf16_f32 v39, v78, v79
v_exp_f32 v82, v82
v_mfma_f32_32x32x16_bf16 v[112:127], a[184:187], a[120:123], v[112:127]
ds_read_b64_tr_b16 a[248:249], v11 offset:12288
ds_read_b64_tr_b16 a[250:251], v11 offset:14336
v_exp_f32 v83, v83
v_add_f32 v24, v24, v80
v_add_f32 v25, v25, v81
v_cvt_pk_bf16_f32 v40, v80, v81
v_mfma_f32_32x32x16_bf16 v[112:127], a[188:191], a[124:127], v[112:127]
ds_read_b64_tr_b16 a[252:253], v12 offset:12288
ds_read_b64_tr_b16 a[254:255], v12 offset:14336
s_nop 0
v_add_f32 v24, v24, v82
v_add_f32 v25, v25, v83
v_cvt_pk_bf16_f32 v41, v82, v83
s_waitcnt lgkmcnt(0)
s_barrier
v_mfma_f32_32x32x16_bf16 a[0:15], a[192:195], v[32:35], a[0:15]
v_exp_f32 v84, v84
v_exp_f32 v85, v85
v_mfma_f32_32x32x16_bf16 a[16:31], a[196:199], v[32:35], a[16:31]
v_exp_f32 v86, v86
v_exp_f32 v87, v87
v_mfma_f32_32x32x16_bf16 a[32:47], a[200:203], v[32:35], a[32:47]
v_add_f32 v24, v24, v84
v_add_f32 v25, v25, v85
v_cvt_pk_bf16_f32 v42, v84, v85
v_mfma_f32_32x32x16_bf16 a[48:63], a[204:207], v[32:35], a[48:63]
v_exp_f32 v88, v88
v_exp_f32 v89, v89
v_add_f32 v24, v24, v86
v_mfma_f32_32x32x16_bf16 a[0:15], a[208:211], v[36:39], a[0:15]
v_add_f32 v25, v25, v87
v_cvt_pk_bf16_f32 v43, v86, v87
v_exp_f32 v90, v90
v_mfma_f32_32x32x16_bf16 a[16:31], a[212:215], v[36:39], a[16:31]
v_exp_f32 v91, v91
v_add_f32 v24, v24, v88
v_mfma_f32_32x32x16_bf16 a[32:47], a[216:219], v[36:39], a[32:47]
v_add_f32 v25, v25, v89
v_cvt_pk_bf16_f32 v44, v88, v89
v_exp_f32 v92, v92
v_mfma_f32_32x32x16_bf16 a[48:63], a[220:223], v[36:39], a[48:63]
v_exp_f32 v93, v93
v_add_f32 v24, v24, v90
v_add_f32 v25, v25, v91
v_mfma_f32_32x32x16_bf16 a[0:15], a[224:227], v[40:43], a[0:15]
v_cvt_pk_bf16_f32 v45, v90, v91
v_exp_f32 v94, v94
v_exp_f32 v95, v95
v_mfma_f32_32x32x16_bf16 a[16:31], a[228:231], v[40:43], a[16:31]
v_add_f32 v24, v24, v92
v_add_f32 v25, v25, v93
v_cvt_pk_bf16_f32 v46, v92, v93
v_mfma_f32_32x32x16_bf16 a[32:47], a[232:235], v[40:43], a[32:47]
s_nop 0
v_add_f32 v24, v24, v94
v_add_f32 v25, v25, v95
v_cvt_pk_bf16_f32 v47, v94, v95
v_max3_f32 v26, v96, v97, v98
v_max3_f32 v26, v26, v99, v100
v_max3_f32 v26, v26, v101, v102
v_mfma_f32_32x32x16_bf16 a[48:63], a[236:239], v[40:43], a[48:63]
v_max3_f32 v26, v26, v103, v104
v_max3_f32 v26, v26, v105, v106
v_mfma_f32_32x32x16_bf16 a[0:15], a[240:243], v[44:47], a[0:15]
v_max3_f32 v26, v26, v107, v108
v_max3_f32 v26, v26, v109, v110
v_max3_f32 v27, v112, v113, v114
v_mfma_f32_32x32x16_bf16 a[16:31], a[244:247], v[44:47], a[16:31]
v_max3_f32 v27, v27, v115, v116
v_max3_f32 v27, v27, v117, v118
v_max3_f32 v27, v27, v119, v120
v_mfma_f32_32x32x16_bf16 a[32:47], a[248:251], v[44:47], a[32:47]
v_max3_f32 v27, v27, v121, v122
v_max3_f32 v27, v27, v123, v124
v_mfma_f32_32x32x16_bf16 a[48:63], a[252:255], v[44:47], a[48:63]
v_max3_f32 v27, v27, v125, v126
v_max3_f32 v26, v26, v111, v127
v_max_f32 v26, v26, v27
v_cmp_lt_f32 vcc, s51, v26
s_cbranch_vccz L_norare_15
s_call_b64 s[46:47], L_rare1
L_norare_15:
v_exp_f32 v96, v96
v_exp_f32 v97, v97
v_exp_f32 v98, v98
v_exp_f32 v99, v99
v_add_f32 v24, v24, v96
v_add_f32 v25, v25, v97
v_cvt_pk_bf16_f32 v32, v96, v97
v_exp_f32 v100, v100
v_exp_f32 v101, v101
v_add_f32 v24, v24, v98
v_add_f32 v25, v25, v99
v_cvt_pk_bf16_f32 v33, v98, v99
v_exp_f32 v102, v102
v_exp_f32 v103, v103
v_add_f32 v24, v24, v100
v_add_f32 v25, v25, v101
v_cvt_pk_bf16_f32 v34, v100, v101
v_exp_f32 v104, v104
v_exp_f32 v105, v105
v_add_f32 v24, v24, v102
v_add_f32 v25, v25, v103
v_cvt_pk_bf16_f32 v35, v102, v103
v_exp_f32 v106, v106
v_exp_f32 v107, v107
v_add_f32 v24, v24, v104
v_add_f32 v25, v25, v105
v_cvt_pk_bf16_f32 v36, v104, v105
v_exp_f32 v108, v108
v_exp_f32 v109, v109
v_add_f32 v24, v24, v106
v_add_f32 v25, v25, v107
v_cvt_pk_bf16_f32 v37, v106, v107
v_exp_f32 v110, v110
v_exp_f32 v111, v111
v_add_f32 v24, v24, v108
v_add_f32 v25, v25, v109
v_cvt_pk_bf16_f32 v38, v108, v109
v_exp_f32 v112, v112
v_exp_f32 v113, v113
v_add_f32 v24, v24, v110
v_add_f32 v25, v25, v111
v_cvt_pk_bf16_f32 v39, v110, v111
v_exp_f32 v114, v114
v_exp_f32 v115, v115
v_add_f32 v24, v24, v112
v_add_f32 v25, v25, v113
v_cvt_pk_bf16_f32 v40, v112, v113
v_exp_f32 v116, v116
v_exp_f32 v117, v117
v_add_f32 v24, v24, v114
v_add_f32 v25, v25, v115
v_cvt_pk_bf16_f32 v41, v114, v115
v_exp_f32 v118, v118
v_exp_f32 v119, v119
v_add_f32 v24, v24, v116
v_add_f32 v25, v25, v117
v_cvt_pk_bf16_f32 v42, v116, v117
v_exp_f32 v120, v120
v_exp_f32 v121, v121
v_add_f32 v24, v24, v118
v_add_f32 v25, v25, v119
v_cvt_pk_bf16_f32 v43, v118, v119
v_exp_f32 v122, v122
v_exp_f32 v123, v123
v_add_f32 v24, v24, v120
v_add_f32 v25, v25, v121
v_cvt_pk_bf16_f32 v44, v120, v121
v_exp_f32 v124, v124
v_exp_f32 v125, v125
v_add_f32 v24, v24, v122
v_add_f32 v25, v25, v123
v_cvt_pk_bf16_f32 v45, v122, v123
v_exp_f32 v126, v126
v_exp_f32 v127, v127
v_add_f32 v24, v24, v124
v_add_f32 v25, v25, v125
v_cvt_pk_bf16_f32 v46, v124, v125
s_nop 0
v_add_f32 v24, v24, v126
v_add_f32 v25, v25, v127
v_cvt_pk_bf16_f32 v47, v126, v127
v_add_f32 v24, v24, v25
v_mov_b32 v28, v24
s_nop 1
v_permlane32_swap_b32 v24, v28
s_nop 0
v_add_f32 v24, v24, v28
v_rcp_f32 v30, v24
s_waitcnt lgkmcnt(0)
s_add_u32 s44, s38, 1
s_and_b32 s44, s44, 3
s_mul_i32 s44, s44, 49152
s_add_u32 s44, s44, s55
buffer_load_dwordx4 a[128:131], v23, s[24:27], s44 offen offset:0 sc1
buffer_load_dwordx4 a[132:135], v23, s[24:27], s44 offen offset:1024 sc1
s_add_u32 s44, s44, 6144
buffer_load_dwordx4 a[136:139], v23, s[24:27], s44 offen offset:0 sc1
buffer_load_dwordx4 a[140:143], v23, s[24:27], s44 offen offset:1024 sc1
s_add_u32 s44, s44, 6144
buffer_load_dwordx4 a[144:147], v23, s[24:27], s44 offen offset:0 sc1
buffer_load_dwordx4 a[148:151], v23, s[24:27], s44 offen offset:1024 sc1
s_add_u32 s44, s44, 6144
buffer_load_dwordx4 a[152:155], v23, s[24:27], s44 offen offset:0 sc1
buffer_load_dwordx4 a[156:159], v23, s[24:27], s44 offen offset:1024 sc1
s_barrier
ds_read_b64_tr_b16 a[192:193], v9 offset:49152
ds_read_b64_tr_b16 a[194:195], v9 offset:51200
ds_read_b64_tr_b16 a[208:209], v9 offset:53248
ds_read_b64_tr_b16 a[210:211], v9 offset:55296
ds_read_b64_tr_b16 a[224:225], v9 offset:57344
ds_read_b64_tr_b16 a[226:227], v9 offset:59392
ds_read_b64_tr_b16 a[240:241], v9 offset:61440
ds_read_b64_tr_b16 a[242:243], v9 offset:63488
ds_read_b64_tr_b16 a[196:197], v10 offset:49152
ds_read_b64_tr_b16 a[198:199], v10 offset:51200
s_waitcnt lgkmcnt(8)
v_mfma_f32_32x32x16_bf16 a[0:15], a[192:195], v[32:35], a[0:15]
ds_read_b64_tr_b16 a[212:213], v10 offset:53248
ds_read_b64_tr_b16 a[214:215], v10 offset:55296
ds_read_b64_tr_b16 a[228:229], v10 offset:57344
s_waitcnt lgkmcnt(9)
v_mfma_f32_32x32x16_bf16 a[0:15], a[208:211], v[36:39], a[0:15]
ds_read_b64_tr_b16 a[230:231], v10 offset:59392
ds_read_b64_tr_b16 a[244:245], v10 offset:61440
ds_read_b64_tr_b16 a[246:247], v10 offset:63488
ds_read_b64_tr_b16 a[200:201], v11 offset:49152
s_waitcnt lgkmcnt(11)
v_mfma_f32_32x32x16_bf16 a[0:15], a[224:227], v[40:43], a[0:15]
ds_read_b64_tr_b16 a[202:203], v11 offset:51200
ds_read_b64_tr_b16 a[216:217], v11 offset:53248
ds_read_b64_tr_b16 a[218:219], v11 offset:55296
s_waitcnt lgkmcnt(12)
v_mfma_f32_32x32x16_bf16 a[0:15], a[240:243], v[44:47], a[0:15]
ds_read_b64_tr_b16 a[232:233], v11 offset:57344
ds_read_b64_tr_b16 a[234:235], v11 offset:59392
ds_read_b64_tr_b16 a[248:249], v11 offset:61440
ds_read_b64_tr_b16 a[250:251], v11 offset:63488
s_waitcnt lgkmcnt(14)
v_mfma_f32_32x32x16_bf16 a[16:31], a[196:199], v[32:35], a[16:31]
ds_read_b64_tr_b16 a[204:205], v12 offset:49152
ds_read_b64_tr_b16 a[206:207], v12 offset:51200
ds_read_b64_tr_b16 a[220:221], v12 offset:53248
s_waitcnt lgkmcnt(15)
v_mfma_f32_32x32x16_bf16 a[16:31], a[212:215], v[36:39], a[16:31]
ds_read_b64_tr_b16 a[222:223], v12 offset:55296
ds_read_b64_tr_b16 a[236:237], v12 offset:57344
ds_read_b64_tr_b16 a[238:239], v12 offset:59392
ds_read_b64_tr_b16 a[252:253], v12 offset:61440
s_waitcnt lgkmcnt(15)
v_mfma_f32_32x32x16_bf16 a[16:31], a[228:231], v[40:43], a[16:31]
ds_read_b64_tr_b16 a[254:255], v12 offset:63488
ds_read_b64_tr_b16 v[208:209], v21 offset:30720
ds_read_b64_tr_b16 v[210:211], v21 offset:32000
v_mfma_f32_32x32x16_bf16 a[16:31], a[244:247], v[44:47], a[16:31]
ds_read_b64_tr_b16 v[212:213], v21 offset:30784
ds_read_b64_tr_b16 v[214:215], v21 offset:32064
ds_read_b64_tr_b16 v[216:217], v21 offset:30848
ds_read_b64_tr_b16 v[218:219], v21 offset:32128
s_waitcnt lgkmcnt(15)
v_mfma_f32_32x32x16_bf16 a[32:47], a[200:203], v[32:35], a[32:47]
ds_read_b64_tr_b16 v[220:221], v21 offset:30912
ds_read_b64_tr_b16 v[222:223], v21 offset:32192
ds_read_b64_tr_b16 v[224:225], v21 offset:30976
v_accvgpr_read_b32 v64, a0
v_accvgpr_read_b32 v65, a1
v_accvgpr_read_b32 v66, a2
v_accvgpr_read_b32 v67, a3
v_accvgpr_read_b32 v68, a4
v_accvgpr_read_b32 v69, a5
v_accvgpr_read_b32 v70, a6
v_accvgpr_read_b32 v71, a7
v_accvgpr_read_b32 v72, a8
v_mfma_f32_32x32x16_bf16 a[32:47], a[216:219], v[36:39], a[32:47]
ds_read_b64_tr_b16 v[226:227], v21 offset:32256
ds_read_b64_tr_b16 v[228:229], v21 offset:35840
ds_read_b64_tr_b16 v[230:231], v21 offset:37120
ds_read_b64_tr_b16 v[232:233], v21 offset:35904
v_accvgpr_read_b32 v73, a9
v_accvgpr_read_b32 v74, a10
v_accvgpr_read_b32 v75, a11
v_accvgpr_read_b32 v76, a12
v_accvgpr_read_b32 v77, a13
v_accvgpr_read_b32 v78, a14
v_accvgpr_read_b32 v79, a15
v_pk_mul_f32 v[64:65], v[64:65], v[30:31] op_sel_hi:[1,0]
v_mfma_f32_32x32x16_bf16 a[32:47], a[232:235], v[40:43], a[32:47]
ds_read_b64_tr_b16 v[234:235], v21 offset:37184
ds_read_b64_tr_b16 v[236:237], v21 offset:35968
ds_read_b64_tr_b16 v[238:239], v21 offset:37248
v_pk_mul_f32 v[66:67], v[66:67], v[30:31] op_sel_hi:[1,0]
v_pk_mul_f32 v[68:69], v[68:69], v[30:31] op_sel_hi:[1,0]
v_pk_mul_f32 v[70:71], v[70:71], v[30:31] op_sel_hi:[1,0]
v_pk_mul_f32 v[72:73], v[72:73], v[30:31] op_sel_hi:[1,0]
v_pk_mul_f32 v[74:75], v[74:75], v[30:31] op_sel_hi:[1,0]
v_pk_mul_f32 v[76:77], v[76:77], v[30:31] op_sel_hi:[1,0]
v_pk_mul_f32 v[78:79], v[78:79], v[30:31] op_sel_hi:[1,0]
v_cvt_pk_bf16_f32 v96, v64, v65
v_cvt_pk_bf16_f32 v97, v66, v67
s_waitcnt lgkmcnt(15)
v_mfma_f32_32x32x16_bf16 a[32:47], a[248:251], v[44:47], a[32:47]
ds_read_b64_tr_b16 v[240:241], v21 offset:36032
ds_read_b64_tr_b16 v[242:243], v21 offset:37312
ds_read_b64_tr_b16 v[244:245], v21 offset:36096
ds_read_b64_tr_b16 v[246:247], v21 offset:37376
v_cvt_pk_bf16_f32 v98, v68, v69
v_cvt_pk_bf16_f32 v99, v70, v71
v_cvt_pk_bf16_f32 v100, v72, v73
v_cvt_pk_bf16_f32 v101, v74, v75
v_cvt_pk_bf16_f32 v102, v76, v77
v_cvt_pk_bf16_f32 v103, v78, v79
s_add_u32 s41, s50, 24576
buffer_store_dwordx4 v[96:99], v23, s[24:27], s41 offen offset:0 sc1
buffer_store_dwordx4 v[100:103], v23, s[24:27], s41 offen offset:1024 sc1
v_mfma_f32_32x32x16_bf16 a[48:63], a[204:207], v[32:35], a[48:63]
v_accvgpr_read_b32 v80, a16
v_accvgpr_read_b32 v81, a17
v_accvgpr_read_b32 v82, a18
v_accvgpr_read_b32 v83, a19
v_accvgpr_read_b32 v84, a20
v_accvgpr_read_b32 v85, a21
v_accvgpr_read_b32 v86, a22
v_accvgpr_read_b32 v87, a23
v_accvgpr_read_b32 v88, a24
v_mfma_f32_32x32x16_bf16 a[48:63], a[220:223], v[36:39], a[48:63]
v_accvgpr_read_b32 v89, a25
v_accvgpr_read_b32 v90, a26
v_accvgpr_read_b32 v91, a27
v_accvgpr_read_b32 v92, a28
v_accvgpr_read_b32 v93, a29
v_accvgpr_read_b32 v94, a30
v_accvgpr_read_b32 v95, a31
v_pk_mul_f32 v[80:81], v[80:81], v[30:31] op_sel_hi:[1,0]
v_mfma_f32_32x32x16_bf16 a[48:63], a[236:239], v[40:43], a[48:63]
v_pk_mul_f32 v[82:83], v[82:83], v[30:31] op_sel_hi:[1,0]
v_pk_mul_f32 v[84:85], v[84:85], v[30:31] op_sel_hi:[1,0]
v_pk_mul_f32 v[86:87], v[86:87], v[30:31] op_sel_hi:[1,0]
v_pk_mul_f32 v[88:89], v[88:89], v[30:31] op_sel_hi:[1,0]
v_pk_mul_f32 v[90:91], v[90:91], v[30:31] op_sel_hi:[1,0]
v_pk_mul_f32 v[92:93], v[92:93], v[30:31] op_sel_hi:[1,0]
v_pk_mul_f32 v[94:95], v[94:95], v[30:31] op_sel_hi:[1,0]
v_cvt_pk_bf16_f32 v104, v80, v81
v_cvt_pk_bf16_f32 v105, v82, v83
v_mfma_f32_32x32x16_bf16 a[48:63], a[252:255], v[44:47], a[48:63]
v_cvt_pk_bf16_f32 v106, v84, v85
v_cvt_pk_bf16_f32 v107, v86, v87
v_cvt_pk_bf16_f32 v108, v88, v89
v_cvt_pk_bf16_f32 v109, v90, v91
v_cvt_pk_bf16_f32 v110, v92, v93
v_cvt_pk_bf16_f32 v111, v94, v95
s_add_u32 s41, s50, 30720
buffer_store_dwordx4 v[104:107], v23, s[24:27], s41 offen offset:0 sc1
buffer_store_dwordx4 v[108:111], v23, s[24:27], s41 offen offset:1024 sc1
s_waitcnt lgkmcnt(0)
s_barrier
v_mfma_f32_32x32x16_bf16 v[128:143], v[208:211], v[96:99], v[128:143]
ds_read_b64_tr_b16 a[96:97], v21 offset:51200
ds_read_b64_tr_b16 a[98:99], v21 offset:52480
v_accvgpr_read_b32 v64, a32
v_accvgpr_read_b32 v65, a33
v_accvgpr_read_b32 v66, a34
v_accvgpr_read_b32 v67, a35
v_accvgpr_read_b32 v68, a36
v_accvgpr_read_b32 v69, a37
v_accvgpr_read_b32 v70, a38
v_mfma_f32_32x32x16_bf16 v[144:159], v[212:215], v[96:99], v[144:159]
ds_read_b64_tr_b16 a[100:101], v21 offset:51264
ds_read_b64_tr_b16 a[102:103], v21 offset:52544
v_accvgpr_read_b32 v71, a39
v_accvgpr_read_b32 v72, a40
v_accvgpr_read_b32 v73, a41
v_accvgpr_read_b32 v74, a42
v_accvgpr_read_b32 v75, a43
v_accvgpr_read_b32 v76, a44
v_accvgpr_read_b32 v77, a45
v_mfma_f32_32x32x16_bf16 v[160:175], v[216:219], v[96:99], v[160:175]
ds_read_b64_tr_b16 a[104:105], v21 offset:51328
ds_read_b64_tr_b16 a[106:107], v21 offset:52608
ds_read_b64_tr_b16 a[108:109], v21 offset:51392
v_accvgpr_read_b32 v78, a46
v_accvgpr_read_b32 v79, a47
v_pk_mul_f32 v[64:65], v[64:65], v[30:31] op_sel_hi:[1,0]
v_pk_mul_f32 v[66:67], v[66:67], v[30:31] op_sel_hi:[1,0]
v_pk_mul_f32 v[68:69], v[68:69], v[30:31] op_sel_hi:[1,0]
v_pk_mul_f32 v[70:71], v[70:71], v[30:31] op_sel_hi:[1,0]
v_pk_mul_f32 v[72:73], v[72:73], v[30:31] op_sel_hi:[1,0]
v_mfma_f32_32x32x16_bf16 v[176:191], v[220:223], v[96:99], v[176:191]
ds_read_b64_tr_b16 a[110:111], v21 offset:52672
ds_read_b64_tr_b16 a[112:113], v21 offset:51456
v_pk_mul_f32 v[74:75], v[74:75], v[30:31] op_sel_hi:[1,0]
v_pk_mul_f32 v[76:77], v[76:77], v[30:31] op_sel_hi:[1,0]
v_pk_mul_f32 v[78:79], v[78:79], v[30:31] op_sel_hi:[1,0]
v_cvt_pk_bf16_f32 v112, v64, v65
v_cvt_pk_bf16_f32 v113, v66, v67
v_cvt_pk_bf16_f32 v114, v68, v69
v_cvt_pk_bf16_f32 v115, v70, v71
v_mfma_f32_32x32x16_bf16 v[192:207], v[224:227], v[96:99], v[192:207]
ds_read_b64_tr_b16 a[114:115], v21 offset:52736
ds_read_b64_tr_b16 a[116:117], v21 offset:56320
v_cvt_pk_bf16_f32 v116, v72, v73
v_cvt_pk_bf16_f32 v117, v74, v75
v_cvt_pk_bf16_f32 v118, v76, v77
v_cvt_pk_bf16_f32 v119, v78, v79
s_add_u32 s41, s50, 36864
buffer_store_dwordx4 v[112:115], v23, s[24:27], s41 offen offset:0 sc1
buffer_store_dwordx4 v[116:119], v23, s[24:27], s41 offen offset:1024 sc1
v_mfma_f32_32x32x16_bf16 v[128:143], v[228:231], v[100:103], v[128:143]
ds_read_b64_tr_b16 a[118:119], v21 offset:57600
ds_read_b64_tr_b16 a[120:121], v21 offset:56384
v_accvgpr_read_b32 v80, a48
v_accvgpr_read_b32 v81, a49
v_accvgpr_read_b32 v82, a50
v_accvgpr_read_b32 v83, a51
v_accvgpr_read_b32 v84, a52
v_accvgpr_read_b32 v85, a53
v_accvgpr_read_b32 v86, a54
v_mfma_f32_32x32x16_bf16 v[144:159], v[232:235], v[100:103], v[144:159]
ds_read_b64_tr_b16 a[122:123], v21 offset:57664
ds_read_b64_tr_b16 a[124:125], v21 offset:56448
ds_read_b64_tr_b16 a[126:127], v21 offset:57728
v_accvgpr_read_b32 v87, a55
v_accvgpr_read_b32 v88, a56
v_accvgpr_read_b32 v89, a57
v_accvgpr_read_b32 v90, a58
v_accvgpr_read_b32 v91, a59
v_accvgpr_read_b32 v92, a60
v_accvgpr_read_b32 v93, a61
v_mfma_f32_32x32x16_bf16 v[160:175], v[236:239], v[100:103], v[160:175]
ds_read_b64_tr_b16 v[248:249], v21 offset:56512
ds_read_b64_tr_b16 v[250:251], v21 offset:57792
v_accvgpr_read_b32 v94, a62
v_accvgpr_read_b32 v95, a63
v_pk_mul_f32 v[80:81], v[80:81], v[30:31] op_sel_hi:[1,0]
v_pk_mul_f32 v[82:83], v[82:83], v[30:31] op_sel_hi:[1,0]
v_pk_mul_f32 v[84:85], v[84:85], v[30:31] op_sel_hi:[1,0]
v_pk_mul_f32 v[86:87], v[86:87], v[30:31] op_sel_hi:[1,0]
v_pk_mul_f32 v[88:89], v[88:89], v[30:31] op_sel_hi:[1,0]
v_mfma_f32_32x32x16_bf16 v[176:191], v[240:243], v[100:103], v[176:191]
ds_read_b64_tr_b16 v[252:253], v21 offset:56576
ds_read_b64_tr_b16 v[254:255], v21 offset:57856
v_pk_mul_f32 v[90:91], v[90:91], v[30:31] op_sel_hi:[1,0]
v_pk_mul_f32 v[92:93], v[92:93], v[30:31] op_sel_hi:[1,0]
v_pk_mul_f32 v[94:95], v[94:95], v[30:31] op_sel_hi:[1,0]
v_cvt_pk_bf16_f32 v120, v80, v81
v_cvt_pk_bf16_f32 v121, v82, v83
v_cvt_pk_bf16_f32 v122, v84, v85
v_cvt_pk_bf16_f32 v123, v86, v87
v_mfma_f32_32x32x16_bf16 v[192:207], v[244:247], v[100:103], v[192:207]
v_cvt_pk_bf16_f32 v124, v88, v89
v_cvt_pk_bf16_f32 v125, v90, v91
v_cvt_pk_bf16_f32 v126, v92, v93
v_cvt_pk_bf16_f32 v127, v94, v95
s_add_u32 s41, s50, 43008
buffer_store_dwordx4 v[120:123], v23, s[24:27], s41 offen offset:0 sc1
buffer_store_dwordx4 v[124:127], v23, s[24:27], s41 offen offset:1024 sc1
s_waitcnt lgkmcnt(0)
s_barrier
v_mfma_f32_32x32x16_bf16 v[128:143], a[96:99], v[104:107], v[128:143]
ds_read_b64_tr_b16 v[208:209], v13 offset:0
ds_read_b64_tr_b16 v[210:211], v13 offset:1280
s_add_u32 s44, s38, 2
v_mfma_f32_32x32x16_bf16 v[144:159], a[100:103], v[104:107], v[144:159]
ds_read_b64_tr_b16 v[212:213], v13 offset:64
ds_read_b64_tr_b16 v[214:215], v13 offset:1344
s_and_b32 s44, s44, 3
v_mfma_f32_32x32x16_bf16 v[160:175], a[104:107], v[104:107], v[160:175]
ds_read_b64_tr_b16 v[216:217], v13 offset:128
ds_read_b64_tr_b16 v[218:219], v13 offset:1408
ds_read_b64_tr_b16 v[220:221], v13 offset:192
s_mul_i32 s44, s44, 49152
v_mfma_f32_32x32x16_bf16 v[176:191], a[108:111], v[104:107], v[176:191]
ds_read_b64_tr_b16 v[222:223], v13 offset:1472
ds_read_b64_tr_b16 v[224:225], v13 offset:256
s_add_u32 s44, s44, s55
v_mfma_f32_32x32x16_bf16 v[192:207], a[112:115], v[104:107], v[192:207]
ds_read_b64_tr_b16 v[226:227], v13 offset:1536
ds_read_b64_tr_b16 v[228:229], v13 offset:5120
v_mfma_f32_32x32x16_bf16 v[128:143], a[116:119], v[108:111], v[128:143]
ds_read_b64_tr_b16 v[230:231], v13 offset:6400
ds_read_b64_tr_b16 v[232:233], v13 offset:5184
buffer_load_dwordx4 a[160:163], v23, s[24:27], s44 offen offset:0 sc1
v_mfma_f32_32x32x16_bf16 v[144:159], a[120:123], v[108:111], v[144:159]
ds_read_b64_tr_b16 v[234:235], v13 offset:6464
ds_read_b64_tr_b16 v[236:237], v13 offset:5248
ds_read_b64_tr_b16 v[238:239], v13 offset:6528
buffer_load_dwordx4 a[164:167], v23, s[24:27], s44 offen offset:1024 sc1
v_mfma_f32_32x32x16_bf16 v[160:175], a[124:127], v[108:111], v[160:175]
ds_read_b64_tr_b16 v[240:241], v13 offset:5312
ds_read_b64_tr_b16 v[242:243], v13 offset:6592
s_add_u32 s44, s44, 6144
v_mfma_f32_32x32x16_bf16 v[176:191], v[248:251], v[108:111], v[176:191]
ds_read_b64_tr_b16 v[244:245], v13 offset:5376
ds_read_b64_tr_b16 v[246:247], v13 offset:6656
buffer_load_dwordx4 a[168:171], v23, s[24:27], s44 offen offset:0 sc1
v_mfma_f32_32x32x16_bf16 v[192:207], v[252:255], v[108:111], v[192:207]
buffer_load_dwordx4 a[172:175], v23, s[24:27], s44 offen offset:1024 sc1
s_waitcnt lgkmcnt(0)
s_barrier
v_mfma_f32_32x32x16_bf16 v[128:143], v[208:211], v[112:115], v[128:143]
ds_read_b64_tr_b16 a[96:97], v13 offset:10240
ds_read_b64_tr_b16 a[98:99], v13 offset:11520
s_add_u32 s44, s44, 6144
v_mfma_f32_32x32x16_bf16 v[144:159], v[212:215], v[112:115], v[144:159]
ds_read_b64_tr_b16 a[100:101], v13 offset:10304
ds_read_b64_tr_b16 a[102:103], v13 offset:11584
v_mfma_f32_32x32x16_bf16 v[160:175], v[216:219], v[112:115], v[160:175]
ds_read_b64_tr_b16 a[104:105], v13 offset:10368
ds_read_b64_tr_b16 a[106:107], v13 offset:11648
ds_read_b64_tr_b16 a[108:109], v13 offset:10432
buffer_load_dwordx4 a[176:179], v23, s[24:27], s44 offen offset:0 sc1
v_mfma_f32_32x32x16_bf16 v[176:191], v[220:223], v[112:115], v[176:191]
ds_read_b64_tr_b16 a[110:111], v13 offset:11712
ds_read_b64_tr_b16 a[112:113], v13 offset:10496
v_mfma_f32_32x32x16_bf16 v[192:207], v[224:227], v[112:115], v[192:207]
ds_read_b64_tr_b16 a[114:115], v13 offset:11776
ds_read_b64_tr_b16 a[116:117], v13 offset:15360
buffer_load_dwordx4 a[180:183], v23, s[24:27], s44 offen offset:1024 sc1
v_mfma_f32_32x32x16_bf16 v[128:143], v[228:231], v[116:119], v[128:143]
ds_read_b64_tr_b16 a[118:119], v13 offset:16640
ds_read_b64_tr_b16 a[120:121], v13 offset:15424
s_add_u32 s44, s44, 6144
v_mfma_f32_32x32x16_bf16 v[144:159], v[232:235], v[116:119], v[144:159]
ds_read_b64_tr_b16 a[122:123], v13 offset:16704
ds_read_b64_tr_b16 a[124:125], v13 offset:15488
ds_read_b64_tr_b16 a[126:127], v13 offset:16768
v_mfma_f32_32x32x16_bf16 v[160:175], v[236:239], v[116:119], v[160:175]
ds_read_b64_tr_b16 v[248:249], v13 offset:15552
ds_read_b64_tr_b16 v[250:251], v13 offset:16832
buffer_load_dwordx4 a[184:187], v23, s[24:27], s44 offen offset:0 sc1
v_mfma_f32_32x32x16_bf16 v[176:191], v[240:243], v[116:119], v[176:191]
ds_read_b64_tr_b16 v[252:253], v13 offset:15616
ds_read_b64_tr_b16 v[254:255], v13 offset:16896
v_mfma_f32_32x32x16_bf16 v[192:207], v[244:247], v[116:119], v[192:207]
buffer_load_dwordx4 a[188:191], v23, s[24:27], s44 offen offset:1024 sc1
s_waitcnt lgkmcnt(0)
s_barrier
v_mfma_f32_32x32x16_bf16 v[128:143], a[96:99], v[120:123], v[128:143]
ds_read_b64_tr_b16 v[208:209], v21 offset:0
ds_read_b64_tr_b16 v[210:211], v21 offset:1280
s_add_u32 s44, s38, 3
v_mfma_f32_32x32x16_bf16 v[144:159], a[100:103], v[120:123], v[144:159]
ds_read_b64_tr_b16 v[212:213], v21 offset:64
ds_read_b64_tr_b16 v[214:215], v21 offset:1344
s_and_b32 s44, s44, 3
v_mfma_f32_32x32x16_bf16 v[160:175], a[104:107], v[120:123], v[160:175]
ds_read_b64_tr_b16 v[216:217], v21 offset:128
ds_read_b64_tr_b16 v[218:219], v21 offset:1408
ds_read_b64_tr_b16 v[220:221], v21 offset:192
s_mul_i32 s44, s44, 49152
v_mfma_f32_32x32x16_bf16 v[176:191], a[108:111], v[120:123], v[176:191]
ds_read_b64_tr_b16 v[222:223], v21 offset:1472
ds_read_b64_tr_b16 v[224:225], v21 offset:256
s_add_u32 s44, s44, s55
v_mfma_f32_32x32x16_bf16 v[192:207], a[112:115], v[120:123], v[192:207]
ds_read_b64_tr_b16 v[226:227], v21 offset:1536
ds_read_b64_tr_b16 v[228:229], v21 offset:5120
v_mfma_f32_32x32x16_bf16 v[128:143], a[116:119], v[124:127], v[128:143]
ds_read_b64_tr_b16 v[230:231], v21 offset:6400
ds_read_b64_tr_b16 v[232:233], v21 offset:5184
buffer_load_dwordx4 a[192:195], v23, s[24:27], s44 offen offset:0 sc1
v_mfma_f32_32x32x16_bf16 v[144:159], a[120:123], v[124:127], v[144:159]
ds_read_b64_tr_b16 v[234:235], v21 offset:6464
ds_read_b64_tr_b16 v[236:237], v21 offset:5248
ds_read_b64_tr_b16 v[238:239], v21 offset:6528
buffer_load_dwordx4 a[196:199], v23, s[24:27], s44 offen offset:1024 sc1
v_mfma_f32_32x32x16_bf16 v[160:175], a[124:127], v[124:127], v[160:175]
ds_read_b64_tr_b16 v[240:241], v21 offset:5312
ds_read_b64_tr_b16 v[242:243], v21 offset:6592
s_add_u32 s44, s44, 6144
v_mfma_f32_32x32x16_bf16 v[176:191], v[248:251], v[124:127], v[176:191]
ds_read_b64_tr_b16 v[244:245], v21 offset:5376
ds_read_b64_tr_b16 v[246:247], v21 offset:6656
buffer_load_dwordx4 a[200:203], v23, s[24:27], s44 offen offset:0 sc1
v_mfma_f32_32x32x16_bf16 v[192:207], v[252:255], v[124:127], v[192:207]
buffer_load_dwordx4 a[204:207], v23, s[24:27], s44 offen offset:1024 sc1
s_waitcnt lgkmcnt(0)
s_barrier
s_waitcnt vmcnt(26)
v_mfma_f32_32x32x16_bf16 v[128:143], v[208:211], a[128:131], v[128:143]
ds_read_b64_tr_b16 a[96:97], v21 offset:10240
ds_read_b64_tr_b16 a[98:99], v21 offset:11520
s_add_u32 s44, s44, 6144
v_mfma_f32_32x32x16_bf16 v[144:159], v[212:215], a[128:131], v[144:159]
ds_read_b64_tr_b16 a[100:101], v21 offset:10304
ds_read_b64_tr_b16 a[102:103], v21 offset:11584
v_mfma_f32_32x32x16_bf16 v[160:175], v[216:219], a[128:131], v[160:175]
ds_read_b64_tr_b16 a[104:105], v21 offset:10368
ds_read_b64_tr_b16 a[106:107], v21 offset:11648
ds_read_b64_tr_b16 a[108:109], v21 offset:10432
buffer_load_dwordx4 a[208:211], v23, s[24:27], s44 offen offset:0 sc1
v_mfma_f32_32x32x16_bf16 v[176:191], v[220:223], a[128:131], v[176:191]
ds_read_b64_tr_b16 a[110:111], v21 offset:11712
ds_read_b64_tr_b16 a[112:113], v21 offset:10496
v_mfma_f32_32x32x16_bf16 v[192:207], v[224:227], a[128:131], v[192:207]
ds_read_b64_tr_b16 a[114:115], v21 offset:11776
ds_read_b64_tr_b16 a[116:117], v21 offset:15360
buffer_load_dwordx4 a[212:215], v23, s[24:27], s44 offen offset:1024 sc1
v_mfma_f32_32x32x16_bf16 v[128:143], v[228:231], a[132:135], v[128:143]
ds_read_b64_tr_b16 a[118:119], v21 offset:16640
ds_read_b64_tr_b16 a[120:121], v21 offset:15424
s_add_u32 s44, s44, 6144
v_mfma_f32_32x32x16_bf16 v[144:159], v[232:235], a[132:135], v[144:159]
ds_read_b64_tr_b16 a[122:123], v21 offset:16704
ds_read_b64_tr_b16 a[124:125], v21 offset:15488
ds_read_b64_tr_b16 a[126:127], v21 offset:16768
v_mfma_f32_32x32x16_bf16 v[160:175], v[236:239], a[132:135], v[160:175]
ds_read_b64_tr_b16 v[248:249], v21 offset:15552
ds_read_b64_tr_b16 v[250:251], v21 offset:16832
buffer_load_dwordx4 a[216:219], v23, s[24:27], s44 offen offset:0 sc1
v_mfma_f32_32x32x16_bf16 v[176:191], v[240:243], a[132:135], v[176:191]
ds_read_b64_tr_b16 v[252:253], v21 offset:15616
ds_read_b64_tr_b16 v[254:255], v21 offset:16896
v_mfma_f32_32x32x16_bf16 v[192:207], v[244:247], a[132:135], v[192:207]
buffer_load_dwordx4 a[220:223], v23, s[24:27], s44 offen offset:1024 sc1
s_waitcnt lgkmcnt(0)
s_barrier
s_waitcnt vmcnt(16)
v_mov_b32 v28, 2
buffer_store_dword v28, v22, s[24:27], s49 offen sc1
v_mfma_f32_32x32x16_bf16 v[128:143], a[96:99], a[136:139], v[128:143]
ds_read_b64_tr_b16 v[208:209], v21 offset:20480
ds_read_b64_tr_b16 v[210:211], v21 offset:21760
v_mfma_f32_32x32x16_bf16 v[144:159], a[100:103], a[136:139], v[144:159]
ds_read_b64_tr_b16 v[212:213], v21 offset:20544
ds_read_b64_tr_b16 v[214:215], v21 offset:21824
v_mfma_f32_32x32x16_bf16 v[160:175], a[104:107], a[136:139], v[160:175]
ds_read_b64_tr_b16 v[216:217], v21 offset:20608
ds_read_b64_tr_b16 v[218:219], v21 offset:21888
ds_read_b64_tr_b16 v[220:221], v21 offset:20672
v_mfma_f32_32x32x16_bf16 v[176:191], a[108:111], a[136:139], v[176:191]
ds_read_b64_tr_b16 v[222:223], v21 offset:21952
ds_read_b64_tr_b16 v[224:225], v21 offset:20736
v_mfma_f32_32x32x16_bf16 v[192:207], a[112:115], a[136:139], v[192:207]
ds_read_b64_tr_b16 v[226:227], v21 offset:22016
ds_read_b64_tr_b16 v[228:229], v21 offset:25600
v_mfma_f32_32x32x16_bf16 v[128:143], a[116:119], a[140:143], v[128:143]
ds_read_b64_tr_b16 v[230:231], v21 offset:26880
ds_read_b64_tr_b16 v[232:233], v21 offset:25664
v_mfma_f32_32x32x16_bf16 v[144:159], a[120:123], a[140:143], v[144:159]
ds_read_b64_tr_b16 v[234:235], v21 offset:26944
ds_read_b64_tr_b16 v[236:237], v21 offset:25728
ds_read_b64_tr_b16 v[238:239], v21 offset:27008
v_mfma_f32_32x32x16_bf16 v[160:175], a[124:127], a[140:143], v[160:175]
ds_read_b64_tr_b16 v[240:241], v21 offset:25792
ds_read_b64_tr_b16 v[242:243], v21 offset:27072
v_mfma_f32_32x32x16_bf16 v[176:191], v[248:251], a[140:143], v[176:191]
ds_read_b64_tr_b16 v[244:245], v21 offset:25856
ds_read_b64_tr_b16 v[246:247], v21 offset:27136
v_mfma_f32_32x32x16_bf16 v[192:207], v[252:255], a[140:143], v[192:207]
s_waitcnt lgkmcnt(0)
s_barrier
v_mfma_f32_32x32x16_bf16 v[128:143], v[208:211], a[144:147], v[128:143]
ds_read_b64_tr_b16 a[96:97], v21 offset:40960
ds_read_b64_tr_b16 a[98:99], v21 offset:42240
v_mfma_f32_32x32x16_bf16 v[144:159], v[212:215], a[144:147], v[144:159]
ds_read_b64_tr_b16 a[100:101], v21 offset:41024
ds_read_b64_tr_b16 a[102:103], v21 offset:42304
v_mfma_f32_32x32x16_bf16 v[160:175], v[216:219], a[144:147], v[160:175]
ds_read_b64_tr_b16 a[104:105], v21 offset:41088
ds_read_b64_tr_b16 a[106:107], v21 offset:42368
ds_read_b64_tr_b16 a[108:109], v21 offset:41152
v_mfma_f32_32x32x16_bf16 v[176:191], v[220:223], a[144:147], v[176:191]
ds_read_b64_tr_b16 a[110:111], v21 offset:42432
ds_read_b64_tr_b16 a[112:113], v21 offset:41216
v_mfma_f32_32x32x16_bf16 v[192:207], v[224:227], a[144:147], v[192:207]
ds_read_b64_tr_b16 a[114:115], v21 offset:42496
ds_read_b64_tr_b16 a[116:117], v21 offset:46080
v_mfma_f32_32x32x16_bf16 v[128:143], v[228:231], a[148:151], v[128:143]
ds_read_b64_tr_b16 a[118:119], v21 offset:47360
ds_read_b64_tr_b16 a[120:121], v21 offset:46144
v_mfma_f32_32x32x16_bf16 v[144:159], v[232:235], a[148:151], v[144:159]
ds_read_b64_tr_b16 a[122:123], v21 offset:47424
ds_read_b64_tr_b16 a[124:125], v21 offset:46208
ds_read_b64_tr_b16 a[126:127], v21 offset:47488
v_mfma_f32_32x32x16_bf16 v[160:175], v[236:239], a[148:151], v[160:175]
ds_read_b64_tr_b16 v[248:249], v21 offset:46272
ds_read_b64_tr_b16 v[250:251], v21 offset:47552
v_mfma_f32_32x32x16_bf16 v[176:191], v[240:243], a[148:151], v[176:191]
ds_read_b64_tr_b16 v[252:253], v21 offset:46336
ds_read_b64_tr_b16 v[254:255], v21 offset:47616
v_mfma_f32_32x32x16_bf16 v[192:207], v[244:247], a[148:151], v[192:207]
s_waitcnt lgkmcnt(0)
s_barrier
v_mfma_f32_32x32x16_bf16 v[128:143], a[96:99], a[152:155], v[128:143]
ds_read_b64_tr_b16 v[208:209], v14 offset:30720
ds_read_b64_tr_b16 v[210:211], v14 offset:32000
v_mfma_f32_32x32x16_bf16 v[144:159], a[100:103], a[152:155], v[144:159]
ds_read_b64_tr_b16 v[212:213], v14 offset:30784
ds_read_b64_tr_b16 v[214:215], v14 offset:32064
v_mfma_f32_32x32x16_bf16 v[160:175], a[104:107], a[152:155], v[160:175]
ds_read_b64_tr_b16 v[216:217], v14 offset:30848
ds_read_b64_tr_b16 v[218:219], v14 offset:32128
ds_read_b64_tr_b16 v[220:221], v14 offset:30912
v_mfma_f32_32x32x16_bf16 v[176:191], a[108:111], a[152:155], v[176:191]
ds_read_b64_tr_b16 v[222:223], v14 offset:32192
ds_read_b64_tr_b16 v[224:225], v14 offset:30976
v_mfma_f32_32x32x16_bf16 v[192:207], a[112:115], a[152:155], v[192:207]
ds_read_b64_tr_b16 v[226:227], v14 offset:32256
ds_read_b64_tr_b16 v[228:229], v14 offset:35840
v_mfma_f32_32x32x16_bf16 v[128:143], a[116:119], a[156:159], v[128:143]
ds_read_b64_tr_b16 v[230:231], v14 offset:37120
ds_read_b64_tr_b16 v[232:233], v14 offset:35904
v_mfma_f32_32x32x16_bf16 v[144:159], a[120:123], a[156:159], v[144:159]
ds_read_b64_tr_b16 v[234:235], v14 offset:37184
ds_read_b64_tr_b16 v[236:237], v14 offset:35968
ds_read_b64_tr_b16 v[238:239], v14 offset:37248
v_mfma_f32_32x32x16_bf16 v[160:175], a[124:127], a[156:159], v[160:175]
ds_read_b64_tr_b16 v[240:241], v14 offset:36032
ds_read_b64_tr_b16 v[242:243], v14 offset:37312
v_mfma_f32_32x32x16_bf16 v[176:191], v[248:251], a[156:159], v[176:191]
ds_read_b64_tr_b16 v[244:245], v14 offset:36096
ds_read_b64_tr_b16 v[246:247], v14 offset:37376
v_mfma_f32_32x32x16_bf16 v[192:207], v[252:255], a[156:159], v[192:207]
s_waitcnt lgkmcnt(0)
s_barrier
s_waitcnt vmcnt(15)
v_mfma_f32_32x32x16_bf16 v[128:143], v[208:211], a[160:163], v[128:143]
ds_read_b64_tr_b16 a[96:97], v13 offset:40960
ds_read_b64_tr_b16 a[98:99], v13 offset:42240
v_mfma_f32_32x32x16_bf16 v[144:159], v[212:215], a[160:163], v[144:159]
ds_read_b64_tr_b16 a[100:101], v13 offset:41024
ds_read_b64_tr_b16 a[102:103], v13 offset:42304
v_mfma_f32_32x32x16_bf16 v[160:175], v[216:219], a[160:163], v[160:175]
ds_read_b64_tr_b16 a[104:105], v13 offset:41088
ds_read_b64_tr_b16 a[106:107], v13 offset:42368
ds_read_b64_tr_b16 a[108:109], v13 offset:41152
v_mfma_f32_32x32x16_bf16 v[176:191], v[220:223], a[160:163], v[176:191]
ds_read_b64_tr_b16 a[110:111], v13 offset:42432
ds_read_b64_tr_b16 a[112:113], v13 offset:41216
v_mfma_f32_32x32x16_bf16 v[192:207], v[224:227], a[160:163], v[192:207]
ds_read_b64_tr_b16 a[114:115], v13 offset:42496
ds_read_b64_tr_b16 a[116:117], v13 offset:46080
v_mfma_f32_32x32x16_bf16 v[128:143], v[228:231], a[164:167], v[128:143]
ds_read_b64_tr_b16 a[118:119], v13 offset:47360
ds_read_b64_tr_b16 a[120:121], v13 offset:46144
v_mfma_f32_32x32x16_bf16 v[144:159], v[232:235], a[164:167], v[144:159]
ds_read_b64_tr_b16 a[122:123], v13 offset:47424
ds_read_b64_tr_b16 a[124:125], v13 offset:46208
ds_read_b64_tr_b16 a[126:127], v13 offset:47488
v_mfma_f32_32x32x16_bf16 v[160:175], v[236:239], a[164:167], v[160:175]
ds_read_b64_tr_b16 v[248:249], v13 offset:46272
ds_read_b64_tr_b16 v[250:251], v13 offset:47552
v_mfma_f32_32x32x16_bf16 v[176:191], v[240:243], a[164:167], v[176:191]
ds_read_b64_tr_b16 v[252:253], v13 offset:46336
ds_read_b64_tr_b16 v[254:255], v13 offset:47616
v_mfma_f32_32x32x16_bf16 v[192:207], v[244:247], a[164:167], v[192:207]
s_waitcnt lgkmcnt(0)
s_barrier
s_waitcnt vmcnt(13)
v_mfma_f32_32x32x16_bf16 v[128:143], a[96:99], a[168:171], v[128:143]
ds_read_b64_tr_b16 v[208:209], v13 offset:51200
ds_read_b64_tr_b16 v[210:211], v13 offset:52480
v_mfma_f32_32x32x16_bf16 v[144:159], a[100:103], a[168:171], v[144:159]
ds_read_b64_tr_b16 v[212:213], v13 offset:51264
ds_read_b64_tr_b16 v[214:215], v13 offset:52544
v_mfma_f32_32x32x16_bf16 v[160:175], a[104:107], a[168:171], v[160:175]
ds_read_b64_tr_b16 v[216:217], v13 offset:51328
ds_read_b64_tr_b16 v[218:219], v13 offset:52608
ds_read_b64_tr_b16 v[220:221], v13 offset:51392
v_mfma_f32_32x32x16_bf16 v[176:191], a[108:111], a[168:171], v[176:191]
ds_read_b64_tr_b16 v[222:223], v13 offset:52672
ds_read_b64_tr_b16 v[224:225], v13 offset:51456
v_mfma_f32_32x32x16_bf16 v[192:207], a[112:115], a[168:171], v[192:207]
ds_read_b64_tr_b16 v[226:227], v13 offset:52736
ds_read_b64_tr_b16 v[228:229], v13 offset:56320
v_mfma_f32_32x32x16_bf16 v[128:143], a[116:119], a[172:175], v[128:143]
ds_read_b64_tr_b16 v[230:231], v13 offset:57600
ds_read_b64_tr_b16 v[232:233], v13 offset:56384
v_mfma_f32_32x32x16_bf16 v[144:159], a[120:123], a[172:175], v[144:159]
ds_read_b64_tr_b16 v[234:235], v13 offset:57664
ds_read_b64_tr_b16 v[236:237], v13 offset:56448
ds_read_b64_tr_b16 v[238:239], v13 offset:57728
v_mfma_f32_32x32x16_bf16 v[160:175], a[124:127], a[172:175], v[160:175]
ds_read_b64_tr_b16 v[240:241], v13 offset:56512
ds_read_b64_tr_b16 v[242:243], v13 offset:57792
v_mfma_f32_32x32x16_bf16 v[176:191], v[248:251], a[172:175], v[176:191]
ds_read_b64_tr_b16 v[244:245], v13 offset:56576
ds_read_b64_tr_b16 v[246:247], v13 offset:57856
v_mfma_f32_32x32x16_bf16 v[192:207], v[252:255], a[172:175], v[192:207]
s_waitcnt lgkmcnt(0)
s_barrier
s_waitcnt vmcnt(11)
v_mfma_f32_32x32x16_bf16 v[128:143], v[208:211], a[176:179], v[128:143]
ds_read_b64_tr_b16 a[96:97], v13 offset:20480
ds_read_b64_tr_b16 a[98:99], v13 offset:21760
v_mfma_f32_32x32x16_bf16 v[144:159], v[212:215], a[176:179], v[144:159]
ds_read_b64_tr_b16 a[100:101], v13 offset:20544
ds_read_b64_tr_b16 a[102:103], v13 offset:21824
v_mfma_f32_32x32x16_bf16 v[160:175], v[216:219], a[176:179], v[160:175]
ds_read_b64_tr_b16 a[104:105], v13 offset:20608
ds_read_b64_tr_b16 a[106:107], v13 offset:21888
ds_read_b64_tr_b16 a[108:109], v13 offset:20672
v_mfma_f32_32x32x16_bf16 v[176:191], v[220:223], a[176:179], v[176:191]
ds_read_b64_tr_b16 a[110:111], v13 offset:21952
ds_read_b64_tr_b16 a[112:113], v13 offset:20736
v_mfma_f32_32x32x16_bf16 v[192:207], v[224:227], a[176:179], v[192:207]
ds_read_b64_tr_b16 a[114:115], v13 offset:22016
ds_read_b64_tr_b16 a[116:117], v13 offset:25600
v_mfma_f32_32x32x16_bf16 v[128:143], v[228:231], a[180:183], v[128:143]
ds_read_b64_tr_b16 a[118:119], v13 offset:26880
ds_read_b64_tr_b16 a[120:121], v13 offset:25664
v_mfma_f32_32x32x16_bf16 v[144:159], v[232:235], a[180:183], v[144:159]
ds_read_b64_tr_b16 a[122:123], v13 offset:26944
ds_read_b64_tr_b16 a[124:125], v13 offset:25728
ds_read_b64_tr_b16 a[126:127], v13 offset:27008
v_mfma_f32_32x32x16_bf16 v[160:175], v[236:239], a[180:183], v[160:175]
ds_read_b64_tr_b16 v[248:249], v13 offset:25792
ds_read_b64_tr_b16 v[250:251], v13 offset:27072
v_mfma_f32_32x32x16_bf16 v[176:191], v[240:243], a[180:183], v[176:191]
ds_read_b64_tr_b16 v[252:253], v13 offset:25856
ds_read_b64_tr_b16 v[254:255], v13 offset:27136
v_mfma_f32_32x32x16_bf16 v[192:207], v[244:247], a[180:183], v[192:207]
s_waitcnt lgkmcnt(0)
s_barrier
s_waitcnt vmcnt(9)
v_mfma_f32_32x32x16_bf16 v[128:143], a[96:99], a[184:187], v[128:143]
ds_read_b64_tr_b16 v[208:209], v13 offset:30720
ds_read_b64_tr_b16 v[210:211], v13 offset:32000
s_add_u32 s44, s38, 1
s_and_b32 s44, s44, 3
v_mfma_f32_32x32x16_bf16 v[144:159], a[100:103], a[184:187], v[144:159]
ds_read_b64_tr_b16 v[212:213], v13 offset:30784
ds_read_b64_tr_b16 v[214:215], v13 offset:32064
s_mul_i32 s44, s44, 49152
v_mfma_f32_32x32x16_bf16 v[160:175], a[104:107], a[184:187], v[160:175]
ds_read_b64_tr_b16 v[216:217], v13 offset:30848
ds_read_b64_tr_b16 v[218:219], v13 offset:32128
ds_read_b64_tr_b16 v[220:221], v13 offset:30912
s_add_u32 s44, s44, s55
s_add_u32 s44, s44, 24576
v_mfma_f32_32x32x16_bf16 v[176:191], a[108:111], a[184:187], v[176:191]
ds_read_b64_tr_b16 v[222:223], v13 offset:32192
ds_read_b64_tr_b16 v[224:225], v13 offset:30976
buffer_load_dwordx4 a[0:3], v23, s[24:27], s44 offen offset:0 sc1
v_mfma_f32_32x32x16_bf16 v[192:207], a[112:115], a[184:187], v[192:207]
ds_read_b64_tr_b16 v[226:227], v13 offset:32256
ds_read_b64_tr_b16 v[228:229], v13 offset:35840
buffer_load_dwordx4 a[4:7], v23, s[24:27], s44 offen offset:1024 sc1
s_add_u32 s44, s44, 6144
v_mfma_f32_32x32x16_bf16 v[128:143], a[116:119], a[188:191], v[128:143]
ds_read_b64_tr_b16 v[230:231], v13 offset:37120
ds_read_b64_tr_b16 v[232:233], v13 offset:35904
buffer_load_dwordx4 a[8:11], v23, s[24:27], s44 offen offset:0 sc1
buffer_load_dwordx4 a[12:15], v23, s[24:27], s44 offen offset:1024 sc1
v_mfma_f32_32x32x16_bf16 v[144:159], a[120:123], a[188:191], v[144:159]
ds_read_b64_tr_b16 v[234:235], v13 offset:37184
ds_read_b64_tr_b16 v[236:237], v13 offset:35968
ds_read_b64_tr_b16 v[238:239], v13 offset:37248
s_add_u32 s44, s44, 6144
v_mfma_f32_32x32x16_bf16 v[160:175], a[124:127], a[188:191], v[160:175]
ds_read_b64_tr_b16 v[240:241], v13 offset:36032
ds_read_b64_tr_b16 v[242:243], v13 offset:37312
buffer_load_dwordx4 a[16:19], v23, s[24:27], s44 offen offset:0 sc1
buffer_load_dwordx4 a[20:23], v23, s[24:27], s44 offen offset:1024 sc1
v_mfma_f32_32x32x16_bf16 v[176:191], v[248:251], a[188:191], v[176:191]
ds_read_b64_tr_b16 v[244:245], v13 offset:36096
ds_read_b64_tr_b16 v[246:247], v13 offset:37376
s_add_u32 s44, s44, 6144
v_mfma_f32_32x32x16_bf16 v[192:207], v[252:255], a[188:191], v[192:207]
buffer_load_dwordx4 a[24:27], v23, s[24:27], s44 offen offset:0 sc1
buffer_load_dwordx4 a[28:31], v23, s[24:27], s44 offen offset:1024 sc1
s_waitcnt lgkmcnt(0)
s_barrier
s_waitcnt vmcnt(15)
v_mfma_f32_32x32x16_bf16 v[128:143], v[208:211], a[192:195], v[128:143]
ds_read_b64_tr_b16 a[96:97], v21 offset:30720
ds_read_b64_tr_b16 a[98:99], v21 offset:32000
s_add_u32 s44, s38, 2
v_mfma_f32_32x32x16_bf16 v[144:159], v[212:215], a[192:195], v[144:159]
ds_read_b64_tr_b16 a[100:101], v21 offset:30784
ds_read_b64_tr_b16 a[102:103], v21 offset:32064
s_and_b32 s44, s44, 3
v_mfma_f32_32x32x16_bf16 v[160:175], v[216:219], a[192:195], v[160:175]
ds_read_b64_tr_b16 a[104:105], v21 offset:30848
ds_read_b64_tr_b16 a[106:107], v21 offset:32128
ds_read_b64_tr_b16 a[108:109], v21 offset:30912
s_mul_i32 s44, s44, 49152
v_mfma_f32_32x32x16_bf16 v[176:191], v[220:223], a[192:195], v[176:191]
ds_read_b64_tr_b16 a[110:111], v21 offset:32192
ds_read_b64_tr_b16 a[112:113], v21 offset:30976
s_add_u32 s44, s44, s55
v_mfma_f32_32x32x16_bf16 v[192:207], v[224:227], a[192:195], v[192:207]
ds_read_b64_tr_b16 a[114:115], v21 offset:32256
ds_read_b64_tr_b16 a[116:117], v21 offset:35840
s_add_u32 s44, s44, 24576
v_mfma_f32_32x32x16_bf16 v[128:143], v[228:231], a[196:199], v[128:143]
ds_read_b64_tr_b16 a[118:119], v21 offset:37120
ds_read_b64_tr_b16 a[120:121], v21 offset:35904
buffer_load_dwordx4 a[32:35], v23, s[24:27], s44 offen offset:0 sc1
v_mfma_f32_32x32x16_bf16 v[144:159], v[232:235], a[196:199], v[144:159]
ds_read_b64_tr_b16 a[122:123], v21 offset:37184
ds_read_b64_tr_b16 a[124:125], v21 offset:35968
ds_read_b64_tr_b16 a[126:127], v21 offset:37248
buffer_load_dwordx4 a[36:39], v23, s[24:27], s44 offen offset:1024 sc1
v_mfma_f32_32x32x16_bf16 v[160:175], v[236:239], a[196:199], v[160:175]
ds_read_b64_tr_b16 v[248:249], v21 offset:36032
ds_read_b64_tr_b16 v[250:251], v21 offset:37312
s_add_u32 s44, s44, 6144
v_mfma_f32_32x32x16_bf16 v[176:191], v[240:243], a[196:199], v[176:191]
ds_read_b64_tr_b16 v[252:253], v21 offset:36096
ds_read_b64_tr_b16 v[254:255], v21 offset:37376
buffer_load_dwordx4 a[40:43], v23, s[24:27], s44 offen offset:0 sc1
v_mfma_f32_32x32x16_bf16 v[192:207], v[244:247], a[196:199], v[192:207]
buffer_load_dwordx4 a[44:47], v23, s[24:27], s44 offen offset:1024 sc1
s_waitcnt lgkmcnt(0)
s_barrier
s_waitcnt vmcnt(17)
v_mfma_f32_32x32x16_bf16 v[128:143], a[96:99], a[200:203], v[128:143]
ds_read_b64_tr_b16 v[208:209], v14 offset:0
ds_read_b64_tr_b16 v[210:211], v14 offset:1280
s_add_u32 s44, s44, 6144
v_mfma_f32_32x32x16_bf16 v[144:159], a[100:103], a[200:203], v[144:159]
ds_read_b64_tr_b16 v[212:213], v14 offset:64
ds_read_b64_tr_b16 v[214:215], v14 offset:1344
v_mfma_f32_32x32x16_bf16 v[160:175], a[104:107], a[200:203], v[160:175]
ds_read_b64_tr_b16 v[216:217], v14 offset:128
ds_read_b64_tr_b16 v[218:219], v14 offset:1408
ds_read_b64_tr_b16 v[220:221], v14 offset:192
buffer_load_dwordx4 a[48:51], v23, s[24:27], s44 offen offset:0 sc1
v_mfma_f32_32x32x16_bf16 v[176:191], a[108:111], a[200:203], v[176:191]
ds_read_b64_tr_b16 v[222:223], v14 offset:1472
ds_read_b64_tr_b16 v[224:225], v14 offset:256
v_mfma_f32_32x32x16_bf16 v[192:207], a[112:115], a[200:203], v[192:207]
ds_read_b64_tr_b16 v[226:227], v14 offset:1536
ds_read_b64_tr_b16 v[228:229], v14 offset:5120
buffer_load_dwordx4 a[52:55], v23, s[24:27], s44 offen offset:1024 sc1
v_mfma_f32_32x32x16_bf16 v[128:143], a[116:119], a[204:207], v[128:143]
ds_read_b64_tr_b16 v[230:231], v14 offset:6400
ds_read_b64_tr_b16 v[232:233], v14 offset:5184
s_add_u32 s44, s44, 6144
v_mfma_f32_32x32x16_bf16 v[144:159], a[120:123], a[204:207], v[144:159]
ds_read_b64_tr_b16 v[234:235], v14 offset:6464
ds_read_b64_tr_b16 v[236:237], v14 offset:5248
ds_read_b64_tr_b16 v[238:239], v14 offset:6528
v_mfma_f32_32x32x16_bf16 v[160:175], a[124:127], a[204:207], v[160:175]
ds_read_b64_tr_b16 v[240:241], v14 offset:5312
ds_read_b64_tr_b16 v[242:243], v14 offset:6592
buffer_load_dwordx4 a[56:59], v23, s[24:27], s44 offen offset:0 sc1
v_mfma_f32_32x32x16_bf16 v[176:191], v[248:251], a[204:207], v[176:191]
ds_read_b64_tr_b16 v[244:245], v14 offset:5376
ds_read_b64_tr_b16 v[246:247], v14 offset:6656
v_mfma_f32_32x32x16_bf16 v[192:207], v[252:255], a[204:207], v[192:207]
buffer_load_dwordx4 a[60:63], v23, s[24:27], s44 offen offset:1024 sc1
s_waitcnt lgkmcnt(0)
s_barrier
s_waitcnt vmcnt(19)
v_mfma_f32_32x32x16_bf16 v[128:143], v[208:211], a[208:211], v[128:143]
ds_read_b64_tr_b16 a[96:97], v14 offset:10240
ds_read_b64_tr_b16 a[98:99], v14 offset:11520
s_add_u32 s44, s38, 3
v_mfma_f32_32x32x16_bf16 v[144:159], v[212:215], a[208:211], v[144:159]
ds_read_b64_tr_b16 a[100:101], v14 offset:10304
ds_read_b64_tr_b16 a[102:103], v14 offset:11584
s_and_b32 s44, s44, 3
v_mfma_f32_32x32x16_bf16 v[160:175], v[216:219], a[208:211], v[160:175]
ds_read_b64_tr_b16 a[104:105], v14 offset:10368
ds_read_b64_tr_b16 a[106:107], v14 offset:11648
ds_read_b64_tr_b16 a[108:109], v14 offset:10432
s_mul_i32 s44, s44, 49152
v_mfma_f32_32x32x16_bf16 v[176:191], v[220:223], a[208:211], v[176:191]
ds_read_b64_tr_b16 a[110:111], v14 offset:11712
ds_read_b64_tr_b16 a[112:113], v14 offset:10496
s_add_u32 s44, s44, s55
v_mfma_f32_32x32x16_bf16 v[192:207], v[224:227], a[208:211], v[192:207]
ds_read_b64_tr_b16 a[114:115], v14 offset:11776
ds_read_b64_tr_b16 a[116:117], v14 offset:15360
s_add_u32 s44, s44, 24576
v_mfma_f32_32x32x16_bf16 v[128:143], v[228:231], a[212:215], v[128:143]
ds_read_b64_tr_b16 a[118:119], v14 offset:16640
ds_read_b64_tr_b16 a[120:121], v14 offset:15424
buffer_load_dwordx4 a[224:227], v23, s[24:27], s44 offen offset:0 sc1
v_mfma_f32_32x32x16_bf16 v[144:159], v[232:235], a[212:215], v[144:159]
ds_read_b64_tr_b16 a[122:123], v14 offset:16704
ds_read_b64_tr_b16 a[124:125], v14 offset:15488
ds_read_b64_tr_b16 a[126:127], v14 offset:16768
buffer_load_dwordx4 a[228:231], v23, s[24:27], s44 offen offset:1024 sc1
v_mfma_f32_32x32x16_bf16 v[160:175], v[236:239], a[212:215], v[160:175]
ds_read_b64_tr_b16 v[248:249], v14 offset:15552
ds_read_b64_tr_b16 v[250:251], v14 offset:16832
s_add_u32 s44, s44, 6144
v_mfma_f32_32x32x16_bf16 v[176:191], v[240:243], a[212:215], v[176:191]
ds_read_b64_tr_b16 v[252:253], v14 offset:15616
ds_read_b64_tr_b16 v[254:255], v14 offset:16896
buffer_load_dwordx4 a[232:235], v23, s[24:27], s44 offen offset:0 sc1
v_mfma_f32_32x32x16_bf16 v[192:207], v[244:247], a[212:215], v[192:207]
buffer_load_dwordx4 a[236:239], v23, s[24:27], s44 offen offset:1024 sc1
s_waitcnt lgkmcnt(0)
s_barrier
s_waitcnt vmcnt(21)
v_mfma_f32_32x32x16_bf16 v[128:143], a[96:99], a[216:219], v[128:143]
ds_read_b64_tr_b16 v[208:209], v14 offset:20480
ds_read_b64_tr_b16 v[210:211], v14 offset:21760
s_add_u32 s44, s44, 6144
v_mfma_f32_32x32x16_bf16 v[144:159], a[100:103], a[216:219], v[144:159]
ds_read_b64_tr_b16 v[212:213], v14 offset:20544
ds_read_b64_tr_b16 v[214:215], v14 offset:21824
v_mfma_f32_32x32x16_bf16 v[160:175], a[104:107], a[216:219], v[160:175]
ds_read_b64_tr_b16 v[216:217], v14 offset:20608
ds_read_b64_tr_b16 v[218:219], v14 offset:21888
ds_read_b64_tr_b16 v[220:221], v14 offset:20672
buffer_load_dwordx4 a[240:243], v23, s[24:27], s44 offen offset:0 sc1
v_mfma_f32_32x32x16_bf16 v[176:191], a[108:111], a[216:219], v[176:191]
ds_read_b64_tr_b16 v[222:223], v14 offset:21952
ds_read_b64_tr_b16 v[224:225], v14 offset:20736
v_mfma_f32_32x32x16_bf16 v[192:207], a[112:115], a[216:219], v[192:207]
ds_read_b64_tr_b16 v[226:227], v14 offset:22016
ds_read_b64_tr_b16 v[228:229], v14 offset:25600
buffer_load_dwordx4 a[244:247], v23, s[24:27], s44 offen offset:1024 sc1
v_mfma_f32_32x32x16_bf16 v[128:143], a[116:119], a[220:223], v[128:143]
ds_read_b64_tr_b16 v[230:231], v14 offset:26880
ds_read_b64_tr_b16 v[232:233], v14 offset:25664
s_add_u32 s44, s44, 6144
v_mfma_f32_32x32x16_bf16 v[144:159], a[120:123], a[220:223], v[144:159]
ds_read_b64_tr_b16 v[234:235], v14 offset:26944
ds_read_b64_tr_b16 v[236:237], v14 offset:25728
ds_read_b64_tr_b16 v[238:239], v14 offset:27008
v_mfma_f32_32x32x16_bf16 v[160:175], a[124:127], a[220:223], v[160:175]
ds_read_b64_tr_b16 v[240:241], v14 offset:25792
ds_read_b64_tr_b16 v[242:243], v14 offset:27072
buffer_load_dwordx4 a[248:251], v23, s[24:27], s44 offen offset:0 sc1
v_mfma_f32_32x32x16_bf16 v[176:191], v[248:251], a[220:223], v[176:191]
ds_read_b64_tr_b16 v[244:245], v14 offset:25856
ds_read_b64_tr_b16 v[246:247], v14 offset:27136
v_mfma_f32_32x32x16_bf16 v[192:207], v[252:255], a[220:223], v[192:207]
buffer_load_dwordx4 a[252:255], v23, s[24:27], s44 offen offset:1024 sc1
s_waitcnt lgkmcnt(0)
s_barrier
s_waitcnt vmcnt(22)
v_mfma_f32_32x32x16_bf16 v[128:143], v[208:211], a[0:3], v[128:143]
ds_read_b64_tr_b16 a[96:97], v21 offset:51200
ds_read_b64_tr_b16 a[98:99], v21 offset:52480
v_mfma_f32_32x32x16_bf16 v[144:159], v[212:215], a[0:3], v[144:159]
ds_read_b64_tr_b16 a[100:101], v21 offset:51264
ds_read_b64_tr_b16 a[102:103], v21 offset:52544
v_mfma_f32_32x32x16_bf16 v[160:175], v[216:219], a[0:3], v[160:175]
ds_read_b64_tr_b16 a[104:105], v21 offset:51328
ds_read_b64_tr_b16 a[106:107], v21 offset:52608
ds_read_b64_tr_b16 a[108:109], v21 offset:51392
v_mfma_f32_32x32x16_bf16 v[176:191], v[220:223], a[0:3], v[176:191]
ds_read_b64_tr_b16 a[110:111], v21 offset:52672
ds_read_b64_tr_b16 a[112:113], v21 offset:51456
v_mfma_f32_32x32x16_bf16 v[192:207], v[224:227], a[0:3], v[192:207]
ds_read_b64_tr_b16 a[114:115], v21 offset:52736
ds_read_b64_tr_b16 a[116:117], v21 offset:56320
v_mfma_f32_32x32x16_bf16 v[128:143], v[228:231], a[4:7], v[128:143]
ds_read_b64_tr_b16 a[118:119], v21 offset:57600
ds_read_b64_tr_b16 a[120:121], v21 offset:56384
v_mfma_f32_32x32x16_bf16 v[144:159], v[232:235], a[4:7], v[144:159]
ds_read_b64_tr_b16 a[122:123], v21 offset:57664
ds_read_b64_tr_b16 a[124:125], v21 offset:56448
ds_read_b64_tr_b16 a[126:127], v21 offset:57728
v_mfma_f32_32x32x16_bf16 v[160:175], v[236:239], a[4:7], v[160:175]
ds_read_b64_tr_b16 v[248:249], v21 offset:56512
ds_read_b64_tr_b16 v[250:251], v21 offset:57792
v_mfma_f32_32x32x16_bf16 v[176:191], v[240:243], a[4:7], v[176:191]
ds_read_b64_tr_b16 v[252:253], v21 offset:56576
ds_read_b64_tr_b16 v[254:255], v21 offset:57856
v_mfma_f32_32x32x16_bf16 v[192:207], v[244:247], a[4:7], v[192:207]
s_waitcnt lgkmcnt(0)
s_barrier
s_waitcnt vmcnt(20)
v_mfma_f32_32x32x16_bf16 v[128:143], a[96:99], a[8:11], v[128:143]
ds_read_b64_tr_b16 v[208:209], v13 offset:0
ds_read_b64_tr_b16 v[210:211], v13 offset:1280
v_mfma_f32_32x32x16_bf16 v[144:159], a[100:103], a[8:11], v[144:159]
ds_read_b64_tr_b16 v[212:213], v13 offset:64
ds_read_b64_tr_b16 v[214:215], v13 offset:1344
v_mfma_f32_32x32x16_bf16 v[160:175], a[104:107], a[8:11], v[160:175]
ds_read_b64_tr_b16 v[216:217], v13 offset:128
ds_read_b64_tr_b16 v[218:219], v13 offset:1408
ds_read_b64_tr_b16 v[220:221], v13 offset:192
v_mfma_f32_32x32x16_bf16 v[176:191], a[108:111], a[8:11], v[176:191]
ds_read_b64_tr_b16 v[222:223], v13 offset:1472
ds_read_b64_tr_b16 v[224:225], v13 offset:256
v_mfma_f32_32x32x16_bf16 v[192:207], a[112:115], a[8:11], v[192:207]
ds_read_b64_tr_b16 v[226:227], v13 offset:1536
ds_read_b64_tr_b16 v[228:229], v13 offset:5120
v_mfma_f32_32x32x16_bf16 v[128:143], a[116:119], a[12:15], v[128:143]
ds_read_b64_tr_b16 v[230:231], v13 offset:6400
ds_read_b64_tr_b16 v[232:233], v13 offset:5184
v_mfma_f32_32x32x16_bf16 v[144:159], a[120:123], a[12:15], v[144:159]
ds_read_b64_tr_b16 v[234:235], v13 offset:6464
ds_read_b64_tr_b16 v[236:237], v13 offset:5248
ds_read_b64_tr_b16 v[238:239], v13 offset:6528
v_mfma_f32_32x32x16_bf16 v[160:175], a[124:127], a[12:15], v[160:175]
ds_read_b64_tr_b16 v[240:241], v13 offset:5312
ds_read_b64_tr_b16 v[242:243], v13 offset:6592
v_mfma_f32_32x32x16_bf16 v[176:191], v[248:251], a[12:15], v[176:191]
ds_read_b64_tr_b16 v[244:245], v13 offset:5376
ds_read_b64_tr_b16 v[246:247], v13 offset:6656
v_mfma_f32_32x32x16_bf16 v[192:207], v[252:255], a[12:15], v[192:207]
s_waitcnt lgkmcnt(0)
s_barrier
s_waitcnt vmcnt(18)
v_mfma_f32_32x32x16_bf16 v[128:143], v[208:211], a[16:19], v[128:143]
ds_read_b64_tr_b16 a[96:97], v13 offset:10240
ds_read_b64_tr_b16 a[98:99], v13 offset:11520
v_add_u32 v26, 0, v0
v_lshrrev_b32 v27, 3, v26
v_mfma_f32_32x32x16_bf16 v[144:159], v[212:215], a[16:19], v[144:159]
ds_read_b64_tr_b16 a[100:101], v13 offset:10304
ds_read_b64_tr_b16 a[102:103], v13 offset:11584
v_and_b32 v26, 7, v26
v_lshlrev_b32 v3, 9, v27
v_mfma_f32_32x32x16_bf16 v[160:175], v[216:219], a[16:19], v[160:175]
ds_read_b64_tr_b16 a[104:105], v13 offset:10368
ds_read_b64_tr_b16 a[106:107], v13 offset:11648
ds_read_b64_tr_b16 a[108:109], v13 offset:10432
v_lshl_add_u32 v3, v26, 4, v3
v_mul_u32_u24 v6, 2560, v26
v_lshl_add_u32 v6, v27, 4, v6
v_mfma_f32_32x32x16_bf16 v[176:191], v[220:223], a[16:19], v[176:191]
ds_read_b64_tr_b16 a[110:111], v13 offset:11712
ds_read_b64_tr_b16 a[112:113], v13 offset:10496
v_add_u32 v26, 64, v0
v_lshrrev_b32 v27, 3, v26
v_mfma_f32_32x32x16_bf16 v[192:207], v[224:227], a[16:19], v[192:207]
ds_read_b64_tr_b16 a[114:115], v13 offset:11776
ds_read_b64_tr_b16 a[116:117], v13 offset:15360
v_and_b32 v26, 7, v26
v_lshlrev_b32 v4, 9, v27
v_mfma_f32_32x32x16_bf16 v[128:143], v[228:231], a[20:23], v[128:143]
ds_read_b64_tr_b16 a[118:119], v13 offset:16640
ds_read_b64_tr_b16 a[120:121], v13 offset:15424
v_lshl_add_u32 v4, v26, 4, v4
v_mul_u32_u24 v7, 2560, v26
v_mfma_f32_32x32x16_bf16 v[144:159], v[232:235], a[20:23], v[144:159]
ds_read_b64_tr_b16 a[122:123], v13 offset:16704
ds_read_b64_tr_b16 a[124:125], v13 offset:15488
ds_read_b64_tr_b16 a[126:127], v13 offset:16768
v_lshl_add_u32 v7, v27, 4, v7
s_mov_b32 s43, 128
v_mfma_f32_32x32x16_bf16 v[160:175], v[236:239], a[20:23], v[160:175]
ds_read_b64_tr_b16 v[248:249], v13 offset:15552
ds_read_b64_tr_b16 v[250:251], v13 offset:16832
v_and_or_b32 v26, v0, 31, s43
v_lshrrev_b32 v27, 3, v26
v_and_b32 v26, 7, v26
v_mfma_f32_32x32x16_bf16 v[176:191], v[240:243], a[20:23], v[176:191]
ds_read_b64_tr_b16 v[252:253], v13 offset:15616
ds_read_b64_tr_b16 v[254:255], v13 offset:16896
v_lshlrev_b32 v5, 9, v27
v_lshl_add_u32 v5, v26, 4, v5
v_mfma_f32_32x32x16_bf16 v[192:207], v[244:247], a[20:23], v[192:207]
v_mul_u32_u24 v8, 2560, v26
v_lshl_add_u32 v8, v27, 4, v8
s_waitcnt lgkmcnt(0)
s_waitcnt vmcnt(16)
v_mfma_f32_32x32x16_bf16 v[128:143], a[96:99], a[24:27], v[128:143]
ds_read_b64_tr_b16 v[208:209], v21 offset:0
ds_read_b64_tr_b16 v[210:211], v21 offset:1280
v_and_b32 v26, 32, v0
v_lshl_or_b32 v8, v26, 25, v8
v_mfma_f32_32x32x16_bf16 v[144:159], a[100:103], a[24:27], v[144:159]
ds_read_b64_tr_b16 v[212:213], v21 offset:64
ds_read_b64_tr_b16 v[214:215], v21 offset:1344
v_bfe_u32 v26, v0, 3, 2
v_cmp_eq_u32 vcc, s39, v26
v_mfma_f32_32x32x16_bf16 v[160:175], a[104:107], a[24:27], v[160:175]
ds_read_b64_tr_b16 v[216:217], v21 offset:128
ds_read_b64_tr_b16 v[218:219], v21 offset:1408
ds_read_b64_tr_b16 v[220:221], v21 offset:192
v_mov_b32 v27, 0x40000000
v_mfma_f32_32x32x16_bf16 v[176:191], a[108:111], a[24:27], v[176:191]
ds_read_b64_tr_b16 v[222:223], v21 offset:1472
ds_read_b64_tr_b16 v[224:225], v21 offset:256
s_cmp_eq_u32 s36, 1
s_mov_b32 s43, 30720
v_mfma_f32_32x32x16_bf16 v[192:207], a[112:115], a[24:27], v[192:207]
ds_read_b64_tr_b16 v[226:227], v21 offset:1536
ds_read_b64_tr_b16 v[228:229], v21 offset:5120
v_cndmask_b32 v9, v23, v27, vcc
s_cselect_b32 s43, 51200, s43
v_mfma_f32_32x32x16_bf16 v[128:143], a[116:119], a[28:31], v[128:143]
ds_read_b64_tr_b16 v[230:231], v21 offset:6400
ds_read_b64_tr_b16 v[232:233], v21 offset:5184
s_cmp_eq_u32 s36, 2
s_cselect_b32 s43, 61440, s43
v_mfma_f32_32x32x16_bf16 v[144:159], a[120:123], a[28:31], v[144:159]
ds_read_b64_tr_b16 v[234:235], v21 offset:6464
ds_read_b64_tr_b16 v[236:237], v21 offset:5248
ds_read_b64_tr_b16 v[238:239], v21 offset:6528
v_add_u32 v10, s43, v23
s_lshl_b32 s42, s39, 7
v_mfma_f32_32x32x16_bf16 v[160:175], a[124:127], a[28:31], v[160:175]
ds_read_b64_tr_b16 v[240:241], v21 offset:5312
ds_read_b64_tr_b16 v[242:243], v21 offset:6592
s_add_u32 s43, s43, s42
v_mfma_f32_32x32x16_bf16 v[176:191], v[248:251], a[28:31], v[176:191]
ds_read_b64_tr_b16 v[244:245], v21 offset:5376
ds_read_b64_tr_b16 v[246:247], v21 offset:6656
v_add_u32 v11, s43, v3
v_add_u32 v12, s43, v4
v_mfma_f32_32x32x16_bf16 v[192:207], v[252:255], a[28:31], v[192:207]
v_add_u32 v2, s43, v5
s_mov_b32 s60, 0x00010001
s_waitcnt lgkmcnt(0)
s_waitcnt vmcnt(14)
v_mfma_f32_32x32x16_bf16 v[128:143], v[208:211], a[32:35], v[128:143]
ds_read_b64_tr_b16 a[96:97], v21 offset:10240
ds_read_b64_tr_b16 a[98:99], v21 offset:11520
v_mfma_f32_32x32x16_bf16 v[144:159], v[212:215], a[32:35], v[144:159]
ds_read_b64_tr_b16 a[100:101], v21 offset:10304
ds_read_b64_tr_b16 a[102:103], v21 offset:11584
v_mfma_f32_32x32x16_bf16 v[160:175], v[216:219], a[32:35], v[160:175]
ds_read_b64_tr_b16 a[104:105], v21 offset:10368
ds_read_b64_tr_b16 a[106:107], v21 offset:11648
ds_read_b64_tr_b16 a[108:109], v21 offset:10432
v_mfma_f32_32x32x16_bf16 v[176:191], v[220:223], a[32:35], v[176:191]
ds_read_b64_tr_b16 a[110:111], v21 offset:11712
ds_read_b64_tr_b16 a[112:113], v21 offset:10496
v_mfma_f32_32x32x16_bf16 v[192:207], v[224:227], a[32:35], v[192:207]
ds_read_b64_tr_b16 a[114:115], v21 offset:11776
ds_read_b64_tr_b16 a[116:117], v21 offset:15360
v_mfma_f32_32x32x16_bf16 v[128:143], v[228:231], a[36:39], v[128:143]
ds_read_b64_tr_b16 a[118:119], v21 offset:16640
ds_read_b64_tr_b16 a[120:121], v21 offset:15424
v_mfma_f32_32x32x16_bf16 v[144:159], v[232:235], a[36:39], v[144:159]
ds_read_b64_tr_b16 a[122:123], v21 offset:16704
ds_read_b64_tr_b16 a[124:125], v21 offset:15488
ds_read_b64_tr_b16 a[126:127], v21 offset:16768
v_mfma_f32_32x32x16_bf16 v[160:175], v[236:239], a[36:39], v[160:175]
ds_read_b64_tr_b16 v[248:249], v21 offset:15552
ds_read_b64_tr_b16 v[250:251], v21 offset:16832
v_mfma_f32_32x32x16_bf16 v[176:191], v[240:243], a[36:39], v[176:191]
ds_read_b64_tr_b16 v[252:253], v21 offset:15616
ds_read_b64_tr_b16 v[254:255], v21 offset:16896
v_mfma_f32_32x32x16_bf16 v[192:207], v[244:247], a[36:39], v[192:207]
s_waitcnt lgkmcnt(0)
s_waitcnt vmcnt(12)
v_mfma_f32_32x32x16_bf16 v[128:143], a[96:99], a[40:43], v[128:143]
ds_read_b64_tr_b16 v[208:209], v21 offset:20480
ds_read_b64_tr_b16 v[210:211], v21 offset:21760
v_mfma_f32_32x32x16_bf16 v[144:159], a[100:103], a[40:43], v[144:159]
ds_read_b64_tr_b16 v[212:213], v21 offset:20544
ds_read_b64_tr_b16 v[214:215], v21 offset:21824
v_mfma_f32_32x32x16_bf16 v[160:175], a[104:107], a[40:43], v[160:175]
ds_read_b64_tr_b16 v[216:217], v21 offset:20608
ds_read_b64_tr_b16 v[218:219], v21 offset:21888
ds_read_b64_tr_b16 v[220:221], v21 offset:20672
v_mfma_f32_32x32x16_bf16 v[176:191], a[108:111], a[40:43], v[176:191]
ds_read_b64_tr_b16 v[222:223], v21 offset:21952
ds_read_b64_tr_b16 v[224:225], v21 offset:20736
v_mfma_f32_32x32x16_bf16 v[192:207], a[112:115], a[40:43], v[192:207]
ds_read_b64_tr_b16 v[226:227], v21 offset:22016
ds_read_b64_tr_b16 v[228:229], v21 offset:25600
v_mfma_f32_32x32x16_bf16 v[128:143], a[116:119], a[44:47], v[128:143]
ds_read_b64_tr_b16 v[230:231], v21 offset:26880
ds_read_b64_tr_b16 v[232:233], v21 offset:25664
v_mfma_f32_32x32x16_bf16 v[144:159], a[120:123], a[44:47], v[144:159]
ds_read_b64_tr_b16 v[234:235], v21 offset:26944
ds_read_b64_tr_b16 v[236:237], v21 offset:25728
ds_read_b64_tr_b16 v[238:239], v21 offset:27008
v_mfma_f32_32x32x16_bf16 v[160:175], a[124:127], a[44:47], v[160:175]
ds_read_b64_tr_b16 v[240:241], v21 offset:25792
ds_read_b64_tr_b16 v[242:243], v21 offset:27072
v_mfma_f32_32x32x16_bf16 v[176:191], v[248:251], a[44:47], v[176:191]
ds_read_b64_tr_b16 v[244:245], v21 offset:25856
ds_read_b64_tr_b16 v[246:247], v21 offset:27136
v_mfma_f32_32x32x16_bf16 v[192:207], v[252:255], a[44:47], v[192:207]
s_waitcnt lgkmcnt(0)
s_waitcnt vmcnt(10)
v_mfma_f32_32x32x16_bf16 v[128:143], v[208:211], a[48:51], v[128:143]
ds_read_b64_tr_b16 a[96:97], v21 offset:40960
ds_read_b64_tr_b16 a[98:99], v21 offset:42240
v_mfma_f32_32x32x16_bf16 v[144:159], v[212:215], a[48:51], v[144:159]
ds_read_b64_tr_b16 a[100:101], v21 offset:41024
ds_read_b64_tr_b16 a[102:103], v21 offset:42304
v_mfma_f32_32x32x16_bf16 v[160:175], v[216:219], a[48:51], v[160:175]
ds_read_b64_tr_b16 a[104:105], v21 offset:41088
ds_read_b64_tr_b16 a[106:107], v21 offset:42368
ds_read_b64_tr_b16 a[108:109], v21 offset:41152
v_mfma_f32_32x32x16_bf16 v[176:191], v[220:223], a[48:51], v[176:191]
ds_read_b64_tr_b16 a[110:111], v21 offset:42432
ds_read_b64_tr_b16 a[112:113], v21 offset:41216
v_mfma_f32_32x32x16_bf16 v[192:207], v[224:227], a[48:51], v[192:207]
ds_read_b64_tr_b16 a[114:115], v21 offset:42496
ds_read_b64_tr_b16 a[116:117], v21 offset:46080
v_mfma_f32_32x32x16_bf16 v[128:143], v[228:231], a[52:55], v[128:143]
ds_read_b64_tr_b16 a[118:119], v21 offset:47360
ds_read_b64_tr_b16 a[120:121], v21 offset:46144
v_mfma_f32_32x32x16_bf16 v[144:159], v[232:235], a[52:55], v[144:159]
ds_read_b64_tr_b16 a[122:123], v21 offset:47424
ds_read_b64_tr_b16 a[124:125], v21 offset:46208
ds_read_b64_tr_b16 a[126:127], v21 offset:47488
v_mfma_f32_32x32x16_bf16 v[160:175], v[236:239], a[52:55], v[160:175]
ds_read_b64_tr_b16 v[248:249], v21 offset:46272
ds_read_b64_tr_b16 v[250:251], v21 offset:47552
v_mfma_f32_32x32x16_bf16 v[176:191], v[240:243], a[52:55], v[176:191]
ds_read_b64_tr_b16 v[252:253], v21 offset:46336
ds_read_b64_tr_b16 v[254:255], v21 offset:47616
v_mfma_f32_32x32x16_bf16 v[192:207], v[244:247], a[52:55], v[192:207]
s_waitcnt lgkmcnt(0)
s_waitcnt vmcnt(8)
v_mfma_f32_32x32x16_bf16 v[128:143], a[96:99], a[56:59], v[128:143]
ds_read_b64_tr_b16 v[208:209], v14 offset:30720
ds_read_b64_tr_b16 v[210:211], v14 offset:32000
v_mfma_f32_32x32x16_bf16 v[144:159], a[100:103], a[56:59], v[144:159]
ds_read_b64_tr_b16 v[212:213], v14 offset:35840
ds_read_b64_tr_b16 v[214:215], v14 offset:37120
v_mfma_f32_32x32x16_bf16 v[160:175], a[104:107], a[56:59], v[160:175]
ds_read_b64_tr_b16 v[216:217], v13 offset:40960
v_mfma_f32_32x32x16_bf16 v[176:191], a[108:111], a[56:59], v[176:191]
ds_read_b64_tr_b16 v[218:219], v13 offset:42240
ds_read_b64_tr_b16 v[220:221], v13 offset:46080
v_mfma_f32_32x32x16_bf16 v[192:207], a[112:115], a[56:59], v[192:207]
ds_read_b64_tr_b16 v[222:223], v13 offset:47360
ds_read_b64_tr_b16 v[224:225], v13 offset:51200
v_mfma_f32_32x32x16_bf16 v[128:143], a[116:119], a[60:63], v[128:143]
ds_read_b64_tr_b16 v[226:227], v13 offset:52480
ds_read_b64_tr_b16 v[228:229], v13 offset:56320
v_mfma_f32_32x32x16_bf16 v[144:159], a[120:123], a[60:63], v[144:159]
ds_read_b64_tr_b16 v[230:231], v13 offset:57600
v_mfma_f32_32x32x16_bf16 v[160:175], a[124:127], a[60:63], v[160:175]
ds_read_b64_tr_b16 v[232:233], v13 offset:20480
ds_read_b64_tr_b16 v[234:235], v13 offset:21760
v_mfma_f32_32x32x16_bf16 v[176:191], v[248:251], a[60:63], v[176:191]
ds_read_b64_tr_b16 v[236:237], v13 offset:25600
ds_read_b64_tr_b16 v[238:239], v13 offset:26880
v_mfma_f32_32x32x16_bf16 v[192:207], v[252:255], a[60:63], v[192:207]
s_waitcnt lgkmcnt(0)
s_waitcnt vmcnt(6)
s_waitcnt vmcnt(4)
s_waitcnt vmcnt(2)
s_waitcnt vmcnt(0)
v_mfma_f32_32x32x16_bf16 v[128:143], v[208:211], a[224:227], v[128:143]
ds_read_b64_tr_b16 a[96:97], v14 offset:30784
ds_read_b64_tr_b16 a[98:99], v14 offset:32064
v_mfma_f32_32x32x16_bf16 v[128:143], v[212:215], a[228:231], v[128:143]
ds_read_b64_tr_b16 a[100:101], v14 offset:35904
ds_read_b64_tr_b16 a[102:103], v14 offset:37184
ds_read_b64_tr_b16 a[104:105], v13 offset:41024
v_mfma_f32_32x32x16_bf16 v[128:143], v[216:219], a[232:235], v[128:143]
ds_read_b64_tr_b16 a[106:107], v13 offset:42304
ds_read_b64_tr_b16 a[108:109], v13 offset:46144
v_mfma_f32_32x32x16_bf16 v[128:143], v[220:223], a[236:239], v[128:143]
ds_read_b64_tr_b16 a[110:111], v13 offset:47424
ds_read_b64_tr_b16 a[112:113], v13 offset:51264
v_mfma_f32_32x32x16_bf16 v[128:143], v[224:227], a[240:243], v[128:143]
ds_read_b64_tr_b16 a[114:115], v13 offset:52544
ds_read_b64_tr_b16 a[116:117], v13 offset:56384
v_mfma_f32_32x32x16_bf16 v[128:143], v[228:231], a[244:247], v[128:143]
ds_read_b64_tr_b16 a[118:119], v13 offset:57664
ds_read_b64_tr_b16 a[120:121], v13 offset:20544
ds_read_b64_tr_b16 a[122:123], v13 offset:21824
v_mfma_f32_32x32x16_bf16 v[128:143], v[232:235], a[248:251], v[128:143]
ds_read_b64_tr_b16 a[124:125], v13 offset:25664
ds_read_b64_tr_b16 a[126:127], v13 offset:26944
v_mfma_f32_32x32x16_bf16 v[128:143], v[236:239], a[252:255], v[128:143]
s_waitcnt lgkmcnt(0)
v_mfma_f32_32x32x16_bf16 v[144:159], a[96:99], a[224:227], v[144:159]
ds_read_b64_tr_b16 v[208:209], v14 offset:30848
ds_read_b64_tr_b16 v[210:211], v14 offset:32128
v_mfma_f32_32x32x16_bf16 v[144:159], a[100:103], a[228:231], v[144:159]
ds_read_b64_tr_b16 v[212:213], v14 offset:35968
ds_read_b64_tr_b16 v[214:215], v14 offset:37248
ds_read_b64_tr_b16 v[216:217], v13 offset:41088
v_mfma_f32_32x32x16_bf16 v[144:159], a[104:107], a[232:235], v[144:159]
ds_read_b64_tr_b16 v[218:219], v13 offset:42368
ds_read_b64_tr_b16 v[220:221], v13 offset:46208
v_mfma_f32_32x32x16_bf16 v[144:159], a[108:111], a[236:239], v[144:159]
ds_read_b64_tr_b16 v[222:223], v13 offset:47488
ds_read_b64_tr_b16 v[224:225], v13 offset:51328
v_cvt_pk_bf16_f32 v32, v128, v129
v_cvt_pk_bf16_f32 v33, v130, v131
v_cvt_pk_bf16_f32 v34, v132, v133
v_cvt_pk_bf16_f32 v35, v134, v135
v_mfma_f32_32x32x16_bf16 v[144:159], a[112:115], a[240:243], v[144:159]
ds_read_b64_tr_b16 v[226:227], v13 offset:52608
ds_read_b64_tr_b16 v[228:229], v13 offset:56448
v_cvt_pk_bf16_f32 v36, v136, v137
v_cvt_pk_bf16_f32 v37, v138, v139
v_cvt_pk_bf16_f32 v38, v140, v141
v_cvt_pk_bf16_f32 v39, v142, v143
v_mfma_f32_32x32x16_bf16 v[144:159], a[116:119], a[244:247], v[144:159]
ds_read_b64_tr_b16 v[230:231], v13 offset:57728
ds_read_b64_tr_b16 v[232:233], v13 offset:20608
ds_read_b64_tr_b16 v[234:235], v13 offset:21888
ds_write_b128 v10, v[32:35] offset:0
ds_write_b128 v10, v[36:39] offset:1024
v_bfi_b32 v32, s60, v17, v32
v_bfi_b32 v33, s60, v18, v33
v_bfi_b32 v34, s60, v19, v34
v_mfma_f32_32x32x16_bf16 v[144:159], a[120:123], a[248:251], v[144:159]
ds_read_b64_tr_b16 v[236:237], v13 offset:25728
ds_read_b64_tr_b16 v[238:239], v13 offset:27008
v_bfi_b32 v35, s60, v20, v35
v_bfi_b32 v36, s60, v17, v36
v_bfi_b32 v37, s60, v18, v37
v_bfi_b32 v38, s60, v19, v38
v_mfma_f32_32x32x16_bf16 v[144:159], a[124:127], a[252:255], v[144:159]
v_bfi_b32 v39, s60, v20, v39
s_add_u32 s41, s54, 0
buffer_store_dwordx4 v[32:35], v9, s[24:27], s41 offen offset:0 sc1
buffer_store_dwordx4 v[36:39], v9, s[24:27], s41 offen offset:1024 sc1
s_waitcnt lgkmcnt(0)
v_mfma_f32_32x32x16_bf16 v[160:175], v[208:211], a[224:227], v[160:175]
ds_read_b64_tr_b16 a[96:97], v14 offset:30912
ds_read_b64_tr_b16 a[98:99], v14 offset:32192
v_mfma_f32_32x32x16_bf16 v[160:175], v[212:215], a[228:231], v[160:175]
ds_read_b64_tr_b16 a[100:101], v14 offset:36032
ds_read_b64_tr_b16 a[102:103], v14 offset:37312
ds_read_b64_tr_b16 a[104:105], v13 offset:41152
v_mfma_f32_32x32x16_bf16 v[160:175], v[216:219], a[232:235], v[160:175]
ds_read_b64_tr_b16 a[106:107], v13 offset:42432
ds_read_b64_tr_b16 a[108:109], v13 offset:46272
v_mfma_f32_32x32x16_bf16 v[160:175], v[220:223], a[236:239], v[160:175]
ds_read_b64_tr_b16 a[110:111], v13 offset:47552
ds_read_b64_tr_b16 a[112:113], v13 offset:51392
v_cvt_pk_bf16_f32 v40, v144, v145
v_cvt_pk_bf16_f32 v41, v146, v147
v_cvt_pk_bf16_f32 v42, v148, v149
v_cvt_pk_bf16_f32 v43, v150, v151
v_mfma_f32_32x32x16_bf16 v[160:175], v[224:227], a[240:243], v[160:175]
ds_read_b64_tr_b16 a[114:115], v13 offset:52672
ds_read_b64_tr_b16 a[116:117], v13 offset:56512
v_cvt_pk_bf16_f32 v44, v152, v153
v_cvt_pk_bf16_f32 v45, v154, v155
v_cvt_pk_bf16_f32 v46, v156, v157
v_cvt_pk_bf16_f32 v47, v158, v159
v_mfma_f32_32x32x16_bf16 v[160:175], v[228:231], a[244:247], v[160:175]
ds_read_b64_tr_b16 a[118:119], v13 offset:57792
ds_read_b64_tr_b16 a[120:121], v13 offset:20672
ds_read_b64_tr_b16 a[122:123], v13 offset:21952
ds_write_b128 v10, v[40:43] offset:2048
ds_write_b128 v10, v[44:47] offset:3072
v_bfi_b32 v40, s60, v17, v40
v_bfi_b32 v41, s60, v18, v41
v_bfi_b32 v42, s60, v19, v42
v_mfma_f32_32x32x16_bf16 v[160:175], v[232:235], a[248:251], v[160:175]
ds_read_b64_tr_b16 a[124:125], v13 offset:25792
ds_read_b64_tr_b16 a[126:127], v13 offset:27072
v_bfi_b32 v43, s60, v20, v43
v_bfi_b32 v44, s60, v17, v44
v_bfi_b32 v45, s60, v18, v45
v_bfi_b32 v46, s60, v19, v46
v_mfma_f32_32x32x16_bf16 v[160:175], v[236:239], a[252:255], v[160:175]
v_bfi_b32 v47, s60, v20, v47
s_add_u32 s41, s54, 2048
buffer_store_dwordx4 v[40:43], v9, s[24:27], s41 offen offset:0 sc1
buffer_store_dwordx4 v[44:47], v9, s[24:27], s41 offen offset:1024 sc1
s_waitcnt lgkmcnt(0)
v_mfma_f32_32x32x16_bf16 v[176:191], a[96:99], a[224:227], v[176:191]
ds_read_b64_tr_b16 v[208:209], v14 offset:30976
ds_read_b64_tr_b16 v[210:211], v14 offset:32256
v_mfma_f32_32x32x16_bf16 v[176:191], a[100:103], a[228:231], v[176:191]
ds_read_b64_tr_b16 v[212:213], v14 offset:36096
ds_read_b64_tr_b16 v[214:215], v14 offset:37376
ds_read_b64_tr_b16 v[216:217], v13 offset:41216
v_mfma_f32_32x32x16_bf16 v[176:191], a[104:107], a[232:235], v[176:191]
ds_read_b64_tr_b16 v[218:219], v13 offset:42496
ds_read_b64_tr_b16 v[220:221], v13 offset:46336
v_mfma_f32_32x32x16_bf16 v[176:191], a[108:111], a[236:239], v[176:191]
ds_read_b64_tr_b16 v[222:223], v13 offset:47616
ds_read_b64_tr_b16 v[224:225], v13 offset:51456
v_cvt_pk_bf16_f32 v48, v160, v161
v_cvt_pk_bf16_f32 v49, v162, v163
v_cvt_pk_bf16_f32 v50, v164, v165
v_cvt_pk_bf16_f32 v51, v166, v167
v_mfma_f32_32x32x16_bf16 v[176:191], a[112:115], a[240:243], v[176:191]
ds_read_b64_tr_b16 v[226:227], v13 offset:52736
ds_read_b64_tr_b16 v[228:229], v13 offset:56576
v_cvt_pk_bf16_f32 v52, v168, v169
v_cvt_pk_bf16_f32 v53, v170, v171
v_cvt_pk_bf16_f32 v54, v172, v173
v_cvt_pk_bf16_f32 v55, v174, v175
v_mfma_f32_32x32x16_bf16 v[176:191], a[116:119], a[244:247], v[176:191]
ds_read_b64_tr_b16 v[230:231], v13 offset:57856
ds_read_b64_tr_b16 v[232:233], v13 offset:20736
ds_read_b64_tr_b16 v[234:235], v13 offset:22016
ds_write_b128 v10, v[48:51] offset:4096
ds_write_b128 v10, v[52:55] offset:5120
v_bfi_b32 v48, s60, v17, v48
v_bfi_b32 v49, s60, v18, v49
v_bfi_b32 v50, s60, v19, v50
v_mfma_f32_32x32x16_bf16 v[176:191], a[120:123], a[248:251], v[176:191]
ds_read_b64_tr_b16 v[236:237], v13 offset:25856
ds_read_b64_tr_b16 v[238:239], v13 offset:27136
v_bfi_b32 v51, s60, v20, v51
v_bfi_b32 v52, s60, v17, v52
v_bfi_b32 v53, s60, v18, v53
v_bfi_b32 v54, s60, v19, v54
v_mfma_f32_32x32x16_bf16 v[176:191], a[124:127], a[252:255], v[176:191]
v_bfi_b32 v55, s60, v20, v55
s_add_u32 s41, s54, 4096
buffer_store_dwordx4 v[48:51], v9, s[24:27], s41 offen offset:0 sc1
buffer_store_dwordx4 v[52:55], v9, s[24:27], s41 offen offset:1024 sc1
s_waitcnt lgkmcnt(0)
v_mfma_f32_32x32x16_bf16 v[192:207], v[208:211], a[224:227], v[192:207]
v_mfma_f32_32x32x16_bf16 v[192:207], v[212:215], a[228:231], v[192:207]
v_mfma_f32_32x32x16_bf16 v[192:207], v[216:219], a[232:235], v[192:207]
v_mfma_f32_32x32x16_bf16 v[192:207], v[220:223], a[236:239], v[192:207]
s_nop 5
v_cvt_pk_bf16_f32 v56, v176, v177
v_cvt_pk_bf16_f32 v57, v178, v179
v_cvt_pk_bf16_f32 v58, v180, v181
v_mfma_f32_32x32x16_bf16 v[192:207], v[224:227], a[240:243], v[192:207]
v_cvt_pk_bf16_f32 v59, v182, v183
v_cvt_pk_bf16_f32 v60, v184, v185
v_cvt_pk_bf16_f32 v61, v186, v187
v_cvt_pk_bf16_f32 v62, v188, v189
v_cvt_pk_bf16_f32 v63, v190, v191
v_mfma_f32_32x32x16_bf16 v[192:207], v[228:231], a[244:247], v[192:207]
ds_write_b128 v10, v[56:59] offset:6144
ds_write_b128 v10, v[60:63] offset:7168
v_bfi_b32 v56, s60, v17, v56
v_bfi_b32 v57, s60, v18, v57
v_mfma_f32_32x32x16_bf16 v[192:207], v[232:235], a[248:251], v[192:207]
v_bfi_b32 v58, s60, v19, v58
v_bfi_b32 v59, s60, v20, v59
v_bfi_b32 v60, s60, v17, v60
v_bfi_b32 v61, s60, v18, v61
v_bfi_b32 v62, s60, v19, v62
v_mfma_f32_32x32x16_bf16 v[192:207], v[236:239], a[252:255], v[192:207]
v_bfi_b32 v63, s60, v20, v63
s_add_u32 s41, s54, 6144
buffer_store_dwordx4 v[56:59], v9, s[24:27], s41 offen offset:0 sc1
buffer_store_dwordx4 v[60:63], v9, s[24:27], s41 offen offset:1024 sc1
s_waitcnt lgkmcnt(0)
s_nop 10
v_cvt_pk_bf16_f32 v64, v192, v193
v_cvt_pk_bf16_f32 v65, v194, v195
v_cvt_pk_bf16_f32 v66, v196, v197
v_cvt_pk_bf16_f32 v67, v198, v199
v_cvt_pk_bf16_f32 v68, v200, v201
v_cvt_pk_bf16_f32 v69, v202, v203
v_cvt_pk_bf16_f32 v70, v204, v205
v_cvt_pk_bf16_f32 v71, v206, v207
ds_write_b128 v10, v[64:67] offset:8192
ds_write_b128 v10, v[68:71] offset:9216
v_bfi_b32 v64, s60, v17, v64
v_bfi_b32 v65, s60, v18, v65
v_bfi_b32 v66, s60, v19, v66
v_bfi_b32 v67, s60, v20, v67
v_bfi_b32 v68, s60, v17, v68
v_bfi_b32 v69, s60, v18, v69
v_bfi_b32 v70, s60, v19, v70
v_bfi_b32 v71, s60, v20, v71
s_add_u32 s41, s54, 8192
buffer_store_dwordx4 v[64:67], v9, s[24:27], s41 offen offset:0 sc1
buffer_store_dwordx4 v[68:71], v9, s[24:27], s41 offen offset:1024 sc1
s_add_u32 s41, s39, 1
s_and_b32 s41, s41, 3
s_mul_i32 s41, s41, 30720
s_add_u32 s61, s56, s41
buffer_load_dwordx4 v[72:75], v3, s[24:27], s61 offen sc1
buffer_load_dwordx4 v[76:79], v4, s[24:27], s61 offen sc1
buffer_load_dwordx4 v[80:83], v5, s[24:27], s61 offen sc1
s_add_u32 s41, s39, 2
s_and_b32 s41, s41, 3
s_mul_i32 s41, s41, 30720
s_add_u32 s62, s56, s41
buffer_load_dwordx4 v[84:87], v3, s[24:27], s62 offen sc1
buffer_load_dwordx4 v[88:91], v4, s[24:27], s62 offen sc1
buffer_load_dwordx4 v[92:95], v5, s[24:27], s62 offen sc1
s_add_u32 s41, s39, 3
s_and_b32 s41, s41, 3
s_mul_i32 s41, s41, 30720
s_add_u32 s63, s56, s41
buffer_load_dwordx4 v[96:99], v3, s[24:27], s63 offen sc1
buffer_load_dwordx4 v[100:103], v4, s[24:27], s63 offen sc1
buffer_load_dwordx4 v[104:107], v5, s[24:27], s63 offen sc1
ds_read_b128 v[108:111], v11
ds_read_b128 v[112:115], v12
ds_read_b128 v[116:119], v2
s_mov_b32 s42, 0
s_waitcnt lgkmcnt(0)
v_lshlrev_b32 v128, 16, v108
v_and_b32 v129, s58, v108
v_lshlrev_b32 v130, 16, v109
v_and_b32 v131, s58, v109
v_lshlrev_b32 v132, 16, v110
v_and_b32 v133, s58, v110
v_lshlrev_b32 v134, 16, v111
v_and_b32 v135, s58, v111
v_lshlrev_b32 v136, 16, v112
v_and_b32 v137, s58, v112
v_lshlrev_b32 v138, 16, v113
v_and_b32 v139, s58, v113
v_lshlrev_b32 v140, 16, v114
v_and_b32 v141, s58, v114
v_lshlrev_b32 v142, 16, v115
v_and_b32 v143, s58, v115
v_lshlrev_b32 v144, 16, v116
v_and_b32 v145, s58, v116
v_lshlrev_b32 v146, 16, v117
v_and_b32 v147, s58, v117
v_lshlrev_b32 v148, 16, v118
v_and_b32 v149, s58, v118
v_lshlrev_b32 v150, 16, v119
v_and_b32 v151, s58, v119
s_waitcnt vmcnt(6)
s_branch L_fc0
L_fr0:
buffer_load_dwordx4 v[72:75], v3, s[24:27], s61 offen sc1
buffer_load_dwordx4 v[76:79], v4, s[24:27], s61 offen sc1
buffer_load_dwordx4 v[80:83], v5, s[24:27], s61 offen sc1
s_add_u32 s42, s42, 1
s_cmp_ge_u32 s42, 65536
s_cbranch_scc1 L_fd0
s_waitcnt vmcnt(0)
L_fc0:
v_xor_b32 v72, v17, v72
v_xor_b32 v73, v18, v73
v_xor_b32 v74, v19, v74
v_xor_b32 v75, v20, v75
v_xor_b32 v76, v17, v76
v_xor_b32 v77, v18, v77
v_xor_b32 v78, v19, v78
v_xor_b32 v79, v20, v79
v_xor_b32 v80, v17, v80
v_xor_b32 v81, v18, v81
v_xor_b32 v82, v19, v82
v_xor_b32 v83, v20, v83
v_or3_b32 v120, v72, v73, v74
v_or3_b32 v120, v120, v75, v76
v_or3_b32 v120, v120, v77, v78
v_or3_b32 v120, v120, v79, v80
v_or3_b32 v120, v120, v81, v82
v_or_b32 v120, v120, v83
v_and_b32 v120, s60, v120
v_cmp_ne_u32 vcc, 0, v120
s_cbranch_vccnz L_fr0
L_fd0:
v_lshl_or_b32 v152, v72, 16, v16
v_and_or_b32 v153, v72, s58, v16
v_lshl_or_b32 v154, v73, 16, v16
v_and_or_b32 v155, v73, s58, v16
v_lshl_or_b32 v156, v74, 16, v16
v_and_or_b32 v157, v74, s58, v16
v_lshl_or_b32 v158, v75, 16, v16
v_and_or_b32 v159, v75, s58, v16
v_pk_add_f32 v[128:129], v[128:129], v[152:153]
v_pk_add_f32 v[130:131], v[130:131], v[154:155]
v_pk_add_f32 v[132:133], v[132:133], v[156:157]
v_pk_add_f32 v[134:135], v[134:135], v[158:159]
v_lshl_or_b32 v160, v76, 16, v16
v_and_or_b32 v161, v76, s58, v16
v_lshl_or_b32 v162, v77, 16, v16
v_and_or_b32 v163, v77, s58, v16
v_lshl_or_b32 v164, v78, 16, v16
v_and_or_b32 v165, v78, s58, v16
v_lshl_or_b32 v166, v79, 16, v16
v_and_or_b32 v167, v79, s58, v16
v_pk_add_f32 v[136:137], v[136:137], v[160:161]
v_pk_add_f32 v[138:139], v[138:139], v[162:163]
v_pk_add_f32 v[140:141], v[140:141], v[164:165]
v_pk_add_f32 v[142:143], v[142:143], v[166:167]
v_lshl_or_b32 v168, v80, 16, v16
v_and_or_b32 v169, v80, s58, v16
v_lshl_or_b32 v170, v81, 16, v16
v_and_or_b32 v171, v81, s58, v16
v_lshl_or_b32 v172, v82, 16, v16
v_and_or_b32 v173, v82, s58, v16
v_lshl_or_b32 v174, v83, 16, v16
v_and_or_b32 v175, v83, s58, v16
v_pk_add_f32 v[144:145], v[144:145], v[168:169]
v_pk_add_f32 v[146:147], v[146:147], v[170:171]
v_pk_add_f32 v[148:149], v[148:149], v[172:173]
v_pk_add_f32 v[150:151], v[150:151], v[174:175]
s_waitcnt vmcnt(3)
s_branch L_fc1
L_fr1:
buffer_load_dwordx4 v[84:87], v3, s[24:27], s62 offen sc1
buffer_load_dwordx4 v[88:91], v4, s[24:27], s62 offen sc1
buffer_load_dwordx4 v[92:95], v5, s[24:27], s62 offen sc1
s_add_u32 s42, s42, 1
s_cmp_ge_u32 s42, 65536
s_cbranch_scc1 L_fd1
s_waitcnt vmcnt(0)
L_fc1:
v_xor_b32 v84, v17, v84
v_xor_b32 v85, v18, v85
v_xor_b32 v86, v19, v86
v_xor_b32 v87, v20, v87
v_xor_b32 v88, v17, v88
v_xor_b32 v89, v18, v89
v_xor_b32 v90, v19, v90
v_xor_b32 v91, v20, v91
v_xor_b32 v92, v17, v92
v_xor_b32 v93, v18, v93
v_xor_b32 v94, v19, v94
v_xor_b32 v95, v20, v95
v_or3_b32 v120, v84, v85, v86
v_or3_b32 v120, v120, v87, v88
v_or3_b32 v120, v120, v89, v90
v_or3_b32 v120, v120, v91, v92
v_or3_b32 v120, v120, v93, v94
v_or_b32 v120, v120, v95
v_and_b32 v120, s60, v120
v_cmp_ne_u32 vcc, 0, v120
s_cbranch_vccnz L_fr1
L_fd1:
v_lshl_or_b32 v152, v84, 16, v16
v_and_or_b32 v153, v84, s58, v16
v_lshl_or_b32 v154, v85, 16, v16
v_and_or_b32 v155, v85, s58, v16
v_lshl_or_b32 v156, v86, 16, v16
v_and_or_b32 v157, v86, s58, v16
v_lshl_or_b32 v158, v87, 16, v16
v_and_or_b32 v159, v87, s58, v16
v_pk_add_f32 v[128:129], v[128:129], v[152:153]
v_pk_add_f32 v[130:131], v[130:131], v[154:155]
v_pk_add_f32 v[132:133], v[132:133], v[156:157]
v_pk_add_f32 v[134:135], v[134:135], v[158:159]
v_lshl_or_b32 v160, v88, 16, v16
v_and_or_b32 v161, v88, s58, v16
v_lshl_or_b32 v162, v89, 16, v16
v_and_or_b32 v163, v89, s58, v16
v_lshl_or_b32 v164, v90, 16, v16
v_and_or_b32 v165, v90, s58, v16
v_lshl_or_b32 v166, v91, 16, v16
v_and_or_b32 v167, v91, s58, v16
v_pk_add_f32 v[136:137], v[136:137], v[160:161]
v_pk_add_f32 v[138:139], v[138:139], v[162:163]
v_pk_add_f32 v[140:141], v[140:141], v[164:165]
v_pk_add_f32 v[142:143], v[142:143], v[166:167]
v_lshl_or_b32 v168, v92, 16, v16
v_and_or_b32 v169, v92, s58, v16
v_lshl_or_b32 v170, v93, 16, v16
v_and_or_b32 v171, v93, s58, v16
v_lshl_or_b32 v172, v94, 16, v16
v_and_or_b32 v173, v94, s58, v16
v_lshl_or_b32 v174, v95, 16, v16
v_and_or_b32 v175, v95, s58, v16
v_pk_add_f32 v[144:145], v[144:145], v[168:169]
v_pk_add_f32 v[146:147], v[146:147], v[170:171]
v_pk_add_f32 v[148:149], v[148:149], v[172:173]
v_pk_add_f32 v[150:151], v[150:151], v[174:175]
s_waitcnt vmcnt(0)
s_branch L_fc2
L_fr2:
buffer_load_dwordx4 v[96:99], v3, s[24:27], s63 offen sc1
buffer_load_dwordx4 v[100:103], v4, s[24:27], s63 offen sc1
buffer_load_dwordx4 v[104:107], v5, s[24:27], s63 offen sc1
s_add_u32 s42, s42, 1
s_cmp_ge_u32 s42, 65536
s_cbranch_scc1 L_fd2
s_waitcnt vmcnt(0)
L_fc2:
v_xor_b32 v96, v17, v96
v_xor_b32 v97, v18, v97
v_xor_b32 v98, v19, v98
v_xor_b32 v99, v20, v99
v_xor_b32 v100, v17, v100
v_xor_b32 v101, v18, v101
v_xor_b32 v102, v19, v102
v_xor_b32 v103, v20, v103
v_xor_b32 v104, v17, v104
v_xor_b32 v105, v18, v105
v_xor_b32 v106, v19, v106
v_xor_b32 v107, v20, v107
v_or3_b32 v120, v96, v97, v98
v_or3_b32 v120, v120, v99, v100
v_or3_b32 v120, v120, v101, v102
v_or3_b32 v120, v120, v103, v104
v_or3_b32 v120, v120, v105, v106
v_or_b32 v120, v120, v107
v_and_b32 v120, s60, v120
v_cmp_ne_u32 vcc, 0, v120
s_cbranch_vccnz L_fr2
L_fd2:
v_lshl_or_b32 v152, v96, 16, v16
v_and_or_b32 v153, v96, s58, v16
v_lshl_or_b32 v154, v97, 16, v16
v_and_or_b32 v155, v97, s58, v16
v_lshl_or_b32 v156, v98, 16, v16
v_and_or_b32 v157, v98, s58, v16
v_lshl_or_b32 v158, v99, 16, v16
v_and_or_b32 v159, v99, s58, v16
v_pk_add_f32 v[128:129], v[128:129], v[152:153]
v_pk_add_f32 v[130:131], v[130:131], v[154:155]
v_pk_add_f32 v[132:133], v[132:133], v[156:157]
v_pk_add_f32 v[134:135], v[134:135], v[158:159]
v_cvt_pk_bf16_f32 v176, v128, v129
v_cvt_pk_bf16_f32 v177, v130, v131
v_cvt_pk_bf16_f32 v178, v132, v133
v_cvt_pk_bf16_f32 v179, v134, v135
buffer_store_dwordx4 v[176:179], v6, s[32:35], s57 offen sc1
v_lshl_or_b32 v160, v100, 16, v16
v_and_or_b32 v161, v100, s58, v16
v_lshl_or_b32 v162, v101, 16, v16
v_and_or_b32 v163, v101, s58, v16
v_lshl_or_b32 v164, v102, 16, v16
v_and_or_b32 v165, v102, s58, v16
v_lshl_or_b32 v166, v103, 16, v16
v_and_or_b32 v167, v103, s58, v16
v_pk_add_f32 v[136:137], v[136:137], v[160:161]
v_pk_add_f32 v[138:139], v[138:139], v[162:163]
v_pk_add_f32 v[140:141], v[140:141], v[164:165]
v_pk_add_f32 v[142:143], v[142:143], v[166:167]
v_cvt_pk_bf16_f32 v180, v136, v137
v_cvt_pk_bf16_f32 v181, v138, v139
v_cvt_pk_bf16_f32 v182, v140, v141
v_cvt_pk_bf16_f32 v183, v142, v143
buffer_store_dwordx4 v[180:183], v7, s[32:35], s57 offen sc1
v_lshl_or_b32 v168, v104, 16, v16
v_and_or_b32 v169, v104, s58, v16
v_lshl_or_b32 v170, v105, 16, v16
v_and_or_b32 v171, v105, s58, v16
v_lshl_or_b32 v172, v106, 16, v16
v_and_or_b32 v173, v106, s58, v16
v_lshl_or_b32 v174, v107, 16, v16
v_and_or_b32 v175, v107, s58, v16
v_pk_add_f32 v[144:145], v[144:145], v[168:169]
v_pk_add_f32 v[146:147], v[146:147], v[170:171]
v_pk_add_f32 v[148:149], v[148:149], v[172:173]
v_pk_add_f32 v[150:151], v[150:151], v[174:175]
v_cvt_pk_bf16_f32 v184, v144, v145
v_cvt_pk_bf16_f32 v185, v146, v147
v_cvt_pk_bf16_f32 v186, v148, v149
v_cvt_pk_bf16_f32 v187, v150, v151
buffer_store_dwordx4 v[184:187], v8, s[32:35], s57 offen sc1
s_endpgm
L_spinA:
s_mov_b32 s48, 0
L_spinlA:
buffer_load_dword v29, v15, s[24:27], s42 offen sc1
s_add_u32 s48, s48, 1
s_cmp_ge_u32 s48, 65536
s_cbranch_scc1 L_spindA
s_waitcnt vmcnt(0)
v_cmp_gt_u32 vcc, s43, v29
s_cbranch_vccnz L_spinlA
L_spindA:
s_waitcnt vmcnt(0)
s_setpc_b64 s[46:47]
L_rare0:
v_mov_b32 v28, v26
s_nop 1
v_permlane32_swap_b32 v26, v28
s_nop 0
v_max_f32 v26, v26, v28
v_max_f32 v26, 0, v26
v_sub_f32 v27, 0, v26
v_exp_f32 v27, v27
s_nop 7
v_sub_f32 v64, v64, v26
v_sub_f32 v65, v65, v26
v_sub_f32 v66, v66, v26
v_sub_f32 v67, v67, v26
v_sub_f32 v68, v68, v26
v_sub_f32 v69, v69, v26
v_sub_f32 v70, v70, v26
v_sub_f32 v71, v71, v26
v_sub_f32 v72, v72, v26
v_sub_f32 v73, v73, v26
v_sub_f32 v74, v74, v26
v_sub_f32 v75, v75, v26
v_sub_f32 v76, v76, v26
v_sub_f32 v77, v77, v26
v_sub_f32 v78, v78, v26
v_sub_f32 v79, v79, v26
v_sub_f32 v80, v80, v26
v_sub_f32 v81, v81, v26
v_sub_f32 v82, v82, v26
v_sub_f32 v83, v83, v26
v_sub_f32 v84, v84, v26
v_sub_f32 v85, v85, v26
v_sub_f32 v86, v86, v26
v_sub_f32 v87, v87, v26
v_sub_f32 v88, v88, v26
v_sub_f32 v89, v89, v26
v_sub_f32 v90, v90, v26
v_sub_f32 v91, v91, v26
v_sub_f32 v92, v92, v26
v_sub_f32 v93, v93, v26
v_sub_f32 v94, v94, v26
v_sub_f32 v95, v95, v26
s_branch L_rescaleO
L_rare1:
v_mov_b32 v28, v26
s_nop 1
v_permlane32_swap_b32 v26, v28
s_nop 0
v_max_f32 v26, v26, v28
v_max_f32 v26, 0, v26
v_sub_f32 v27, 0, v26
v_exp_f32 v27, v27
s_nop 7
v_sub_f32 v96, v96, v26
v_sub_f32 v97, v97, v26
v_sub_f32 v98, v98, v26
v_sub_f32 v99, v99, v26
v_sub_f32 v100, v100, v26
v_sub_f32 v101, v101, v26
v_sub_f32 v102, v102, v26
v_sub_f32 v103, v103, v26
v_sub_f32 v104, v104, v26
v_sub_f32 v105, v105, v26
v_sub_f32 v106, v106, v26
v_sub_f32 v107, v107, v26
v_sub_f32 v108, v108, v26
v_sub_f32 v109, v109, v26
v_sub_f32 v110, v110, v26
v_sub_f32 v111, v111, v26
v_sub_f32 v112, v112, v26
v_sub_f32 v113, v113, v26
v_sub_f32 v114, v114, v26
v_sub_f32 v115, v115, v26
v_sub_f32 v116, v116, v26
v_sub_f32 v117, v117, v26
v_sub_f32 v118, v118, v26
v_sub_f32 v119, v119, v26
v_sub_f32 v120, v120, v26
v_sub_f32 v121, v121, v26
v_sub_f32 v122, v122, v26
v_sub_f32 v123, v123, v26
v_sub_f32 v124, v124, v26
v_sub_f32 v125, v125, v26
v_sub_f32 v126, v126, v26
v_sub_f32 v127, v127, v26
s_branch L_rescaleO
L_rescaleO:
v_sub_f32 v48, v48, v26
v_sub_f32 v49, v49, v26
v_sub_f32 v50, v50, v26
v_sub_f32 v51, v51, v26
v_sub_f32 v52, v52, v26
v_sub_f32 v53, v53, v26
v_sub_f32 v54, v54, v26
v_sub_f32 v55, v55, v26
v_sub_f32 v56, v56, v26
v_sub_f32 v57, v57, v26
v_sub_f32 v58, v58, v26
v_sub_f32 v59, v59, v26
v_sub_f32 v60, v60, v26
v_sub_f32 v61, v61, v26
v_sub_f32 v62, v62, v26
v_sub_f32 v63, v63, v26
v_mul_f32 v24, v24, v27
v_mul_f32 v25, v25, v27
v_accvgpr_read_b32 v28, a0
v_accvgpr_read_b32 v29, a1
v_mul_f32 v28, v28, v27
v_mul_f32 v29, v29, v27
v_accvgpr_write_b32 a0, v28
v_accvgpr_write_b32 a1, v29
v_accvgpr_read_b32 v28, a2
v_accvgpr_read_b32 v29, a3
v_mul_f32 v28, v28, v27
v_mul_f32 v29, v29, v27
v_accvgpr_write_b32 a2, v28
v_accvgpr_write_b32 a3, v29
v_accvgpr_read_b32 v28, a4
v_accvgpr_read_b32 v29, a5
v_mul_f32 v28, v28, v27
v_mul_f32 v29, v29, v27
v_accvgpr_write_b32 a4, v28
v_accvgpr_write_b32 a5, v29
v_accvgpr_read_b32 v28, a6
v_accvgpr_read_b32 v29, a7
v_mul_f32 v28, v28, v27
v_mul_f32 v29, v29, v27
v_accvgpr_write_b32 a6, v28
v_accvgpr_write_b32 a7, v29
v_accvgpr_read_b32 v28, a8
v_accvgpr_read_b32 v29, a9
v_mul_f32 v28, v28, v27
v_mul_f32 v29, v29, v27
v_accvgpr_write_b32 a8, v28
v_accvgpr_write_b32 a9, v29
v_accvgpr_read_b32 v28, a10
v_accvgpr_read_b32 v29, a11
v_mul_f32 v28, v28, v27
v_mul_f32 v29, v29, v27
v_accvgpr_write_b32 a10, v28
v_accvgpr_write_b32 a11, v29
v_accvgpr_read_b32 v28, a12
v_accvgpr_read_b32 v29, a13
v_mul_f32 v28, v28, v27
v_mul_f32 v29, v29, v27
v_accvgpr_write_b32 a12, v28
v_accvgpr_write_b32 a13, v29
v_accvgpr_read_b32 v28, a14
v_accvgpr_read_b32 v29, a15
v_mul_f32 v28, v28, v27
v_mul_f32 v29, v29, v27
v_accvgpr_write_b32 a14, v28
v_accvgpr_write_b32 a15, v29
v_accvgpr_read_b32 v28, a16
v_accvgpr_read_b32 v29, a17
v_mul_f32 v28, v28, v27
v_mul_f32 v29, v29, v27
v_accvgpr_write_b32 a16, v28
v_accvgpr_write_b32 a17, v29
v_accvgpr_read_b32 v28, a18
v_accvgpr_read_b32 v29, a19
v_mul_f32 v28, v28, v27
v_mul_f32 v29, v29, v27
v_accvgpr_write_b32 a18, v28
v_accvgpr_write_b32 a19, v29
v_accvgpr_read_b32 v28, a20
v_accvgpr_read_b32 v29, a21
v_mul_f32 v28, v28, v27
v_mul_f32 v29, v29, v27
v_accvgpr_write_b32 a20, v28
v_accvgpr_write_b32 a21, v29
v_accvgpr_read_b32 v28, a22
v_accvgpr_read_b32 v29, a23
v_mul_f32 v28, v28, v27
v_mul_f32 v29, v29, v27
v_accvgpr_write_b32 a22, v28
v_accvgpr_write_b32 a23, v29
v_accvgpr_read_b32 v28, a24
v_accvgpr_read_b32 v29, a25
v_mul_f32 v28, v28, v27
v_mul_f32 v29, v29, v27
v_accvgpr_write_b32 a24, v28
v_accvgpr_write_b32 a25, v29
v_accvgpr_read_b32 v28, a26
v_accvgpr_read_b32 v29, a27
v_mul_f32 v28, v28, v27
v_mul_f32 v29, v29, v27
v_accvgpr_write_b32 a26, v28
v_accvgpr_write_b32 a27, v29
v_accvgpr_read_b32 v28, a28
v_accvgpr_read_b32 v29, a29
v_mul_f32 v28, v28, v27
v_mul_f32 v29, v29, v27
v_accvgpr_write_b32 a28, v28
v_accvgpr_write_b32 a29, v29
v_accvgpr_read_b32 v28, a30
v_accvgpr_read_b32 v29, a31
v_mul_f32 v28, v28, v27
v_mul_f32 v29, v29, v27
v_accvgpr_write_b32 a30, v28
v_accvgpr_write_b32 a31, v29
v_accvgpr_read_b32 v28, a32
v_accvgpr_read_b32 v29, a33
v_mul_f32 v28, v28, v27
v_mul_f32 v29, v29, v27
v_accvgpr_write_b32 a32, v28
v_accvgpr_write_b32 a33, v29
v_accvgpr_read_b32 v28, a34
v_accvgpr_read_b32 v29, a35
v_mul_f32 v28, v28, v27
v_mul_f32 v29, v29, v27
v_accvgpr_write_b32 a34, v28
v_accvgpr_write_b32 a35, v29
v_accvgpr_read_b32 v28, a36
v_accvgpr_read_b32 v29, a37
v_mul_f32 v28, v28, v27
v_mul_f32 v29, v29, v27
v_accvgpr_write_b32 a36, v28
v_accvgpr_write_b32 a37, v29
v_accvgpr_read_b32 v28, a38
v_accvgpr_read_b32 v29, a39
v_mul_f32 v28, v28, v27
v_mul_f32 v29, v29, v27
v_accvgpr_write_b32 a38, v28
v_accvgpr_write_b32 a39, v29
v_accvgpr_read_b32 v28, a40
v_accvgpr_read_b32 v29, a41
v_mul_f32 v28, v28, v27
v_mul_f32 v29, v29, v27
v_accvgpr_write_b32 a40, v28
v_accvgpr_write_b32 a41, v29
v_accvgpr_read_b32 v28, a42
v_accvgpr_read_b32 v29, a43
v_mul_f32 v28, v28, v27
v_mul_f32 v29, v29, v27
v_accvgpr_write_b32 a42, v28
v_accvgpr_write_b32 a43, v29
v_accvgpr_read_b32 v28, a44
v_accvgpr_read_b32 v29, a45
v_mul_f32 v28, v28, v27
v_mul_f32 v29, v29, v27
v_accvgpr_write_b32 a44, v28
v_accvgpr_write_b32 a45, v29
v_accvgpr_read_b32 v28, a46
v_accvgpr_read_b32 v29, a47
v_mul_f32 v28, v28, v27
v_mul_f32 v29, v29, v27
v_accvgpr_write_b32 a46, v28
v_accvgpr_write_b32 a47, v29
v_accvgpr_read_b32 v28, a48
v_accvgpr_read_b32 v29, a49
v_mul_f32 v28, v28, v27
v_mul_f32 v29, v29, v27
v_accvgpr_write_b32 a48, v28
v_accvgpr_write_b32 a49, v29
v_accvgpr_read_b32 v28, a50
v_accvgpr_read_b32 v29, a51
v_mul_f32 v28, v28, v27
v_mul_f32 v29, v29, v27
v_accvgpr_write_b32 a50, v28
v_accvgpr_write_b32 a51, v29
v_accvgpr_read_b32 v28, a52
v_accvgpr_read_b32 v29, a53
v_mul_f32 v28, v28, v27
v_mul_f32 v29, v29, v27
v_accvgpr_write_b32 a52, v28
v_accvgpr_write_b32 a53, v29
v_accvgpr_read_b32 v28, a54
v_accvgpr_read_b32 v29, a55
v_mul_f32 v28, v28, v27
v_mul_f32 v29, v29, v27
v_accvgpr_write_b32 a54, v28
v_accvgpr_write_b32 a55, v29
v_accvgpr_read_b32 v28, a56
v_accvgpr_read_b32 v29, a57
v_mul_f32 v28, v28, v27
v_mul_f32 v29, v29, v27
v_accvgpr_write_b32 a56, v28
v_accvgpr_write_b32 a57, v29
v_accvgpr_read_b32 v28, a58
v_accvgpr_read_b32 v29, a59
v_mul_f32 v28, v28, v27
v_mul_f32 v29, v29, v27
v_accvgpr_write_b32 a58, v28
v_accvgpr_write_b32 a59, v29
v_accvgpr_read_b32 v28, a60
v_accvgpr_read_b32 v29, a61
v_mul_f32 v28, v28, v27
v_mul_f32 v29, v29, v27
v_accvgpr_write_b32 a60, v28
v_accvgpr_write_b32 a61, v29
v_accvgpr_read_b32 v28, a62
v_accvgpr_read_b32 v29, a63
v_mul_f32 v28, v28, v27
v_mul_f32 v29, v29, v27
v_accvgpr_write_b32 a62, v28
v_accvgpr_write_b32 a63, v29
s_nop 1
s_setpc_b64 s[46:47]
L_exit:
s_endpgm
.section .rodata,"a"
.p2align 6
.amdhsa_kernel concat_heads__gqa_block_cached__mha_block_cached__near_ridge_kernel
  .amdhsa_next_free_vgpr 512
  .amdhsa_next_free_sgpr 102
  .amdhsa_accum_offset 256
  .amdhsa_group_segment_fixed_size 0
  .amdhsa_kernarg_size 104
  .amdhsa_user_sgpr_count 2
  .amdhsa_user_sgpr_kernarg_segment_ptr 1
  .amdhsa_system_sgpr_workgroup_id_x 1
.end_amdhsa_kernel
```
